```python
import torch

def _softmax(x, axis=-1):
    return torch.softmax(x, dim=axis)
def _gelu(x):
    return torch.nn.functional.gelu(x, approximate="tanh")
def _silu(x):
    return torch.nn.functional.silu(x)
def _sigmoid(x):
    return torch.sigmoid(x)
def _layernorm(x, axis=-1, eps=1e-5):
    m = x.mean(dim=axis, keepdim=True)
    v = x.var(dim=axis, keepdim=True, unbiased=False)
    return (x - m) / torch.sqrt(v + eps)
def _scatter_add(tgt, idx, src, axis=0):
    return tgt.clone().index_add_(axis, idx, src)
def _segment_sum(src, seg, n):
    out = torch.zeros((n,) + src.shape[1:], dtype=src.dtype)
    return out.index_add_(0, seg, src)
def _pad(x, pw):
    flat = tuple(v for pair in reversed(pw) for v in pair)
    return torch.nn.functional.pad(x, flat)

kernel_name = 'recurrent_scan__ssm_conv_s5__dense_activation_squared_relu__prompt'

def setup_inputs():

    _w = (lambda a: (lambda t: t.to(torch.bfloat16) if t.is_floating_point() else t)(torch.as_tensor(a)))
    def _A_setup():
        B, S, D = 1, 2048, 640
        P = D
        Lambda_re = -0.5 * (lambda _x: torch.exp(torch.as_tensor(_x)))((lambda *s: torch.randn(*s, dtype=torch.bfloat16) * 0.2)(P))
        Lambda_im = (lambda *s: torch.randn(*s, dtype=torch.bfloat16) * 0.4)(P) * 1.0
        B_re = (lambda *s: torch.randn(*s, dtype=torch.bfloat16) * 0.2)(P, D) * (D ** -0.5)
        B_im = (lambda *s: torch.randn(*s, dtype=torch.bfloat16) * 0.2)(P, D) * (D ** -0.5)
        C_re = (lambda *s: torch.randn(*s, dtype=torch.bfloat16) * 0.2)(D, P) * (P ** -0.5)
        C_im = (lambda *s: torch.randn(*s, dtype=torch.bfloat16) * 0.2)(D, P) * (P ** -0.5)
        log_dt = (lambda *s: torch.randn(*s, dtype=torch.bfloat16) * 0.2)(P) * 0.3 - 2.0
        Dskip = (lambda *s: torch.randn(*s, dtype=torch.bfloat16) * 0.05)(D)
        return {
            "x": _w((lambda *s: torch.randn(*s, dtype=torch.bfloat16) * 0.05)(B, S, D)),
            "Lambda_re": _w(Lambda_re),
            "Lambda_im": _w(Lambda_im),
            "B_re": _w(B_re),
            "B_im": _w(B_im),
            "C_re": _w(C_re),
            "C_im": _w(C_im),
            "log_dt": _w(log_dt),
            "Dskip": _w(Dskip),
        }
    _A_in = _A_setup()

    def _B_setup():
        B, S, D, F = 1, 2048, 640, 1536
        return {
            "x": _w((lambda *s: torch.randn(*s, dtype=torch.bfloat16) * 0.05)(B, S, D)),
            "w1": _w((lambda *s: torch.randn(*s, dtype=torch.bfloat16) * 0.05)(D, F)),
            "b1": _w((lambda *s: torch.randn(*s, dtype=torch.bfloat16) * 0.4)(F)),
            "w2": _w((lambda *s: torch.randn(*s, dtype=torch.bfloat16) * 0.05)(F, D)),
            "b2": _w((lambda *s: torch.randn(*s, dtype=torch.bfloat16) * 1.6)(D)),
        }
    _B_in = _B_setup()

    return {
        "A_x": _A_in["x"],
        "A_Lambda_re": _A_in["Lambda_re"],
        "A_Lambda_im": _A_in["Lambda_im"],
        "A_B_re": _A_in["B_re"],
        "A_B_im": _A_in["B_im"],
        "A_C_re": _A_in["C_re"],
        "A_C_im": _A_in["C_im"],
        "A_log_dt": _A_in["log_dt"],
        "A_Dskip": _A_in["Dskip"],
        "B_x": _B_in["x"],
        "B_w1": _B_in["w1"],
        "B_b1": _B_in["b1"],
        "B_w2": _B_in["w2"],
        "B_b2": _B_in["b2"],
    }

def reference(A_x, A_Lambda_re, A_Lambda_im, A_B_re, A_B_im, A_C_re, A_C_im, A_log_dt, A_Dskip, B_x, B_w1, B_b1, B_w2, B_b2):
    def _A_ref(x, Lambda_re, Lambda_im, B_re, B_im, C_re, C_im, log_dt, Dskip):
        Bsz, L, H = x.shape
        Lam = Lambda_re + 1j * Lambda_im
        Bmat = B_re + 1j * B_im
        Cmat = C_re + 1j * C_im
        dt = torch.exp(log_dt)
        Lam_bar = torch.exp(dt * Lam)
        B_bar = ((Lam_bar - 1.0) / Lam)[:, None] * Bmat
        Bu = torch.einsum("bld,pd->blp", x + 0j, B_bar)
        h = torch.zeros_like(Bu[:, 0, :])
        hs = []
        for t in range(L):
            h = Lam_bar[None, :] * h + Bu[:, t, :]
            hs.append(h)
        hseq = torch.stack(hs, 1)
        y = 2.0 * torch.einsum("blp,dp->bld", hseq, Cmat).real + x * Dskip[None, None, :]
        return y

    def _B_ref(x, w1, b1, w2, b2):
        h = torch.einsum("bsd,df->bsf", x, w1) + b1
        zero = torch.zeros_like(h)
        r = torch.where(h > zero, h, zero)
        h = r * r
        out = torch.einsum("bsf,fd->bsd", h, w2) + b2
        return out

    x = A_x
    xn = _layernorm(x, axis=-1)
    s = _A_ref(xn, A_Lambda_re, A_Lambda_im, A_B_re, A_B_im, A_C_re, A_C_im, A_log_dt, A_Dskip)
    g = _silu(_B_ref(xn, B_w1, B_b1, B_w2, B_b2))
    return x + s * g
```

```asm
; @launch grid=(256,1,1) block=(512,1,1) lds=163840
.amdgcn_target "amdgcn-amd-amdhsa--gfx950"
.text
.globl recurrent_scan__ssm_conv_s5__dense_activation_squared_relu__prompt_kernel
.p2align 8
.type recurrent_scan__ssm_conv_s5__dense_activation_squared_relu__prompt_kernel,@function
recurrent_scan__ssm_conv_s5__dense_activation_squared_relu__prompt_kernel:

  s_cmp_ge_u32 s2, 256
  s_cbranch_scc1 K1_end
  s_load_dwordx2 s[4:5], s[0:1], 0
  s_load_dwordx2 s[6:7], s[0:1], 24
  s_load_dwordx2 s[8:9], s[0:1], 32
  s_load_dwordx2 s[10:11], s[0:1], 80
  s_load_dwordx2 s[12:13], s[0:1], 128
  s_load_dwordx2 s[14:15], s[0:1], 88
  s_load_dwordx2 s[16:17], s[0:1], 8
  s_load_dwordx2 s[18:19], s[0:1], 16
  s_load_dwordx2 s[20:21], s[0:1], 56
  s_load_dwordx2 s[22:23], s[0:1], 40
  s_load_dwordx2 s[24:25], s[0:1], 48
  s_load_dwordx2 s[26:27], s[0:1], 96

  v_lshrrev_b32 v1, 6, v0
  v_and_b32 v0, 63, v0
  v_readfirstlane_b32 s28, v1
  s_and_b32 s60, s2, 7
  s_lshr_b32 s61, s2, 3
  s_lshr_b32 s62, s61, 3
  s_lshl_b32 s62, s62, 2
  s_lshr_b32 s63, s60, 1
  s_add_u32 s29, s62, s63
  s_and_b32 s62, s60, 1
  s_lshl_b32 s62, s62, 3
  s_and_b32 s63, s61, 7
  s_add_u32 s30, s62, s63

  s_and_b32 s31, s30, 1
  s_lshr_b32 s35, s30, 1
  s_mul_i32 s32, s35, 5
  s_mul_i32 s62, s31, 3
  s_add_u32 s32, s32, s62
  s_mul_i32 s33, s35, 3
  s_add_u32 s33, s33, s31
  s_and_b32 s62, s61, 7
  s_mul_i32 s62, s62, 0
  s_lshr_b32 s63, s61, 3
  s_mul_i32 s63, s63, 0
  s_add_u32 s62, s62, s63
  s_mul_i32 s63, s62, 6554
  s_lshr_b32 s63, s63, 16
  s_mul_i32 s63, s63, 10
  s_sub_u32 s34, s62, s63
  s_waitcnt lgkmcnt(0)

  s_cmp_lt_u32 s28, 4
  s_cbranch_scc1 K1_compute
  s_cmp_eq_u32 s28, 4
  s_cbranch_scc1 K1_ldx
  s_cmp_eq_u32 s28, 5
  s_cbranch_scc1 K1_ldb
  s_cmp_eq_u32 s28, 6
  s_cbranch_scc1 K1_ldw
  s_branch K1_sync

K1_ldx:
  s_mov_b32 s36, s4
  s_and_b32 s37, s5, 0xffff
  s_mov_b32 s38, 2621440
  s_mov_b32 s39, 0x20000

  v_lshrrev_b32 v1, 5, v0
  v_lshlrev_b32 v1, 4, v1
  v_bfe_u32 v2, v0, 3, 1
  v_lshl_add_u32 v1, v2, 3, v1
  v_bfe_u32 v2, v0, 4, 1
  v_add_u32 v1, v1, v2
  s_lshl_b32 s63, s29, 7
  v_add_u32 v1, s63, v1
  v_mul_u32_u24 v1, 1280, v1
  v_and_b32 v2, 7, v0
  v_lshrrev_b32 v3, 4, v0
  v_xor_b32 v2, v2, v3
  v_lshl_add_u32 v4, v2, 4, v1
  v_xor_b32 v2, 4, v2
  v_lshl_add_u32 v5, v2, 4, v1

  s_mov_b32 s44, s12
  s_and_b32 s45, s13, 0xffff
  s_mov_b32 s46, 1048576
  s_mov_b32 s47, 0x20000
  v_lshrrev_b32 v20, 4, v0
  s_lshl_b32 s60, s29, 7
  s_lshl_b32 s61, s30, 3
  s_add_u32 s60, s60, s61
  s_add_u32 s60, s60, 0
  v_add_u32 v20, s60, v20
  v_lshlrev_b32 v21, 4, v20
  v_add_u32 v21, 4096, v21
  v_mul_u32_u24 v20, 1280, v20
  v_and_b32 v22, 15, v0
  v_lshl_add_u32 v20, v22, 4, v20
  buffer_load_dwordx4 v[24:27], v20, s[36:39], 0 offen offset:0
  buffer_load_dwordx4 v[28:31], v20, s[36:39], 0 offen offset:256
  buffer_load_dwordx4 v[32:35], v20, s[36:39], 0 offen offset:512
  buffer_load_dwordx4 v[36:39], v20, s[36:39], 0 offen offset:768
  buffer_load_dwordx4 v[40:43], v20, s[36:39], 0 offen offset:1024
  s_mov_b32 s60, s34
  s_mov_b32 s61, 0
  s_lshl_b32 s63, s60, 7
  s_add_u32 m0, s61, 0
  s_add_u32 s64, s63, 0
  buffer_load_dwordx4 v4, s[36:39], s64 offen  lds
  s_add_u32 m0, s61, 1024
  s_add_u32 s64, s63, 40960
  buffer_load_dwordx4 v5, s[36:39], s64 offen  lds
  s_add_u32 m0, s61, 2048
  s_add_u32 s64, s63, 2560
  buffer_load_dwordx4 v4, s[36:39], s64 offen  lds
  s_add_u32 m0, s61, 3072
  s_add_u32 s64, s63, 43520
  buffer_load_dwordx4 v5, s[36:39], s64 offen  lds
  s_add_u32 m0, s61, 4096
  s_add_u32 s64, s63, 5120
  buffer_load_dwordx4 v4, s[36:39], s64 offen  lds
  s_add_u32 m0, s61, 5120
  s_add_u32 s64, s63, 46080
  buffer_load_dwordx4 v5, s[36:39], s64 offen  lds
  s_add_u32 m0, s61, 6144
  s_add_u32 s64, s63, 7680
  buffer_load_dwordx4 v4, s[36:39], s64 offen  lds
  s_add_u32 m0, s61, 7168
  s_add_u32 s64, s63, 48640
  buffer_load_dwordx4 v5, s[36:39], s64 offen  lds
  s_add_u32 m0, s61, 8192
  s_add_u32 s64, s63, 81920
  buffer_load_dwordx4 v4, s[36:39], s64 offen  lds
  s_add_u32 m0, s61, 9216
  s_add_u32 s64, s63, 122880
  buffer_load_dwordx4 v5, s[36:39], s64 offen  lds
  s_add_u32 m0, s61, 10240
  s_add_u32 s64, s63, 84480
  buffer_load_dwordx4 v4, s[36:39], s64 offen  lds
  s_add_u32 m0, s61, 11264
  s_add_u32 s64, s63, 125440
  buffer_load_dwordx4 v5, s[36:39], s64 offen  lds
  s_add_u32 m0, s61, 12288
  s_add_u32 s64, s63, 87040
  buffer_load_dwordx4 v4, s[36:39], s64 offen  lds
  s_add_u32 m0, s61, 13312
  s_add_u32 s64, s63, 128000
  buffer_load_dwordx4 v5, s[36:39], s64 offen  lds
  s_add_u32 m0, s61, 14336
  s_add_u32 s64, s63, 89600
  buffer_load_dwordx4 v4, s[36:39], s64 offen  lds
  s_add_u32 m0, s61, 15360
  s_add_u32 s64, s63, 130560
  buffer_load_dwordx4 v5, s[36:39], s64 offen  lds
  s_add_u32 s60, s60, 1
  s_cmp_eq_u32 s60, 10
  s_cselect_b32 s60, 0, s60
  s_add_u32 s61, s61, 40960
  s_cmp_eq_u32 s61, 122880
  s_cselect_b32 s61, 0, s61
  s_barrier
  s_waitcnt vmcnt(16)
  v_mov_b32 v23, 122912
  ds_read_b32 v23, v23
  s_waitcnt lgkmcnt(0)
  v_lshlrev_b32 v48, 16, v24
  v_and_b32 v49, 0xffff0000, v24
  v_lshlrev_b32 v50, 16, v25
  v_and_b32 v51, 0xffff0000, v25
  v_lshlrev_b32 v52, 16, v26
  v_and_b32 v53, 0xffff0000, v26
  v_lshlrev_b32 v54, 16, v27
  v_and_b32 v55, 0xffff0000, v27
  v_lshlrev_b32 v56, 16, v28
  v_and_b32 v57, 0xffff0000, v28
  v_lshlrev_b32 v58, 16, v29
  v_and_b32 v59, 0xffff0000, v29
  v_lshlrev_b32 v60, 16, v30
  v_and_b32 v61, 0xffff0000, v30
  v_lshlrev_b32 v62, 16, v31
  v_and_b32 v63, 0xffff0000, v31
  v_lshlrev_b32 v64, 16, v32
  v_and_b32 v65, 0xffff0000, v32
  v_lshlrev_b32 v66, 16, v33
  v_and_b32 v67, 0xffff0000, v33
  v_lshlrev_b32 v68, 16, v34
  v_and_b32 v69, 0xffff0000, v34
  v_lshlrev_b32 v70, 16, v35
  v_and_b32 v71, 0xffff0000, v35
  v_lshlrev_b32 v72, 16, v36
  v_and_b32 v73, 0xffff0000, v36
  v_lshlrev_b32 v74, 16, v37
  v_and_b32 v75, 0xffff0000, v37
  v_lshlrev_b32 v76, 16, v38
  v_and_b32 v77, 0xffff0000, v38
  v_lshlrev_b32 v78, 16, v39
  v_and_b32 v79, 0xffff0000, v39
  v_lshlrev_b32 v80, 16, v40
  v_and_b32 v81, 0xffff0000, v40
  v_lshlrev_b32 v82, 16, v41
  v_and_b32 v83, 0xffff0000, v41
  v_lshlrev_b32 v84, 16, v42
  v_and_b32 v85, 0xffff0000, v42
  v_lshlrev_b32 v86, 16, v43
  v_and_b32 v87, 0xffff0000, v43
  v_add_f32 v88, v48, v52
  v_add_f32 v89, v49, v53
  v_add_f32 v90, v50, v54
  v_add_f32 v91, v51, v55
  v_add_f32 v88, v88, v56
  v_add_f32 v89, v89, v57
  v_add_f32 v90, v90, v58
  v_add_f32 v91, v91, v59
  v_add_f32 v88, v88, v60
  v_add_f32 v89, v89, v61
  v_add_f32 v90, v90, v62
  v_add_f32 v91, v91, v63
  v_add_f32 v88, v88, v64
  v_add_f32 v89, v89, v65
  v_add_f32 v90, v90, v66
  v_add_f32 v91, v91, v67
  v_add_f32 v88, v88, v68
  v_add_f32 v89, v89, v69
  v_add_f32 v90, v90, v70
  v_add_f32 v91, v91, v71
  v_add_f32 v88, v88, v72
  v_add_f32 v89, v89, v73
  v_add_f32 v90, v90, v74
  v_add_f32 v91, v91, v75
  v_add_f32 v88, v88, v76
  v_add_f32 v89, v89, v77
  v_add_f32 v90, v90, v78
  v_add_f32 v91, v91, v79
  v_add_f32 v88, v88, v80
  v_add_f32 v89, v89, v81
  v_add_f32 v90, v90, v82
  v_add_f32 v91, v91, v83
  v_add_f32 v88, v88, v84
  v_add_f32 v89, v89, v85
  v_add_f32 v90, v90, v86
  v_add_f32 v91, v91, v87
  v_add_f32 v88, v88, v89
  v_add_f32 v90, v90, v91
  v_add_f32 v88, v88, v90
  s_nop 1
  v_add_f32_dpp v88, v88, v88 row_ror:8 row_mask:0xf bank_mask:0xf
  s_nop 1
  v_add_f32_dpp v88, v88, v88 row_ror:4 row_mask:0xf bank_mask:0xf
  s_nop 1
  v_add_f32_dpp v88, v88, v88 row_ror:2 row_mask:0xf bank_mask:0xf
  s_nop 1
  v_add_f32_dpp v88, v88, v88 row_ror:1 row_mask:0xf bank_mask:0xf
  s_nop 0
  v_mul_f32 v92, 0.0015625000232830644, v88
  v_sub_f32 v48, v48, v92
  v_sub_f32 v49, v49, v92
  v_sub_f32 v50, v50, v92
  v_sub_f32 v51, v51, v92
  v_sub_f32 v52, v52, v92
  v_sub_f32 v53, v53, v92
  v_sub_f32 v54, v54, v92
  v_sub_f32 v55, v55, v92
  v_sub_f32 v56, v56, v92
  v_sub_f32 v57, v57, v92
  v_sub_f32 v58, v58, v92
  v_sub_f32 v59, v59, v92
  v_sub_f32 v60, v60, v92
  v_sub_f32 v61, v61, v92
  v_sub_f32 v62, v62, v92
  v_sub_f32 v63, v63, v92
  v_sub_f32 v64, v64, v92
  v_sub_f32 v65, v65, v92
  v_sub_f32 v66, v66, v92
  v_sub_f32 v67, v67, v92
  v_sub_f32 v68, v68, v92
  v_sub_f32 v69, v69, v92
  v_sub_f32 v70, v70, v92
  v_sub_f32 v71, v71, v92
  v_sub_f32 v72, v72, v92
  v_sub_f32 v73, v73, v92
  v_sub_f32 v74, v74, v92
  v_sub_f32 v75, v75, v92
  v_sub_f32 v76, v76, v92
  v_sub_f32 v77, v77, v92
  v_sub_f32 v78, v78, v92
  v_sub_f32 v79, v79, v92
  v_sub_f32 v80, v80, v92
  v_sub_f32 v81, v81, v92
  v_sub_f32 v82, v82, v92
  v_sub_f32 v83, v83, v92
  v_sub_f32 v84, v84, v92
  v_sub_f32 v85, v85, v92
  v_sub_f32 v86, v86, v92
  v_sub_f32 v87, v87, v92
  v_mul_f32 v88, v48, v48
  v_mul_f32 v89, v49, v49
  v_mul_f32 v90, v50, v50
  v_mul_f32 v91, v51, v51
  v_fmac_f32 v88, v52, v52
  v_fmac_f32 v89, v53, v53
  v_fmac_f32 v90, v54, v54
  v_fmac_f32 v91, v55, v55
  v_fmac_f32 v88, v56, v56
  v_fmac_f32 v89, v57, v57
  v_fmac_f32 v90, v58, v58
  v_fmac_f32 v91, v59, v59
  v_fmac_f32 v88, v60, v60
  v_fmac_f32 v89, v61, v61
  v_fmac_f32 v90, v62, v62
  v_fmac_f32 v91, v63, v63
  v_fmac_f32 v88, v64, v64
  v_fmac_f32 v89, v65, v65
  v_fmac_f32 v90, v66, v66
  v_fmac_f32 v91, v67, v67
  v_fmac_f32 v88, v68, v68
  v_fmac_f32 v89, v69, v69
  v_fmac_f32 v90, v70, v70
  v_fmac_f32 v91, v71, v71
  v_fmac_f32 v88, v72, v72
  v_fmac_f32 v89, v73, v73
  v_fmac_f32 v90, v74, v74
  v_fmac_f32 v91, v75, v75
  v_fmac_f32 v88, v76, v76
  v_fmac_f32 v89, v77, v77
  v_fmac_f32 v90, v78, v78
  v_fmac_f32 v91, v79, v79
  v_fmac_f32 v88, v80, v80
  v_fmac_f32 v89, v81, v81
  v_fmac_f32 v90, v82, v82
  v_fmac_f32 v91, v83, v83
  v_fmac_f32 v88, v84, v84
  v_fmac_f32 v89, v85, v85
  v_fmac_f32 v90, v86, v86
  v_fmac_f32 v91, v87, v87
  v_add_f32 v88, v88, v89
  v_add_f32 v90, v90, v91
  v_add_f32 v88, v88, v90
  s_nop 1
  v_add_f32_dpp v88, v88, v88 row_ror:8 row_mask:0xf bank_mask:0xf
  s_nop 1
  v_add_f32_dpp v88, v88, v88 row_ror:4 row_mask:0xf bank_mask:0xf
  s_nop 1
  v_add_f32_dpp v88, v88, v88 row_ror:2 row_mask:0xf bank_mask:0xf
  s_nop 1
  v_add_f32_dpp v88, v88, v88 row_ror:1 row_mask:0xf bank_mask:0xf
  s_nop 0
  v_mul_f32 v88, 0.0015625000232830644, v88
  v_cvt_pk_bf16_f32 v96, v92, v92
  v_lshlrev_b32 v96, 16, v96
  v_cvt_pk_bf16_f32 v88, v88, v88
  v_lshlrev_b32 v88, 16, v88
  v_add_f32 v88, 0x3727c5ac, v88
  v_cvt_pk_bf16_f32 v88, v88, v88
  v_lshlrev_b32 v88, 16, v88
  v_sqrt_f32 v88, v88
  s_nop 0
  v_cvt_pk_bf16_f32 v88, v88, v88
  v_lshlrev_b32 v88, 16, v88
  v_rcp_f32 v98, v88
  v_mov_b32 v97, v23
  v_mov_b32 v99, v23
  s_mov_b32 exec_lo, 0x00010001
  s_mov_b32 exec_hi, 0x00010001
  buffer_store_dwordx4 v[96:99], v21, s[44:47], 0 offen sc1
  s_mov_b64 exec, -1
  s_lshl_b32 s63, s60, 7
  s_add_u32 m0, s61, 0
  s_add_u32 s64, s63, 0
  buffer_load_dwordx4 v4, s[36:39], s64 offen  lds
  s_add_u32 m0, s61, 1024
  s_add_u32 s64, s63, 40960
  buffer_load_dwordx4 v5, s[36:39], s64 offen  lds
  s_add_u32 m0, s61, 2048
  s_add_u32 s64, s63, 2560
  buffer_load_dwordx4 v4, s[36:39], s64 offen  lds
  s_add_u32 m0, s61, 3072
  s_add_u32 s64, s63, 43520
  buffer_load_dwordx4 v5, s[36:39], s64 offen  lds
  s_add_u32 m0, s61, 4096
  s_add_u32 s64, s63, 5120
  buffer_load_dwordx4 v4, s[36:39], s64 offen  lds
  s_add_u32 m0, s61, 5120
  s_add_u32 s64, s63, 46080
  buffer_load_dwordx4 v5, s[36:39], s64 offen  lds
  s_add_u32 m0, s61, 6144
  s_add_u32 s64, s63, 7680
  buffer_load_dwordx4 v4, s[36:39], s64 offen  lds
  s_add_u32 m0, s61, 7168
  s_add_u32 s64, s63, 48640
  buffer_load_dwordx4 v5, s[36:39], s64 offen  lds
  s_add_u32 m0, s61, 8192
  s_add_u32 s64, s63, 81920
  buffer_load_dwordx4 v4, s[36:39], s64 offen  lds
  s_add_u32 m0, s61, 9216
  s_add_u32 s64, s63, 122880
  buffer_load_dwordx4 v5, s[36:39], s64 offen  lds
  s_add_u32 m0, s61, 10240
  s_add_u32 s64, s63, 84480
  buffer_load_dwordx4 v4, s[36:39], s64 offen  lds
  s_add_u32 m0, s61, 11264
  s_add_u32 s64, s63, 125440
  buffer_load_dwordx4 v5, s[36:39], s64 offen  lds
  s_add_u32 m0, s61, 12288
  s_add_u32 s64, s63, 87040
  buffer_load_dwordx4 v4, s[36:39], s64 offen  lds
  s_add_u32 m0, s61, 13312
  s_add_u32 s64, s63, 128000
  buffer_load_dwordx4 v5, s[36:39], s64 offen  lds
  s_add_u32 m0, s61, 14336
  s_add_u32 s64, s63, 89600
  buffer_load_dwordx4 v4, s[36:39], s64 offen  lds
  s_add_u32 m0, s61, 15360
  s_add_u32 s64, s63, 130560
  buffer_load_dwordx4 v5, s[36:39], s64 offen  lds
  s_add_u32 s60, s60, 1
  s_cmp_eq_u32 s60, 10
  s_cselect_b32 s60, 0, s60
  s_add_u32 s61, s61, 40960
  s_cmp_eq_u32 s61, 122880
  s_cselect_b32 s61, 0, s61
  s_waitcnt vmcnt(17)
  s_barrier
  s_lshl_b32 s63, s60, 7
  s_add_u32 m0, s61, 0
  s_add_u32 s64, s63, 0
  buffer_load_dwordx4 v4, s[36:39], s64 offen  lds
  s_add_u32 m0, s61, 1024
  s_add_u32 s64, s63, 40960
  buffer_load_dwordx4 v5, s[36:39], s64 offen  lds
  s_add_u32 m0, s61, 2048
  s_add_u32 s64, s63, 2560
  buffer_load_dwordx4 v4, s[36:39], s64 offen  lds
  s_add_u32 m0, s61, 3072
  s_add_u32 s64, s63, 43520
  buffer_load_dwordx4 v5, s[36:39], s64 offen  lds
  s_add_u32 m0, s61, 4096
  s_add_u32 s64, s63, 5120
  buffer_load_dwordx4 v4, s[36:39], s64 offen  lds
  s_add_u32 m0, s61, 5120
  s_add_u32 s64, s63, 46080
  buffer_load_dwordx4 v5, s[36:39], s64 offen  lds
  s_add_u32 m0, s61, 6144
  s_add_u32 s64, s63, 7680
  buffer_load_dwordx4 v4, s[36:39], s64 offen  lds
  s_add_u32 m0, s61, 7168
  s_add_u32 s64, s63, 48640
  buffer_load_dwordx4 v5, s[36:39], s64 offen  lds
  s_add_u32 m0, s61, 8192
  s_add_u32 s64, s63, 81920
  buffer_load_dwordx4 v4, s[36:39], s64 offen  lds
  s_add_u32 m0, s61, 9216
  s_add_u32 s64, s63, 122880
  buffer_load_dwordx4 v5, s[36:39], s64 offen  lds
  s_add_u32 m0, s61, 10240
  s_add_u32 s64, s63, 84480
  buffer_load_dwordx4 v4, s[36:39], s64 offen  lds
  s_add_u32 m0, s61, 11264
  s_add_u32 s64, s63, 125440
  buffer_load_dwordx4 v5, s[36:39], s64 offen  lds
  s_add_u32 m0, s61, 12288
  s_add_u32 s64, s63, 87040
  buffer_load_dwordx4 v4, s[36:39], s64 offen  lds
  s_add_u32 m0, s61, 13312
  s_add_u32 s64, s63, 128000
  buffer_load_dwordx4 v5, s[36:39], s64 offen  lds
  s_add_u32 m0, s61, 14336
  s_add_u32 s64, s63, 89600
  buffer_load_dwordx4 v4, s[36:39], s64 offen  lds
  s_add_u32 m0, s61, 15360
  s_add_u32 s64, s63, 130560
  buffer_load_dwordx4 v5, s[36:39], s64 offen  lds
  s_add_u32 s60, s60, 1
  s_cmp_eq_u32 s60, 10
  s_cselect_b32 s60, 0, s60
  s_add_u32 s61, s61, 40960
  s_cmp_eq_u32 s61, 122880
  s_cselect_b32 s61, 0, s61
  s_waitcnt vmcnt(16)
  s_barrier
  s_lshl_b32 s63, s60, 7
  s_add_u32 m0, s61, 0
  s_add_u32 s64, s63, 0
  buffer_load_dwordx4 v4, s[36:39], s64 offen  lds
  s_add_u32 m0, s61, 1024
  s_add_u32 s64, s63, 40960
  buffer_load_dwordx4 v5, s[36:39], s64 offen  lds
  s_add_u32 m0, s61, 2048
  s_add_u32 s64, s63, 2560
  buffer_load_dwordx4 v4, s[36:39], s64 offen  lds
  s_add_u32 m0, s61, 3072
  s_add_u32 s64, s63, 43520
  buffer_load_dwordx4 v5, s[36:39], s64 offen  lds
  s_add_u32 m0, s61, 4096
  s_add_u32 s64, s63, 5120
  buffer_load_dwordx4 v4, s[36:39], s64 offen  lds
  s_add_u32 m0, s61, 5120
  s_add_u32 s64, s63, 46080
  buffer_load_dwordx4 v5, s[36:39], s64 offen  lds
  s_add_u32 m0, s61, 6144
  s_add_u32 s64, s63, 7680
  buffer_load_dwordx4 v4, s[36:39], s64 offen  lds
  s_add_u32 m0, s61, 7168
  s_add_u32 s64, s63, 48640
  buffer_load_dwordx4 v5, s[36:39], s64 offen  lds
  s_add_u32 m0, s61, 8192
  s_add_u32 s64, s63, 81920
  buffer_load_dwordx4 v4, s[36:39], s64 offen  lds
  s_add_u32 m0, s61, 9216
  s_add_u32 s64, s63, 122880
  buffer_load_dwordx4 v5, s[36:39], s64 offen  lds
  s_add_u32 m0, s61, 10240
  s_add_u32 s64, s63, 84480
  buffer_load_dwordx4 v4, s[36:39], s64 offen  lds
  s_add_u32 m0, s61, 11264
  s_add_u32 s64, s63, 125440
  buffer_load_dwordx4 v5, s[36:39], s64 offen  lds
  s_add_u32 m0, s61, 12288
  s_add_u32 s64, s63, 87040
  buffer_load_dwordx4 v4, s[36:39], s64 offen  lds
  s_add_u32 m0, s61, 13312
  s_add_u32 s64, s63, 128000
  buffer_load_dwordx4 v5, s[36:39], s64 offen  lds
  s_add_u32 m0, s61, 14336
  s_add_u32 s64, s63, 89600
  buffer_load_dwordx4 v4, s[36:39], s64 offen  lds
  s_add_u32 m0, s61, 15360
  s_add_u32 s64, s63, 130560
  buffer_load_dwordx4 v5, s[36:39], s64 offen  lds
  s_add_u32 s60, s60, 1
  s_cmp_eq_u32 s60, 10
  s_cselect_b32 s60, 0, s60
  s_add_u32 s61, s61, 40960
  s_cmp_eq_u32 s61, 122880
  s_cselect_b32 s61, 0, s61
  s_waitcnt vmcnt(16)
  s_barrier
  s_lshl_b32 s63, s60, 7
  s_add_u32 m0, s61, 0
  s_add_u32 s64, s63, 0
  buffer_load_dwordx4 v4, s[36:39], s64 offen  lds
  s_add_u32 m0, s61, 1024
  s_add_u32 s64, s63, 40960
  buffer_load_dwordx4 v5, s[36:39], s64 offen  lds
  s_add_u32 m0, s61, 2048
  s_add_u32 s64, s63, 2560
  buffer_load_dwordx4 v4, s[36:39], s64 offen  lds
  s_add_u32 m0, s61, 3072
  s_add_u32 s64, s63, 43520
  buffer_load_dwordx4 v5, s[36:39], s64 offen  lds
  s_add_u32 m0, s61, 4096
  s_add_u32 s64, s63, 5120
  buffer_load_dwordx4 v4, s[36:39], s64 offen  lds
  s_add_u32 m0, s61, 5120
  s_add_u32 s64, s63, 46080
  buffer_load_dwordx4 v5, s[36:39], s64 offen  lds
  s_add_u32 m0, s61, 6144
  s_add_u32 s64, s63, 7680
  buffer_load_dwordx4 v4, s[36:39], s64 offen  lds
  s_add_u32 m0, s61, 7168
  s_add_u32 s64, s63, 48640
  buffer_load_dwordx4 v5, s[36:39], s64 offen  lds
  s_add_u32 m0, s61, 8192
  s_add_u32 s64, s63, 81920
  buffer_load_dwordx4 v4, s[36:39], s64 offen  lds
  s_add_u32 m0, s61, 9216
  s_add_u32 s64, s63, 122880
  buffer_load_dwordx4 v5, s[36:39], s64 offen  lds
  s_add_u32 m0, s61, 10240
  s_add_u32 s64, s63, 84480
  buffer_load_dwordx4 v4, s[36:39], s64 offen  lds
  s_add_u32 m0, s61, 11264
  s_add_u32 s64, s63, 125440
  buffer_load_dwordx4 v5, s[36:39], s64 offen  lds
  s_add_u32 m0, s61, 12288
  s_add_u32 s64, s63, 87040
  buffer_load_dwordx4 v4, s[36:39], s64 offen  lds
  s_add_u32 m0, s61, 13312
  s_add_u32 s64, s63, 128000
  buffer_load_dwordx4 v5, s[36:39], s64 offen  lds
  s_add_u32 m0, s61, 14336
  s_add_u32 s64, s63, 89600
  buffer_load_dwordx4 v4, s[36:39], s64 offen  lds
  s_add_u32 m0, s61, 15360
  s_add_u32 s64, s63, 130560
  buffer_load_dwordx4 v5, s[36:39], s64 offen  lds
  s_add_u32 s60, s60, 1
  s_cmp_eq_u32 s60, 10
  s_cselect_b32 s60, 0, s60
  s_add_u32 s61, s61, 40960
  s_cmp_eq_u32 s61, 122880
  s_cselect_b32 s61, 0, s61
  s_waitcnt vmcnt(16)
  s_barrier
  s_lshl_b32 s63, s60, 7
  s_add_u32 m0, s61, 0
  s_add_u32 s64, s63, 0
  buffer_load_dwordx4 v4, s[36:39], s64 offen  lds
  s_add_u32 m0, s61, 1024
  s_add_u32 s64, s63, 40960
  buffer_load_dwordx4 v5, s[36:39], s64 offen  lds
  s_add_u32 m0, s61, 2048
  s_add_u32 s64, s63, 2560
  buffer_load_dwordx4 v4, s[36:39], s64 offen  lds
  s_add_u32 m0, s61, 3072
  s_add_u32 s64, s63, 43520
  buffer_load_dwordx4 v5, s[36:39], s64 offen  lds
  s_add_u32 m0, s61, 4096
  s_add_u32 s64, s63, 5120
  buffer_load_dwordx4 v4, s[36:39], s64 offen  lds
  s_add_u32 m0, s61, 5120
  s_add_u32 s64, s63, 46080
  buffer_load_dwordx4 v5, s[36:39], s64 offen  lds
  s_add_u32 m0, s61, 6144
  s_add_u32 s64, s63, 7680
  buffer_load_dwordx4 v4, s[36:39], s64 offen  lds
  s_add_u32 m0, s61, 7168
  s_add_u32 s64, s63, 48640
  buffer_load_dwordx4 v5, s[36:39], s64 offen  lds
  s_add_u32 m0, s61, 8192
  s_add_u32 s64, s63, 81920
  buffer_load_dwordx4 v4, s[36:39], s64 offen  lds
  s_add_u32 m0, s61, 9216
  s_add_u32 s64, s63, 122880
  buffer_load_dwordx4 v5, s[36:39], s64 offen  lds
  s_add_u32 m0, s61, 10240
  s_add_u32 s64, s63, 84480
  buffer_load_dwordx4 v4, s[36:39], s64 offen  lds
  s_add_u32 m0, s61, 11264
  s_add_u32 s64, s63, 125440
  buffer_load_dwordx4 v5, s[36:39], s64 offen  lds
  s_add_u32 m0, s61, 12288
  s_add_u32 s64, s63, 87040
  buffer_load_dwordx4 v4, s[36:39], s64 offen  lds
  s_add_u32 m0, s61, 13312
  s_add_u32 s64, s63, 128000
  buffer_load_dwordx4 v5, s[36:39], s64 offen  lds
  s_add_u32 m0, s61, 14336
  s_add_u32 s64, s63, 89600
  buffer_load_dwordx4 v4, s[36:39], s64 offen  lds
  s_add_u32 m0, s61, 15360
  s_add_u32 s64, s63, 130560
  buffer_load_dwordx4 v5, s[36:39], s64 offen  lds
  s_add_u32 s60, s60, 1
  s_cmp_eq_u32 s60, 10
  s_cselect_b32 s60, 0, s60
  s_add_u32 s61, s61, 40960
  s_cmp_eq_u32 s61, 122880
  s_cselect_b32 s61, 0, s61
  s_waitcnt vmcnt(16)
  s_barrier
  s_lshl_b32 s63, s60, 7
  s_add_u32 m0, s61, 0
  s_add_u32 s64, s63, 0
  buffer_load_dwordx4 v4, s[36:39], s64 offen  lds
  s_add_u32 m0, s61, 1024
  s_add_u32 s64, s63, 40960
  buffer_load_dwordx4 v5, s[36:39], s64 offen  lds
  s_add_u32 m0, s61, 2048
  s_add_u32 s64, s63, 2560
  buffer_load_dwordx4 v4, s[36:39], s64 offen  lds
  s_add_u32 m0, s61, 3072
  s_add_u32 s64, s63, 43520
  buffer_load_dwordx4 v5, s[36:39], s64 offen  lds
  s_add_u32 m0, s61, 4096
  s_add_u32 s64, s63, 5120
  buffer_load_dwordx4 v4, s[36:39], s64 offen  lds
  s_add_u32 m0, s61, 5120
  s_add_u32 s64, s63, 46080
  buffer_load_dwordx4 v5, s[36:39], s64 offen  lds
  s_add_u32 m0, s61, 6144
  s_add_u32 s64, s63, 7680
  buffer_load_dwordx4 v4, s[36:39], s64 offen  lds
  s_add_u32 m0, s61, 7168
  s_add_u32 s64, s63, 48640
  buffer_load_dwordx4 v5, s[36:39], s64 offen  lds
  s_add_u32 m0, s61, 8192
  s_add_u32 s64, s63, 81920
  buffer_load_dwordx4 v4, s[36:39], s64 offen  lds
  s_add_u32 m0, s61, 9216
  s_add_u32 s64, s63, 122880
  buffer_load_dwordx4 v5, s[36:39], s64 offen  lds
  s_add_u32 m0, s61, 10240
  s_add_u32 s64, s63, 84480
  buffer_load_dwordx4 v4, s[36:39], s64 offen  lds
  s_add_u32 m0, s61, 11264
  s_add_u32 s64, s63, 125440
  buffer_load_dwordx4 v5, s[36:39], s64 offen  lds
  s_add_u32 m0, s61, 12288
  s_add_u32 s64, s63, 87040
  buffer_load_dwordx4 v4, s[36:39], s64 offen  lds
  s_add_u32 m0, s61, 13312
  s_add_u32 s64, s63, 128000
  buffer_load_dwordx4 v5, s[36:39], s64 offen  lds
  s_add_u32 m0, s61, 14336
  s_add_u32 s64, s63, 89600
  buffer_load_dwordx4 v4, s[36:39], s64 offen  lds
  s_add_u32 m0, s61, 15360
  s_add_u32 s64, s63, 130560
  buffer_load_dwordx4 v5, s[36:39], s64 offen  lds
  s_add_u32 s60, s60, 1
  s_cmp_eq_u32 s60, 10
  s_cselect_b32 s60, 0, s60
  s_add_u32 s61, s61, 40960
  s_cmp_eq_u32 s61, 122880
  s_cselect_b32 s61, 0, s61
  s_waitcnt vmcnt(16)
  s_barrier
  s_lshl_b32 s63, s60, 7
  s_add_u32 m0, s61, 0
  s_add_u32 s64, s63, 0
  buffer_load_dwordx4 v4, s[36:39], s64 offen  lds
  s_add_u32 m0, s61, 1024
  s_add_u32 s64, s63, 40960
  buffer_load_dwordx4 v5, s[36:39], s64 offen  lds
  s_add_u32 m0, s61, 2048
  s_add_u32 s64, s63, 2560
  buffer_load_dwordx4 v4, s[36:39], s64 offen  lds
  s_add_u32 m0, s61, 3072
  s_add_u32 s64, s63, 43520
  buffer_load_dwordx4 v5, s[36:39], s64 offen  lds
  s_add_u32 m0, s61, 4096
  s_add_u32 s64, s63, 5120
  buffer_load_dwordx4 v4, s[36:39], s64 offen  lds
  s_add_u32 m0, s61, 5120
  s_add_u32 s64, s63, 46080
  buffer_load_dwordx4 v5, s[36:39], s64 offen  lds
  s_add_u32 m0, s61, 6144
  s_add_u32 s64, s63, 7680
  buffer_load_dwordx4 v4, s[36:39], s64 offen  lds
  s_add_u32 m0, s61, 7168
  s_add_u32 s64, s63, 48640
  buffer_load_dwordx4 v5, s[36:39], s64 offen  lds
  s_add_u32 m0, s61, 8192
  s_add_u32 s64, s63, 81920
  buffer_load_dwordx4 v4, s[36:39], s64 offen  lds
  s_add_u32 m0, s61, 9216
  s_add_u32 s64, s63, 122880
  buffer_load_dwordx4 v5, s[36:39], s64 offen  lds
  s_add_u32 m0, s61, 10240
  s_add_u32 s64, s63, 84480
  buffer_load_dwordx4 v4, s[36:39], s64 offen  lds
  s_add_u32 m0, s61, 11264
  s_add_u32 s64, s63, 125440
  buffer_load_dwordx4 v5, s[36:39], s64 offen  lds
  s_add_u32 m0, s61, 12288
  s_add_u32 s64, s63, 87040
  buffer_load_dwordx4 v4, s[36:39], s64 offen  lds
  s_add_u32 m0, s61, 13312
  s_add_u32 s64, s63, 128000
  buffer_load_dwordx4 v5, s[36:39], s64 offen  lds
  s_add_u32 m0, s61, 14336
  s_add_u32 s64, s63, 89600
  buffer_load_dwordx4 v4, s[36:39], s64 offen  lds
  s_add_u32 m0, s61, 15360
  s_add_u32 s64, s63, 130560
  buffer_load_dwordx4 v5, s[36:39], s64 offen  lds
  s_add_u32 s60, s60, 1
  s_cmp_eq_u32 s60, 10
  s_cselect_b32 s60, 0, s60
  s_add_u32 s61, s61, 40960
  s_cmp_eq_u32 s61, 122880
  s_cselect_b32 s61, 0, s61
  s_waitcnt vmcnt(16)
  s_barrier
  s_lshl_b32 s63, s60, 7
  s_add_u32 m0, s61, 0
  s_add_u32 s64, s63, 0
  buffer_load_dwordx4 v4, s[36:39], s64 offen  lds
  s_add_u32 m0, s61, 1024
  s_add_u32 s64, s63, 40960
  buffer_load_dwordx4 v5, s[36:39], s64 offen  lds
  s_add_u32 m0, s61, 2048
  s_add_u32 s64, s63, 2560
  buffer_load_dwordx4 v4, s[36:39], s64 offen  lds
  s_add_u32 m0, s61, 3072
  s_add_u32 s64, s63, 43520
  buffer_load_dwordx4 v5, s[36:39], s64 offen  lds
  s_add_u32 m0, s61, 4096
  s_add_u32 s64, s63, 5120
  buffer_load_dwordx4 v4, s[36:39], s64 offen  lds
  s_add_u32 m0, s61, 5120
  s_add_u32 s64, s63, 46080
  buffer_load_dwordx4 v5, s[36:39], s64 offen  lds
  s_add_u32 m0, s61, 6144
  s_add_u32 s64, s63, 7680
  buffer_load_dwordx4 v4, s[36:39], s64 offen  lds
  s_add_u32 m0, s61, 7168
  s_add_u32 s64, s63, 48640
  buffer_load_dwordx4 v5, s[36:39], s64 offen  lds
  s_add_u32 m0, s61, 8192
  s_add_u32 s64, s63, 81920
  buffer_load_dwordx4 v4, s[36:39], s64 offen  lds
  s_add_u32 m0, s61, 9216
  s_add_u32 s64, s63, 122880
  buffer_load_dwordx4 v5, s[36:39], s64 offen  lds
  s_add_u32 m0, s61, 10240
  s_add_u32 s64, s63, 84480
  buffer_load_dwordx4 v4, s[36:39], s64 offen  lds
  s_add_u32 m0, s61, 11264
  s_add_u32 s64, s63, 125440
  buffer_load_dwordx4 v5, s[36:39], s64 offen  lds
  s_add_u32 m0, s61, 12288
  s_add_u32 s64, s63, 87040
  buffer_load_dwordx4 v4, s[36:39], s64 offen  lds
  s_add_u32 m0, s61, 13312
  s_add_u32 s64, s63, 128000
  buffer_load_dwordx4 v5, s[36:39], s64 offen  lds
  s_add_u32 m0, s61, 14336
  s_add_u32 s64, s63, 89600
  buffer_load_dwordx4 v4, s[36:39], s64 offen  lds
  s_add_u32 m0, s61, 15360
  s_add_u32 s64, s63, 130560
  buffer_load_dwordx4 v5, s[36:39], s64 offen  lds
  s_add_u32 s60, s60, 1
  s_cmp_eq_u32 s60, 10
  s_cselect_b32 s60, 0, s60
  s_add_u32 s61, s61, 40960
  s_cmp_eq_u32 s61, 122880
  s_cselect_b32 s61, 0, s61
  s_waitcnt vmcnt(16)
  s_barrier
  s_lshl_b32 s63, s60, 7
  s_add_u32 m0, s61, 0
  s_add_u32 s64, s63, 0
  buffer_load_dwordx4 v4, s[36:39], s64 offen  lds
  s_add_u32 m0, s61, 1024
  s_add_u32 s64, s63, 40960
  buffer_load_dwordx4 v5, s[36:39], s64 offen  lds
  s_add_u32 m0, s61, 2048
  s_add_u32 s64, s63, 2560
  buffer_load_dwordx4 v4, s[36:39], s64 offen  lds
  s_add_u32 m0, s61, 3072
  s_add_u32 s64, s63, 43520
  buffer_load_dwordx4 v5, s[36:39], s64 offen  lds
  s_add_u32 m0, s61, 4096
  s_add_u32 s64, s63, 5120
  buffer_load_dwordx4 v4, s[36:39], s64 offen  lds
  s_add_u32 m0, s61, 5120
  s_add_u32 s64, s63, 46080
  buffer_load_dwordx4 v5, s[36:39], s64 offen  lds
  s_add_u32 m0, s61, 6144
  s_add_u32 s64, s63, 7680
  buffer_load_dwordx4 v4, s[36:39], s64 offen  lds
  s_add_u32 m0, s61, 7168
  s_add_u32 s64, s63, 48640
  buffer_load_dwordx4 v5, s[36:39], s64 offen  lds
  s_add_u32 m0, s61, 8192
  s_add_u32 s64, s63, 81920
  buffer_load_dwordx4 v4, s[36:39], s64 offen  lds
  s_add_u32 m0, s61, 9216
  s_add_u32 s64, s63, 122880
  buffer_load_dwordx4 v5, s[36:39], s64 offen  lds
  s_add_u32 m0, s61, 10240
  s_add_u32 s64, s63, 84480
  buffer_load_dwordx4 v4, s[36:39], s64 offen  lds
  s_add_u32 m0, s61, 11264
  s_add_u32 s64, s63, 125440
  buffer_load_dwordx4 v5, s[36:39], s64 offen  lds
  s_add_u32 m0, s61, 12288
  s_add_u32 s64, s63, 87040
  buffer_load_dwordx4 v4, s[36:39], s64 offen  lds
  s_add_u32 m0, s61, 13312
  s_add_u32 s64, s63, 128000
  buffer_load_dwordx4 v5, s[36:39], s64 offen  lds
  s_add_u32 m0, s61, 14336
  s_add_u32 s64, s63, 89600
  buffer_load_dwordx4 v4, s[36:39], s64 offen  lds
  s_add_u32 m0, s61, 15360
  s_add_u32 s64, s63, 130560
  buffer_load_dwordx4 v5, s[36:39], s64 offen  lds
  s_add_u32 s60, s60, 1
  s_cmp_eq_u32 s60, 10
  s_cselect_b32 s60, 0, s60
  s_add_u32 s61, s61, 40960
  s_cmp_eq_u32 s61, 122880
  s_cselect_b32 s61, 0, s61
  s_waitcnt vmcnt(16)
  s_barrier
  s_waitcnt vmcnt(0)
  s_barrier
  s_barrier
  s_branch K2_loader
K1_ldb:
  s_mov_b32 s36, s6
  s_and_b32 s37, s7, 0xffff
  s_mov_b32 s38, 819200
  s_mov_b32 s39, 0x20000
  s_mov_b32 s40, s8
  s_and_b32 s41, s9, 0xffff
  s_mov_b32 s42, 819200
  s_mov_b32 s43, 0x20000

  v_lshrrev_b32 v1, 3, v0
  s_lshl_b32 s63, s32, 4
  v_add_u32 v1, s63, v1
  v_mul_u32_u24 v1, 1280, v1
  v_and_b32 v2, 7, v0
  v_lshrrev_b32 v3, 4, v0
  v_xor_b32 v2, v2, v3
  v_lshl_add_u32 v4, v2, 4, v1
  v_xor_b32 v2, 4, v2
  v_lshl_add_u32 v5, v2, 4, v1

  s_mov_b32 s44, s12
  s_and_b32 s45, s13, 0xffff
  s_mov_b32 s46, 1048576
  s_mov_b32 s47, 0x20000
  s_cmp_eq_u32 s31, 1
  s_cbranch_scc1 K1_ldbY
  v_lshrrev_b32 v20, 4, v0
  v_min_u32 v20, 2, v20
  s_mul_i32 s60, s29, 3
  s_lshl_b32 s61, s32, 4
  s_add_u32 s60, s60, s61
  v_add_u32 v20, s60, v20
  v_lshlrev_b32 v21, 4, v20
  v_add_u32 v21, 36864, v21
  v_mul_u32_u24 v20, 1280, v20
  v_and_b32 v22, 15, v0
  v_lshl_add_u32 v20, v22, 4, v20
  buffer_load_dwordx4 v[24:27], v20, s[36:39], 0 offen offset:0
  buffer_load_dwordx4 v[28:31], v20, s[36:39], 0 offen offset:256
  buffer_load_dwordx4 v[32:35], v20, s[36:39], 0 offen offset:512
  buffer_load_dwordx4 v[36:39], v20, s[36:39], 0 offen offset:768
  buffer_load_dwordx4 v[40:43], v20, s[36:39], 0 offen offset:1024
  buffer_load_dwordx4 v[44:47], v20, s[40:43], 0 offen offset:0
  buffer_load_dwordx4 v[48:51], v20, s[40:43], 0 offen offset:256
  buffer_load_dwordx4 v[52:55], v20, s[40:43], 0 offen offset:512
  buffer_load_dwordx4 v[56:59], v20, s[40:43], 0 offen offset:768
  buffer_load_dwordx4 v[60:63], v20, s[40:43], 0 offen offset:1024
  s_mov_b32 s60, s34
  s_mov_b32 s61, 0
  s_lshl_b32 s63, s60, 7
  s_add_u32 m0, s61, 16384
  s_add_u32 s64, s63, 0
  buffer_load_dwordx4 v4, s[36:39], s64 offen  lds
  s_add_u32 m0, s61, 17408
  s_add_u32 s64, s63, 10240
  buffer_load_dwordx4 v5, s[36:39], s64 offen  lds
  s_add_u32 m0, s61, 18432
  s_add_u32 s64, s63, 0
  buffer_load_dwordx4 v4, s[40:43], s64 offen  lds
  s_add_u32 m0, s61, 19456
  s_add_u32 s64, s63, 10240
  buffer_load_dwordx4 v5, s[40:43], s64 offen  lds
  s_add_u32 m0, s61, 20480
  s_add_u32 s64, s63, 20480
  buffer_load_dwordx4 v4, s[36:39], s64 offen  lds
  s_add_u32 m0, s61, 21504
  s_add_u32 s64, s63, 30720
  buffer_load_dwordx4 v5, s[36:39], s64 offen  lds
  s_add_u32 m0, s61, 22528
  s_add_u32 s64, s63, 20480
  buffer_load_dwordx4 v4, s[40:43], s64 offen  lds
  s_add_u32 m0, s61, 23552
  s_add_u32 s64, s63, 30720
  buffer_load_dwordx4 v5, s[40:43], s64 offen  lds
  s_add_u32 m0, s61, 24576
  s_add_u32 s64, s63, 40960
  buffer_load_dwordx4 v4, s[36:39], s64 offen  lds
  s_add_u32 m0, s61, 25600
  s_add_u32 s64, s63, 51200
  buffer_load_dwordx4 v5, s[36:39], s64 offen  lds
  s_add_u32 m0, s61, 26624
  s_add_u32 s64, s63, 40960
  buffer_load_dwordx4 v4, s[40:43], s64 offen  lds
  s_add_u32 m0, s61, 27648
  s_add_u32 s64, s63, 51200
  buffer_load_dwordx4 v5, s[40:43], s64 offen  lds
  s_add_u32 s60, s60, 1
  s_cmp_eq_u32 s60, 10
  s_cselect_b32 s60, 0, s60
  s_add_u32 s61, s61, 40960
  s_cmp_eq_u32 s61, 122880
  s_cselect_b32 s61, 0, s61
  s_barrier
  s_waitcnt vmcnt(12)
  v_mov_b32 v23, 122912
  ds_read_b32 v23, v23
  s_waitcnt lgkmcnt(0)
  v_lshlrev_b32 v64, 16, v24
  v_and_b32 v65, 0xffff0000, v24
  v_lshlrev_b32 v66, 16, v25
  v_and_b32 v67, 0xffff0000, v25
  v_add_f32 v64, v64, v66
  v_add_f32 v65, v65, v67
  v_lshlrev_b32 v66, 16, v26
  v_and_b32 v67, 0xffff0000, v26
  v_add_f32 v64, v64, v66
  v_add_f32 v65, v65, v67
  v_lshlrev_b32 v66, 16, v27
  v_and_b32 v67, 0xffff0000, v27
  v_add_f32 v64, v64, v66
  v_add_f32 v65, v65, v67
  v_lshlrev_b32 v66, 16, v28
  v_and_b32 v67, 0xffff0000, v28
  v_add_f32 v64, v64, v66
  v_add_f32 v65, v65, v67
  v_lshlrev_b32 v66, 16, v29
  v_and_b32 v67, 0xffff0000, v29
  v_add_f32 v64, v64, v66
  v_add_f32 v65, v65, v67
  v_lshlrev_b32 v66, 16, v30
  v_and_b32 v67, 0xffff0000, v30
  v_add_f32 v64, v64, v66
  v_add_f32 v65, v65, v67
  v_lshlrev_b32 v66, 16, v31
  v_and_b32 v67, 0xffff0000, v31
  v_add_f32 v64, v64, v66
  v_add_f32 v65, v65, v67
  v_lshlrev_b32 v66, 16, v32
  v_and_b32 v67, 0xffff0000, v32
  v_add_f32 v64, v64, v66
  v_add_f32 v65, v65, v67
  v_lshlrev_b32 v66, 16, v33
  v_and_b32 v67, 0xffff0000, v33
  v_add_f32 v64, v64, v66
  v_add_f32 v65, v65, v67
  v_lshlrev_b32 v66, 16, v34
  v_and_b32 v67, 0xffff0000, v34
  v_add_f32 v64, v64, v66
  v_add_f32 v65, v65, v67
  v_lshlrev_b32 v66, 16, v35
  v_and_b32 v67, 0xffff0000, v35
  v_add_f32 v64, v64, v66
  v_add_f32 v65, v65, v67
  v_lshlrev_b32 v66, 16, v36
  v_and_b32 v67, 0xffff0000, v36
  v_add_f32 v64, v64, v66
  v_add_f32 v65, v65, v67
  v_lshlrev_b32 v66, 16, v37
  v_and_b32 v67, 0xffff0000, v37
  v_add_f32 v64, v64, v66
  v_add_f32 v65, v65, v67
  v_lshlrev_b32 v66, 16, v38
  v_and_b32 v67, 0xffff0000, v38
  v_add_f32 v64, v64, v66
  v_add_f32 v65, v65, v67
  v_lshlrev_b32 v66, 16, v39
  v_and_b32 v67, 0xffff0000, v39
  v_add_f32 v64, v64, v66
  v_add_f32 v65, v65, v67
  v_lshlrev_b32 v66, 16, v40
  v_and_b32 v67, 0xffff0000, v40
  v_add_f32 v64, v64, v66
  v_add_f32 v65, v65, v67
  v_lshlrev_b32 v66, 16, v41
  v_and_b32 v67, 0xffff0000, v41
  v_add_f32 v64, v64, v66
  v_add_f32 v65, v65, v67
  v_lshlrev_b32 v66, 16, v42
  v_and_b32 v67, 0xffff0000, v42
  v_add_f32 v64, v64, v66
  v_add_f32 v65, v65, v67
  v_lshlrev_b32 v66, 16, v43
  v_and_b32 v67, 0xffff0000, v43
  v_add_f32 v64, v64, v66
  v_add_f32 v65, v65, v67
  v_add_f32 v64, v64, v65
  v_lshlrev_b32 v66, 16, v44
  v_and_b32 v67, 0xffff0000, v44
  v_lshlrev_b32 v68, 16, v45
  v_and_b32 v69, 0xffff0000, v45
  v_add_f32 v66, v66, v68
  v_add_f32 v67, v67, v69
  v_lshlrev_b32 v68, 16, v46
  v_and_b32 v69, 0xffff0000, v46
  v_add_f32 v66, v66, v68
  v_add_f32 v67, v67, v69
  v_lshlrev_b32 v68, 16, v47
  v_and_b32 v69, 0xffff0000, v47
  v_add_f32 v66, v66, v68
  v_add_f32 v67, v67, v69
  v_lshlrev_b32 v68, 16, v48
  v_and_b32 v69, 0xffff0000, v48
  v_add_f32 v66, v66, v68
  v_add_f32 v67, v67, v69
  v_lshlrev_b32 v68, 16, v49
  v_and_b32 v69, 0xffff0000, v49
  v_add_f32 v66, v66, v68
  v_add_f32 v67, v67, v69
  v_lshlrev_b32 v68, 16, v50
  v_and_b32 v69, 0xffff0000, v50
  v_add_f32 v66, v66, v68
  v_add_f32 v67, v67, v69
  v_lshlrev_b32 v68, 16, v51
  v_and_b32 v69, 0xffff0000, v51
  v_add_f32 v66, v66, v68
  v_add_f32 v67, v67, v69
  v_lshlrev_b32 v68, 16, v52
  v_and_b32 v69, 0xffff0000, v52
  v_add_f32 v66, v66, v68
  v_add_f32 v67, v67, v69
  v_lshlrev_b32 v68, 16, v53
  v_and_b32 v69, 0xffff0000, v53
  v_add_f32 v66, v66, v68
  v_add_f32 v67, v67, v69
  v_lshlrev_b32 v68, 16, v54
  v_and_b32 v69, 0xffff0000, v54
  v_add_f32 v66, v66, v68
  v_add_f32 v67, v67, v69
  v_lshlrev_b32 v68, 16, v55
  v_and_b32 v69, 0xffff0000, v55
  v_add_f32 v66, v66, v68
  v_add_f32 v67, v67, v69
  v_lshlrev_b32 v68, 16, v56
  v_and_b32 v69, 0xffff0000, v56
  v_add_f32 v66, v66, v68
  v_add_f32 v67, v67, v69
  v_lshlrev_b32 v68, 16, v57
  v_and_b32 v69, 0xffff0000, v57
  v_add_f32 v66, v66, v68
  v_add_f32 v67, v67, v69
  v_lshlrev_b32 v68, 16, v58
  v_and_b32 v69, 0xffff0000, v58
  v_add_f32 v66, v66, v68
  v_add_f32 v67, v67, v69
  v_lshlrev_b32 v68, 16, v59
  v_and_b32 v69, 0xffff0000, v59
  v_add_f32 v66, v66, v68
  v_add_f32 v67, v67, v69
  v_lshlrev_b32 v68, 16, v60
  v_and_b32 v69, 0xffff0000, v60
  v_add_f32 v66, v66, v68
  v_add_f32 v67, v67, v69
  v_lshlrev_b32 v68, 16, v61
  v_and_b32 v69, 0xffff0000, v61
  v_add_f32 v66, v66, v68
  v_add_f32 v67, v67, v69
  v_lshlrev_b32 v68, 16, v62
  v_and_b32 v69, 0xffff0000, v62
  v_add_f32 v66, v66, v68
  v_add_f32 v67, v67, v69
  v_lshlrev_b32 v68, 16, v63
  v_and_b32 v69, 0xffff0000, v63
  v_add_f32 v66, v66, v68
  v_add_f32 v67, v67, v69
  v_add_f32 v66, v66, v67
  s_nop 1
  v_add_f32_dpp v64, v64, v64 row_ror:8 row_mask:0xf bank_mask:0xf
  v_add_f32_dpp v66, v66, v66 row_ror:8 row_mask:0xf bank_mask:0xf
  s_nop 1
  v_add_f32_dpp v64, v64, v64 row_ror:4 row_mask:0xf bank_mask:0xf
  v_add_f32_dpp v66, v66, v66 row_ror:4 row_mask:0xf bank_mask:0xf
  s_nop 1
  v_add_f32_dpp v64, v64, v64 row_ror:2 row_mask:0xf bank_mask:0xf
  v_add_f32_dpp v66, v66, v66 row_ror:2 row_mask:0xf bank_mask:0xf
  s_nop 1
  v_add_f32_dpp v64, v64, v64 row_ror:1 row_mask:0xf bank_mask:0xf
  v_add_f32_dpp v66, v66, v66 row_ror:1 row_mask:0xf bank_mask:0xf
  s_nop 0
  v_mov_b32 v65, v23
  v_mov_b32 v67, v23
  s_mov_b32 exec_lo, 0x00010001
  s_mov_b32 exec_hi, 1
  buffer_store_dwordx4 v[64:67], v21, s[44:47], 0 offen sc1
  s_mov_b64 exec, -1
  s_lshl_b32 s63, s60, 7
  s_add_u32 m0, s61, 16384
  s_add_u32 s64, s63, 0
  buffer_load_dwordx4 v4, s[36:39], s64 offen  lds
  s_add_u32 m0, s61, 17408
  s_add_u32 s64, s63, 10240
  buffer_load_dwordx4 v5, s[36:39], s64 offen  lds
  s_add_u32 m0, s61, 18432
  s_add_u32 s64, s63, 0
  buffer_load_dwordx4 v4, s[40:43], s64 offen  lds
  s_add_u32 m0, s61, 19456
  s_add_u32 s64, s63, 10240
  buffer_load_dwordx4 v5, s[40:43], s64 offen  lds
  s_add_u32 m0, s61, 20480
  s_add_u32 s64, s63, 20480
  buffer_load_dwordx4 v4, s[36:39], s64 offen  lds
  s_add_u32 m0, s61, 21504
  s_add_u32 s64, s63, 30720
  buffer_load_dwordx4 v5, s[36:39], s64 offen  lds
  s_add_u32 m0, s61, 22528
  s_add_u32 s64, s63, 20480
  buffer_load_dwordx4 v4, s[40:43], s64 offen  lds
  s_add_u32 m0, s61, 23552
  s_add_u32 s64, s63, 30720
  buffer_load_dwordx4 v5, s[40:43], s64 offen  lds
  s_add_u32 m0, s61, 24576
  s_add_u32 s64, s63, 40960
  buffer_load_dwordx4 v4, s[36:39], s64 offen  lds
  s_add_u32 m0, s61, 25600
  s_add_u32 s64, s63, 51200
  buffer_load_dwordx4 v5, s[36:39], s64 offen  lds
  s_add_u32 m0, s61, 26624
  s_add_u32 s64, s63, 40960
  buffer_load_dwordx4 v4, s[40:43], s64 offen  lds
  s_add_u32 m0, s61, 27648
  s_add_u32 s64, s63, 51200
  buffer_load_dwordx4 v5, s[40:43], s64 offen  lds
  s_add_u32 s60, s60, 1
  s_cmp_eq_u32 s60, 10
  s_cselect_b32 s60, 0, s60
  s_add_u32 s61, s61, 40960
  s_cmp_eq_u32 s61, 122880
  s_cselect_b32 s61, 0, s61
  s_waitcnt vmcnt(13)
  s_barrier
  s_lshl_b32 s63, s60, 7
  s_add_u32 m0, s61, 16384
  s_add_u32 s64, s63, 0
  buffer_load_dwordx4 v4, s[36:39], s64 offen  lds
  s_add_u32 m0, s61, 17408
  s_add_u32 s64, s63, 10240
  buffer_load_dwordx4 v5, s[36:39], s64 offen  lds
  s_add_u32 m0, s61, 18432
  s_add_u32 s64, s63, 0
  buffer_load_dwordx4 v4, s[40:43], s64 offen  lds
  s_add_u32 m0, s61, 19456
  s_add_u32 s64, s63, 10240
  buffer_load_dwordx4 v5, s[40:43], s64 offen  lds
  s_add_u32 m0, s61, 20480
  s_add_u32 s64, s63, 20480
  buffer_load_dwordx4 v4, s[36:39], s64 offen  lds
  s_add_u32 m0, s61, 21504
  s_add_u32 s64, s63, 30720
  buffer_load_dwordx4 v5, s[36:39], s64 offen  lds
  s_add_u32 m0, s61, 22528
  s_add_u32 s64, s63, 20480
  buffer_load_dwordx4 v4, s[40:43], s64 offen  lds
  s_add_u32 m0, s61, 23552
  s_add_u32 s64, s63, 30720
  buffer_load_dwordx4 v5, s[40:43], s64 offen  lds
  s_add_u32 m0, s61, 24576
  s_add_u32 s64, s63, 40960
  buffer_load_dwordx4 v4, s[36:39], s64 offen  lds
  s_add_u32 m0, s61, 25600
  s_add_u32 s64, s63, 51200
  buffer_load_dwordx4 v5, s[36:39], s64 offen  lds
  s_add_u32 m0, s61, 26624
  s_add_u32 s64, s63, 40960
  buffer_load_dwordx4 v4, s[40:43], s64 offen  lds
  s_add_u32 m0, s61, 27648
  s_add_u32 s64, s63, 51200
  buffer_load_dwordx4 v5, s[40:43], s64 offen  lds
  s_add_u32 s60, s60, 1
  s_cmp_eq_u32 s60, 10
  s_cselect_b32 s60, 0, s60
  s_add_u32 s61, s61, 40960
  s_cmp_eq_u32 s61, 122880
  s_cselect_b32 s61, 0, s61
  s_waitcnt vmcnt(12)
  s_barrier
  s_lshl_b32 s63, s60, 7
  s_add_u32 m0, s61, 16384
  s_add_u32 s64, s63, 0
  buffer_load_dwordx4 v4, s[36:39], s64 offen  lds
  s_add_u32 m0, s61, 17408
  s_add_u32 s64, s63, 10240
  buffer_load_dwordx4 v5, s[36:39], s64 offen  lds
  s_add_u32 m0, s61, 18432
  s_add_u32 s64, s63, 0
  buffer_load_dwordx4 v4, s[40:43], s64 offen  lds
  s_add_u32 m0, s61, 19456
  s_add_u32 s64, s63, 10240
  buffer_load_dwordx4 v5, s[40:43], s64 offen  lds
  s_add_u32 m0, s61, 20480
  s_add_u32 s64, s63, 20480
  buffer_load_dwordx4 v4, s[36:39], s64 offen  lds
  s_add_u32 m0, s61, 21504
  s_add_u32 s64, s63, 30720
  buffer_load_dwordx4 v5, s[36:39], s64 offen  lds
  s_add_u32 m0, s61, 22528
  s_add_u32 s64, s63, 20480
  buffer_load_dwordx4 v4, s[40:43], s64 offen  lds
  s_add_u32 m0, s61, 23552
  s_add_u32 s64, s63, 30720
  buffer_load_dwordx4 v5, s[40:43], s64 offen  lds
  s_add_u32 m0, s61, 24576
  s_add_u32 s64, s63, 40960
  buffer_load_dwordx4 v4, s[36:39], s64 offen  lds
  s_add_u32 m0, s61, 25600
  s_add_u32 s64, s63, 51200
  buffer_load_dwordx4 v5, s[36:39], s64 offen  lds
  s_add_u32 m0, s61, 26624
  s_add_u32 s64, s63, 40960
  buffer_load_dwordx4 v4, s[40:43], s64 offen  lds
  s_add_u32 m0, s61, 27648
  s_add_u32 s64, s63, 51200
  buffer_load_dwordx4 v5, s[40:43], s64 offen  lds
  s_add_u32 s60, s60, 1
  s_cmp_eq_u32 s60, 10
  s_cselect_b32 s60, 0, s60
  s_add_u32 s61, s61, 40960
  s_cmp_eq_u32 s61, 122880
  s_cselect_b32 s61, 0, s61
  s_waitcnt vmcnt(12)
  s_barrier
  s_lshl_b32 s63, s60, 7
  s_add_u32 m0, s61, 16384
  s_add_u32 s64, s63, 0
  buffer_load_dwordx4 v4, s[36:39], s64 offen  lds
  s_add_u32 m0, s61, 17408
  s_add_u32 s64, s63, 10240
  buffer_load_dwordx4 v5, s[36:39], s64 offen  lds
  s_add_u32 m0, s61, 18432
  s_add_u32 s64, s63, 0
  buffer_load_dwordx4 v4, s[40:43], s64 offen  lds
  s_add_u32 m0, s61, 19456
  s_add_u32 s64, s63, 10240
  buffer_load_dwordx4 v5, s[40:43], s64 offen  lds
  s_add_u32 m0, s61, 20480
  s_add_u32 s64, s63, 20480
  buffer_load_dwordx4 v4, s[36:39], s64 offen  lds
  s_add_u32 m0, s61, 21504
  s_add_u32 s64, s63, 30720
  buffer_load_dwordx4 v5, s[36:39], s64 offen  lds
  s_add_u32 m0, s61, 22528
  s_add_u32 s64, s63, 20480
  buffer_load_dwordx4 v4, s[40:43], s64 offen  lds
  s_add_u32 m0, s61, 23552
  s_add_u32 s64, s63, 30720
  buffer_load_dwordx4 v5, s[40:43], s64 offen  lds
  s_add_u32 m0, s61, 24576
  s_add_u32 s64, s63, 40960
  buffer_load_dwordx4 v4, s[36:39], s64 offen  lds
  s_add_u32 m0, s61, 25600
  s_add_u32 s64, s63, 51200
  buffer_load_dwordx4 v5, s[36:39], s64 offen  lds
  s_add_u32 m0, s61, 26624
  s_add_u32 s64, s63, 40960
  buffer_load_dwordx4 v4, s[40:43], s64 offen  lds
  s_add_u32 m0, s61, 27648
  s_add_u32 s64, s63, 51200
  buffer_load_dwordx4 v5, s[40:43], s64 offen  lds
  s_add_u32 s60, s60, 1
  s_cmp_eq_u32 s60, 10
  s_cselect_b32 s60, 0, s60
  s_add_u32 s61, s61, 40960
  s_cmp_eq_u32 s61, 122880
  s_cselect_b32 s61, 0, s61
  s_waitcnt vmcnt(12)
  s_barrier
  s_lshl_b32 s63, s60, 7
  s_add_u32 m0, s61, 16384
  s_add_u32 s64, s63, 0
  buffer_load_dwordx4 v4, s[36:39], s64 offen  lds
  s_add_u32 m0, s61, 17408
  s_add_u32 s64, s63, 10240
  buffer_load_dwordx4 v5, s[36:39], s64 offen  lds
  s_add_u32 m0, s61, 18432
  s_add_u32 s64, s63, 0
  buffer_load_dwordx4 v4, s[40:43], s64 offen  lds
  s_add_u32 m0, s61, 19456
  s_add_u32 s64, s63, 10240
  buffer_load_dwordx4 v5, s[40:43], s64 offen  lds
  s_add_u32 m0, s61, 20480
  s_add_u32 s64, s63, 20480
  buffer_load_dwordx4 v4, s[36:39], s64 offen  lds
  s_add_u32 m0, s61, 21504
  s_add_u32 s64, s63, 30720
  buffer_load_dwordx4 v5, s[36:39], s64 offen  lds
  s_add_u32 m0, s61, 22528
  s_add_u32 s64, s63, 20480
  buffer_load_dwordx4 v4, s[40:43], s64 offen  lds
  s_add_u32 m0, s61, 23552
  s_add_u32 s64, s63, 30720
  buffer_load_dwordx4 v5, s[40:43], s64 offen  lds
  s_add_u32 m0, s61, 24576
  s_add_u32 s64, s63, 40960
  buffer_load_dwordx4 v4, s[36:39], s64 offen  lds
  s_add_u32 m0, s61, 25600
  s_add_u32 s64, s63, 51200
  buffer_load_dwordx4 v5, s[36:39], s64 offen  lds
  s_add_u32 m0, s61, 26624
  s_add_u32 s64, s63, 40960
  buffer_load_dwordx4 v4, s[40:43], s64 offen  lds
  s_add_u32 m0, s61, 27648
  s_add_u32 s64, s63, 51200
  buffer_load_dwordx4 v5, s[40:43], s64 offen  lds
  s_add_u32 s60, s60, 1
  s_cmp_eq_u32 s60, 10
  s_cselect_b32 s60, 0, s60
  s_add_u32 s61, s61, 40960
  s_cmp_eq_u32 s61, 122880
  s_cselect_b32 s61, 0, s61
  s_waitcnt vmcnt(12)
  s_barrier
  s_lshl_b32 s63, s60, 7
  s_add_u32 m0, s61, 16384
  s_add_u32 s64, s63, 0
  buffer_load_dwordx4 v4, s[36:39], s64 offen  lds
  s_add_u32 m0, s61, 17408
  s_add_u32 s64, s63, 10240
  buffer_load_dwordx4 v5, s[36:39], s64 offen  lds
  s_add_u32 m0, s61, 18432
  s_add_u32 s64, s63, 0
  buffer_load_dwordx4 v4, s[40:43], s64 offen  lds
  s_add_u32 m0, s61, 19456
  s_add_u32 s64, s63, 10240
  buffer_load_dwordx4 v5, s[40:43], s64 offen  lds
  s_add_u32 m0, s61, 20480
  s_add_u32 s64, s63, 20480
  buffer_load_dwordx4 v4, s[36:39], s64 offen  lds
  s_add_u32 m0, s61, 21504
  s_add_u32 s64, s63, 30720
  buffer_load_dwordx4 v5, s[36:39], s64 offen  lds
  s_add_u32 m0, s61, 22528
  s_add_u32 s64, s63, 20480
  buffer_load_dwordx4 v4, s[40:43], s64 offen  lds
  s_add_u32 m0, s61, 23552
  s_add_u32 s64, s63, 30720
  buffer_load_dwordx4 v5, s[40:43], s64 offen  lds
  s_add_u32 m0, s61, 24576
  s_add_u32 s64, s63, 40960
  buffer_load_dwordx4 v4, s[36:39], s64 offen  lds
  s_add_u32 m0, s61, 25600
  s_add_u32 s64, s63, 51200
  buffer_load_dwordx4 v5, s[36:39], s64 offen  lds
  s_add_u32 m0, s61, 26624
  s_add_u32 s64, s63, 40960
  buffer_load_dwordx4 v4, s[40:43], s64 offen  lds
  s_add_u32 m0, s61, 27648
  s_add_u32 s64, s63, 51200
  buffer_load_dwordx4 v5, s[40:43], s64 offen  lds
  s_add_u32 s60, s60, 1
  s_cmp_eq_u32 s60, 10
  s_cselect_b32 s60, 0, s60
  s_add_u32 s61, s61, 40960
  s_cmp_eq_u32 s61, 122880
  s_cselect_b32 s61, 0, s61
  s_waitcnt vmcnt(12)
  s_barrier
  s_lshl_b32 s63, s60, 7
  s_add_u32 m0, s61, 16384
  s_add_u32 s64, s63, 0
  buffer_load_dwordx4 v4, s[36:39], s64 offen  lds
  s_add_u32 m0, s61, 17408
  s_add_u32 s64, s63, 10240
  buffer_load_dwordx4 v5, s[36:39], s64 offen  lds
  s_add_u32 m0, s61, 18432
  s_add_u32 s64, s63, 0
  buffer_load_dwordx4 v4, s[40:43], s64 offen  lds
  s_add_u32 m0, s61, 19456
  s_add_u32 s64, s63, 10240
  buffer_load_dwordx4 v5, s[40:43], s64 offen  lds
  s_add_u32 m0, s61, 20480
  s_add_u32 s64, s63, 20480
  buffer_load_dwordx4 v4, s[36:39], s64 offen  lds
  s_add_u32 m0, s61, 21504
  s_add_u32 s64, s63, 30720
  buffer_load_dwordx4 v5, s[36:39], s64 offen  lds
  s_add_u32 m0, s61, 22528
  s_add_u32 s64, s63, 20480
  buffer_load_dwordx4 v4, s[40:43], s64 offen  lds
  s_add_u32 m0, s61, 23552
  s_add_u32 s64, s63, 30720
  buffer_load_dwordx4 v5, s[40:43], s64 offen  lds
  s_add_u32 m0, s61, 24576
  s_add_u32 s64, s63, 40960
  buffer_load_dwordx4 v4, s[36:39], s64 offen  lds
  s_add_u32 m0, s61, 25600
  s_add_u32 s64, s63, 51200
  buffer_load_dwordx4 v5, s[36:39], s64 offen  lds
  s_add_u32 m0, s61, 26624
  s_add_u32 s64, s63, 40960
  buffer_load_dwordx4 v4, s[40:43], s64 offen  lds
  s_add_u32 m0, s61, 27648
  s_add_u32 s64, s63, 51200
  buffer_load_dwordx4 v5, s[40:43], s64 offen  lds
  s_add_u32 s60, s60, 1
  s_cmp_eq_u32 s60, 10
  s_cselect_b32 s60, 0, s60
  s_add_u32 s61, s61, 40960
  s_cmp_eq_u32 s61, 122880
  s_cselect_b32 s61, 0, s61
  s_waitcnt vmcnt(12)
  s_barrier
  s_lshl_b32 s63, s60, 7
  s_add_u32 m0, s61, 16384
  s_add_u32 s64, s63, 0
  buffer_load_dwordx4 v4, s[36:39], s64 offen  lds
  s_add_u32 m0, s61, 17408
  s_add_u32 s64, s63, 10240
  buffer_load_dwordx4 v5, s[36:39], s64 offen  lds
  s_add_u32 m0, s61, 18432
  s_add_u32 s64, s63, 0
  buffer_load_dwordx4 v4, s[40:43], s64 offen  lds
  s_add_u32 m0, s61, 19456
  s_add_u32 s64, s63, 10240
  buffer_load_dwordx4 v5, s[40:43], s64 offen  lds
  s_add_u32 m0, s61, 20480
  s_add_u32 s64, s63, 20480
  buffer_load_dwordx4 v4, s[36:39], s64 offen  lds
  s_add_u32 m0, s61, 21504
  s_add_u32 s64, s63, 30720
  buffer_load_dwordx4 v5, s[36:39], s64 offen  lds
  s_add_u32 m0, s61, 22528
  s_add_u32 s64, s63, 20480
  buffer_load_dwordx4 v4, s[40:43], s64 offen  lds
  s_add_u32 m0, s61, 23552
  s_add_u32 s64, s63, 30720
  buffer_load_dwordx4 v5, s[40:43], s64 offen  lds
  s_add_u32 m0, s61, 24576
  s_add_u32 s64, s63, 40960
  buffer_load_dwordx4 v4, s[36:39], s64 offen  lds
  s_add_u32 m0, s61, 25600
  s_add_u32 s64, s63, 51200
  buffer_load_dwordx4 v5, s[36:39], s64 offen  lds
  s_add_u32 m0, s61, 26624
  s_add_u32 s64, s63, 40960
  buffer_load_dwordx4 v4, s[40:43], s64 offen  lds
  s_add_u32 m0, s61, 27648
  s_add_u32 s64, s63, 51200
  buffer_load_dwordx4 v5, s[40:43], s64 offen  lds
  s_add_u32 s60, s60, 1
  s_cmp_eq_u32 s60, 10
  s_cselect_b32 s60, 0, s60
  s_add_u32 s61, s61, 40960
  s_cmp_eq_u32 s61, 122880
  s_cselect_b32 s61, 0, s61
  s_waitcnt vmcnt(12)
  s_barrier
  s_lshl_b32 s63, s60, 7
  s_add_u32 m0, s61, 16384
  s_add_u32 s64, s63, 0
  buffer_load_dwordx4 v4, s[36:39], s64 offen  lds
  s_add_u32 m0, s61, 17408
  s_add_u32 s64, s63, 10240
  buffer_load_dwordx4 v5, s[36:39], s64 offen  lds
  s_add_u32 m0, s61, 18432
  s_add_u32 s64, s63, 0
  buffer_load_dwordx4 v4, s[40:43], s64 offen  lds
  s_add_u32 m0, s61, 19456
  s_add_u32 s64, s63, 10240
  buffer_load_dwordx4 v5, s[40:43], s64 offen  lds
  s_add_u32 m0, s61, 20480
  s_add_u32 s64, s63, 20480
  buffer_load_dwordx4 v4, s[36:39], s64 offen  lds
  s_add_u32 m0, s61, 21504
  s_add_u32 s64, s63, 30720
  buffer_load_dwordx4 v5, s[36:39], s64 offen  lds
  s_add_u32 m0, s61, 22528
  s_add_u32 s64, s63, 20480
  buffer_load_dwordx4 v4, s[40:43], s64 offen  lds
  s_add_u32 m0, s61, 23552
  s_add_u32 s64, s63, 30720
  buffer_load_dwordx4 v5, s[40:43], s64 offen  lds
  s_add_u32 m0, s61, 24576
  s_add_u32 s64, s63, 40960
  buffer_load_dwordx4 v4, s[36:39], s64 offen  lds
  s_add_u32 m0, s61, 25600
  s_add_u32 s64, s63, 51200
  buffer_load_dwordx4 v5, s[36:39], s64 offen  lds
  s_add_u32 m0, s61, 26624
  s_add_u32 s64, s63, 40960
  buffer_load_dwordx4 v4, s[40:43], s64 offen  lds
  s_add_u32 m0, s61, 27648
  s_add_u32 s64, s63, 51200
  buffer_load_dwordx4 v5, s[40:43], s64 offen  lds
  s_add_u32 s60, s60, 1
  s_cmp_eq_u32 s60, 10
  s_cselect_b32 s60, 0, s60
  s_add_u32 s61, s61, 40960
  s_cmp_eq_u32 s61, 122880
  s_cselect_b32 s61, 0, s61
  s_waitcnt vmcnt(12)
  s_barrier
  s_waitcnt vmcnt(0)
  s_barrier
  s_barrier
  s_branch K2_loader
K1_ldbY:
  v_lshrrev_b32 v20, 4, v0
  v_min_u32 v20, 1, v20
  s_mul_i32 s60, s29, 2
  s_lshl_b32 s61, s32, 4
  s_add_u32 s60, s60, s61
  v_add_u32 v20, s60, v20
  v_lshlrev_b32 v21, 4, v20
  v_add_u32 v21, 36864, v21
  v_mul_u32_u24 v20, 1280, v20
  v_and_b32 v22, 15, v0
  v_lshl_add_u32 v20, v22, 4, v20
  buffer_load_dwordx4 v[24:27], v20, s[36:39], 0 offen offset:0
  buffer_load_dwordx4 v[28:31], v20, s[36:39], 0 offen offset:256
  buffer_load_dwordx4 v[32:35], v20, s[36:39], 0 offen offset:512
  buffer_load_dwordx4 v[36:39], v20, s[36:39], 0 offen offset:768
  buffer_load_dwordx4 v[40:43], v20, s[36:39], 0 offen offset:1024
  buffer_load_dwordx4 v[44:47], v20, s[40:43], 0 offen offset:0
  buffer_load_dwordx4 v[48:51], v20, s[40:43], 0 offen offset:256
  buffer_load_dwordx4 v[52:55], v20, s[40:43], 0 offen offset:512
  buffer_load_dwordx4 v[56:59], v20, s[40:43], 0 offen offset:768
  buffer_load_dwordx4 v[60:63], v20, s[40:43], 0 offen offset:1024
  s_mov_b32 s60, s34
  s_mov_b32 s61, 0
  s_lshl_b32 s63, s60, 7
  s_add_u32 m0, s61, 16384
  s_add_u32 s64, s63, 0
  buffer_load_dwordx4 v4, s[36:39], s64 offen  lds
  s_add_u32 m0, s61, 17408
  s_add_u32 s64, s63, 10240
  buffer_load_dwordx4 v5, s[36:39], s64 offen  lds
  s_add_u32 m0, s61, 18432
  s_add_u32 s64, s63, 0
  buffer_load_dwordx4 v4, s[40:43], s64 offen  lds
  s_add_u32 m0, s61, 19456
  s_add_u32 s64, s63, 10240
  buffer_load_dwordx4 v5, s[40:43], s64 offen  lds
  s_add_u32 m0, s61, 20480
  s_add_u32 s64, s63, 20480
  buffer_load_dwordx4 v4, s[36:39], s64 offen  lds
  s_add_u32 m0, s61, 21504
  s_add_u32 s64, s63, 30720
  buffer_load_dwordx4 v5, s[36:39], s64 offen  lds
  s_add_u32 m0, s61, 22528
  s_add_u32 s64, s63, 20480
  buffer_load_dwordx4 v4, s[40:43], s64 offen  lds
  s_add_u32 m0, s61, 23552
  s_add_u32 s64, s63, 30720
  buffer_load_dwordx4 v5, s[40:43], s64 offen  lds
  s_add_u32 s60, s60, 1
  s_cmp_eq_u32 s60, 10
  s_cselect_b32 s60, 0, s60
  s_add_u32 s61, s61, 40960
  s_cmp_eq_u32 s61, 122880
  s_cselect_b32 s61, 0, s61
  s_barrier
  s_waitcnt vmcnt(8)
  v_mov_b32 v23, 122912
  ds_read_b32 v23, v23
  s_waitcnt lgkmcnt(0)
  v_lshlrev_b32 v64, 16, v24
  v_and_b32 v65, 0xffff0000, v24
  v_lshlrev_b32 v66, 16, v25
  v_and_b32 v67, 0xffff0000, v25
  v_add_f32 v64, v64, v66
  v_add_f32 v65, v65, v67
  v_lshlrev_b32 v66, 16, v26
  v_and_b32 v67, 0xffff0000, v26
  v_add_f32 v64, v64, v66
  v_add_f32 v65, v65, v67
  v_lshlrev_b32 v66, 16, v27
  v_and_b32 v67, 0xffff0000, v27
  v_add_f32 v64, v64, v66
  v_add_f32 v65, v65, v67
  v_lshlrev_b32 v66, 16, v28
  v_and_b32 v67, 0xffff0000, v28
  v_add_f32 v64, v64, v66
  v_add_f32 v65, v65, v67
  v_lshlrev_b32 v66, 16, v29
  v_and_b32 v67, 0xffff0000, v29
  v_add_f32 v64, v64, v66
  v_add_f32 v65, v65, v67
  v_lshlrev_b32 v66, 16, v30
  v_and_b32 v67, 0xffff0000, v30
  v_add_f32 v64, v64, v66
  v_add_f32 v65, v65, v67
  v_lshlrev_b32 v66, 16, v31
  v_and_b32 v67, 0xffff0000, v31
  v_add_f32 v64, v64, v66
  v_add_f32 v65, v65, v67
  v_lshlrev_b32 v66, 16, v32
  v_and_b32 v67, 0xffff0000, v32
  v_add_f32 v64, v64, v66
  v_add_f32 v65, v65, v67
  v_lshlrev_b32 v66, 16, v33
  v_and_b32 v67, 0xffff0000, v33
  v_add_f32 v64, v64, v66
  v_add_f32 v65, v65, v67
  v_lshlrev_b32 v66, 16, v34
  v_and_b32 v67, 0xffff0000, v34
  v_add_f32 v64, v64, v66
  v_add_f32 v65, v65, v67
  v_lshlrev_b32 v66, 16, v35
  v_and_b32 v67, 0xffff0000, v35
  v_add_f32 v64, v64, v66
  v_add_f32 v65, v65, v67
  v_lshlrev_b32 v66, 16, v36
  v_and_b32 v67, 0xffff0000, v36
  v_add_f32 v64, v64, v66
  v_add_f32 v65, v65, v67
  v_lshlrev_b32 v66, 16, v37
  v_and_b32 v67, 0xffff0000, v37
  v_add_f32 v64, v64, v66
  v_add_f32 v65, v65, v67
  v_lshlrev_b32 v66, 16, v38
  v_and_b32 v67, 0xffff0000, v38
  v_add_f32 v64, v64, v66
  v_add_f32 v65, v65, v67
  v_lshlrev_b32 v66, 16, v39
  v_and_b32 v67, 0xffff0000, v39
  v_add_f32 v64, v64, v66
  v_add_f32 v65, v65, v67
  v_lshlrev_b32 v66, 16, v40
  v_and_b32 v67, 0xffff0000, v40
  v_add_f32 v64, v64, v66
  v_add_f32 v65, v65, v67
  v_lshlrev_b32 v66, 16, v41
  v_and_b32 v67, 0xffff0000, v41
  v_add_f32 v64, v64, v66
  v_add_f32 v65, v65, v67
  v_lshlrev_b32 v66, 16, v42
  v_and_b32 v67, 0xffff0000, v42
  v_add_f32 v64, v64, v66
  v_add_f32 v65, v65, v67
  v_lshlrev_b32 v66, 16, v43
  v_and_b32 v67, 0xffff0000, v43
  v_add_f32 v64, v64, v66
  v_add_f32 v65, v65, v67
  v_add_f32 v64, v64, v65
  v_lshlrev_b32 v66, 16, v44
  v_and_b32 v67, 0xffff0000, v44
  v_lshlrev_b32 v68, 16, v45
  v_and_b32 v69, 0xffff0000, v45
  v_add_f32 v66, v66, v68
  v_add_f32 v67, v67, v69
  v_lshlrev_b32 v68, 16, v46
  v_and_b32 v69, 0xffff0000, v46
  v_add_f32 v66, v66, v68
  v_add_f32 v67, v67, v69
  v_lshlrev_b32 v68, 16, v47
  v_and_b32 v69, 0xffff0000, v47
  v_add_f32 v66, v66, v68
  v_add_f32 v67, v67, v69
  v_lshlrev_b32 v68, 16, v48
  v_and_b32 v69, 0xffff0000, v48
  v_add_f32 v66, v66, v68
  v_add_f32 v67, v67, v69
  v_lshlrev_b32 v68, 16, v49
  v_and_b32 v69, 0xffff0000, v49
  v_add_f32 v66, v66, v68
  v_add_f32 v67, v67, v69
  v_lshlrev_b32 v68, 16, v50
  v_and_b32 v69, 0xffff0000, v50
  v_add_f32 v66, v66, v68
  v_add_f32 v67, v67, v69
  v_lshlrev_b32 v68, 16, v51
  v_and_b32 v69, 0xffff0000, v51
  v_add_f32 v66, v66, v68
  v_add_f32 v67, v67, v69
  v_lshlrev_b32 v68, 16, v52
  v_and_b32 v69, 0xffff0000, v52
  v_add_f32 v66, v66, v68
  v_add_f32 v67, v67, v69
  v_lshlrev_b32 v68, 16, v53
  v_and_b32 v69, 0xffff0000, v53
  v_add_f32 v66, v66, v68
  v_add_f32 v67, v67, v69
  v_lshlrev_b32 v68, 16, v54
  v_and_b32 v69, 0xffff0000, v54
  v_add_f32 v66, v66, v68
  v_add_f32 v67, v67, v69
  v_lshlrev_b32 v68, 16, v55
  v_and_b32 v69, 0xffff0000, v55
  v_add_f32 v66, v66, v68
  v_add_f32 v67, v67, v69
  v_lshlrev_b32 v68, 16, v56
  v_and_b32 v69, 0xffff0000, v56
  v_add_f32 v66, v66, v68
  v_add_f32 v67, v67, v69
  v_lshlrev_b32 v68, 16, v57
  v_and_b32 v69, 0xffff0000, v57
  v_add_f32 v66, v66, v68
  v_add_f32 v67, v67, v69
  v_lshlrev_b32 v68, 16, v58
  v_and_b32 v69, 0xffff0000, v58
  v_add_f32 v66, v66, v68
  v_add_f32 v67, v67, v69
  v_lshlrev_b32 v68, 16, v59
  v_and_b32 v69, 0xffff0000, v59
  v_add_f32 v66, v66, v68
  v_add_f32 v67, v67, v69
  v_lshlrev_b32 v68, 16, v60
  v_and_b32 v69, 0xffff0000, v60
  v_add_f32 v66, v66, v68
  v_add_f32 v67, v67, v69
  v_lshlrev_b32 v68, 16, v61
  v_and_b32 v69, 0xffff0000, v61
  v_add_f32 v66, v66, v68
  v_add_f32 v67, v67, v69
  v_lshlrev_b32 v68, 16, v62
  v_and_b32 v69, 0xffff0000, v62
  v_add_f32 v66, v66, v68
  v_add_f32 v67, v67, v69
  v_lshlrev_b32 v68, 16, v63
  v_and_b32 v69, 0xffff0000, v63
  v_add_f32 v66, v66, v68
  v_add_f32 v67, v67, v69
  v_add_f32 v66, v66, v67
  s_nop 1
  v_add_f32_dpp v64, v64, v64 row_ror:8 row_mask:0xf bank_mask:0xf
  v_add_f32_dpp v66, v66, v66 row_ror:8 row_mask:0xf bank_mask:0xf
  s_nop 1
  v_add_f32_dpp v64, v64, v64 row_ror:4 row_mask:0xf bank_mask:0xf
  v_add_f32_dpp v66, v66, v66 row_ror:4 row_mask:0xf bank_mask:0xf
  s_nop 1
  v_add_f32_dpp v64, v64, v64 row_ror:2 row_mask:0xf bank_mask:0xf
  v_add_f32_dpp v66, v66, v66 row_ror:2 row_mask:0xf bank_mask:0xf
  s_nop 1
  v_add_f32_dpp v64, v64, v64 row_ror:1 row_mask:0xf bank_mask:0xf
  v_add_f32_dpp v66, v66, v66 row_ror:1 row_mask:0xf bank_mask:0xf
  s_nop 0
  v_mov_b32 v65, v23
  v_mov_b32 v67, v23
  s_mov_b32 exec_lo, 0x00010001
  s_mov_b32 exec_hi, 0
  buffer_store_dwordx4 v[64:67], v21, s[44:47], 0 offen sc1
  s_mov_b64 exec, -1
  s_lshl_b32 s63, s60, 7
  s_add_u32 m0, s61, 16384
  s_add_u32 s64, s63, 0
  buffer_load_dwordx4 v4, s[36:39], s64 offen  lds
  s_add_u32 m0, s61, 17408
  s_add_u32 s64, s63, 10240
  buffer_load_dwordx4 v5, s[36:39], s64 offen  lds
  s_add_u32 m0, s61, 18432
  s_add_u32 s64, s63, 0
  buffer_load_dwordx4 v4, s[40:43], s64 offen  lds
  s_add_u32 m0, s61, 19456
  s_add_u32 s64, s63, 10240
  buffer_load_dwordx4 v5, s[40:43], s64 offen  lds
  s_add_u32 m0, s61, 20480
  s_add_u32 s64, s63, 20480
  buffer_load_dwordx4 v4, s[36:39], s64 offen  lds
  s_add_u32 m0, s61, 21504
  s_add_u32 s64, s63, 30720
  buffer_load_dwordx4 v5, s[36:39], s64 offen  lds
  s_add_u32 m0, s61, 22528
  s_add_u32 s64, s63, 20480
  buffer_load_dwordx4 v4, s[40:43], s64 offen  lds
  s_add_u32 m0, s61, 23552
  s_add_u32 s64, s63, 30720
  buffer_load_dwordx4 v5, s[40:43], s64 offen  lds
  s_add_u32 s60, s60, 1
  s_cmp_eq_u32 s60, 10
  s_cselect_b32 s60, 0, s60
  s_add_u32 s61, s61, 40960
  s_cmp_eq_u32 s61, 122880
  s_cselect_b32 s61, 0, s61
  s_waitcnt vmcnt(9)
  s_barrier
  s_lshl_b32 s63, s60, 7
  s_add_u32 m0, s61, 16384
  s_add_u32 s64, s63, 0
  buffer_load_dwordx4 v4, s[36:39], s64 offen  lds
  s_add_u32 m0, s61, 17408
  s_add_u32 s64, s63, 10240
  buffer_load_dwordx4 v5, s[36:39], s64 offen  lds
  s_add_u32 m0, s61, 18432
  s_add_u32 s64, s63, 0
  buffer_load_dwordx4 v4, s[40:43], s64 offen  lds
  s_add_u32 m0, s61, 19456
  s_add_u32 s64, s63, 10240
  buffer_load_dwordx4 v5, s[40:43], s64 offen  lds
  s_add_u32 m0, s61, 20480
  s_add_u32 s64, s63, 20480
  buffer_load_dwordx4 v4, s[36:39], s64 offen  lds
  s_add_u32 m0, s61, 21504
  s_add_u32 s64, s63, 30720
  buffer_load_dwordx4 v5, s[36:39], s64 offen  lds
  s_add_u32 m0, s61, 22528
  s_add_u32 s64, s63, 20480
  buffer_load_dwordx4 v4, s[40:43], s64 offen  lds
  s_add_u32 m0, s61, 23552
  s_add_u32 s64, s63, 30720
  buffer_load_dwordx4 v5, s[40:43], s64 offen  lds
  s_add_u32 s60, s60, 1
  s_cmp_eq_u32 s60, 10
  s_cselect_b32 s60, 0, s60
  s_add_u32 s61, s61, 40960
  s_cmp_eq_u32 s61, 122880
  s_cselect_b32 s61, 0, s61
  s_waitcnt vmcnt(8)
  s_barrier
  s_lshl_b32 s63, s60, 7
  s_add_u32 m0, s61, 16384
  s_add_u32 s64, s63, 0
  buffer_load_dwordx4 v4, s[36:39], s64 offen  lds
  s_add_u32 m0, s61, 17408
  s_add_u32 s64, s63, 10240
  buffer_load_dwordx4 v5, s[36:39], s64 offen  lds
  s_add_u32 m0, s61, 18432
  s_add_u32 s64, s63, 0
  buffer_load_dwordx4 v4, s[40:43], s64 offen  lds
  s_add_u32 m0, s61, 19456
  s_add_u32 s64, s63, 10240
  buffer_load_dwordx4 v5, s[40:43], s64 offen  lds
  s_add_u32 m0, s61, 20480
  s_add_u32 s64, s63, 20480
  buffer_load_dwordx4 v4, s[36:39], s64 offen  lds
  s_add_u32 m0, s61, 21504
  s_add_u32 s64, s63, 30720
  buffer_load_dwordx4 v5, s[36:39], s64 offen  lds
  s_add_u32 m0, s61, 22528
  s_add_u32 s64, s63, 20480
  buffer_load_dwordx4 v4, s[40:43], s64 offen  lds
  s_add_u32 m0, s61, 23552
  s_add_u32 s64, s63, 30720
  buffer_load_dwordx4 v5, s[40:43], s64 offen  lds
  s_add_u32 s60, s60, 1
  s_cmp_eq_u32 s60, 10
  s_cselect_b32 s60, 0, s60
  s_add_u32 s61, s61, 40960
  s_cmp_eq_u32 s61, 122880
  s_cselect_b32 s61, 0, s61
  s_waitcnt vmcnt(8)
  s_barrier
  s_lshl_b32 s63, s60, 7
  s_add_u32 m0, s61, 16384
  s_add_u32 s64, s63, 0
  buffer_load_dwordx4 v4, s[36:39], s64 offen  lds
  s_add_u32 m0, s61, 17408
  s_add_u32 s64, s63, 10240
  buffer_load_dwordx4 v5, s[36:39], s64 offen  lds
  s_add_u32 m0, s61, 18432
  s_add_u32 s64, s63, 0
  buffer_load_dwordx4 v4, s[40:43], s64 offen  lds
  s_add_u32 m0, s61, 19456
  s_add_u32 s64, s63, 10240
  buffer_load_dwordx4 v5, s[40:43], s64 offen  lds
  s_add_u32 m0, s61, 20480
  s_add_u32 s64, s63, 20480
  buffer_load_dwordx4 v4, s[36:39], s64 offen  lds
  s_add_u32 m0, s61, 21504
  s_add_u32 s64, s63, 30720
  buffer_load_dwordx4 v5, s[36:39], s64 offen  lds
  s_add_u32 m0, s61, 22528
  s_add_u32 s64, s63, 20480
  buffer_load_dwordx4 v4, s[40:43], s64 offen  lds
  s_add_u32 m0, s61, 23552
  s_add_u32 s64, s63, 30720
  buffer_load_dwordx4 v5, s[40:43], s64 offen  lds
  s_add_u32 s60, s60, 1
  s_cmp_eq_u32 s60, 10
  s_cselect_b32 s60, 0, s60
  s_add_u32 s61, s61, 40960
  s_cmp_eq_u32 s61, 122880
  s_cselect_b32 s61, 0, s61
  s_waitcnt vmcnt(8)
  s_barrier
  s_lshl_b32 s63, s60, 7
  s_add_u32 m0, s61, 16384
  s_add_u32 s64, s63, 0
  buffer_load_dwordx4 v4, s[36:39], s64 offen  lds
  s_add_u32 m0, s61, 17408
  s_add_u32 s64, s63, 10240
  buffer_load_dwordx4 v5, s[36:39], s64 offen  lds
  s_add_u32 m0, s61, 18432
  s_add_u32 s64, s63, 0
  buffer_load_dwordx4 v4, s[40:43], s64 offen  lds
  s_add_u32 m0, s61, 19456
  s_add_u32 s64, s63, 10240
  buffer_load_dwordx4 v5, s[40:43], s64 offen  lds
  s_add_u32 m0, s61, 20480
  s_add_u32 s64, s63, 20480
  buffer_load_dwordx4 v4, s[36:39], s64 offen  lds
  s_add_u32 m0, s61, 21504
  s_add_u32 s64, s63, 30720
  buffer_load_dwordx4 v5, s[36:39], s64 offen  lds
  s_add_u32 m0, s61, 22528
  s_add_u32 s64, s63, 20480
  buffer_load_dwordx4 v4, s[40:43], s64 offen  lds
  s_add_u32 m0, s61, 23552
  s_add_u32 s64, s63, 30720
  buffer_load_dwordx4 v5, s[40:43], s64 offen  lds
  s_add_u32 s60, s60, 1
  s_cmp_eq_u32 s60, 10
  s_cselect_b32 s60, 0, s60
  s_add_u32 s61, s61, 40960
  s_cmp_eq_u32 s61, 122880
  s_cselect_b32 s61, 0, s61
  s_waitcnt vmcnt(8)
  s_barrier
  s_lshl_b32 s63, s60, 7
  s_add_u32 m0, s61, 16384
  s_add_u32 s64, s63, 0
  buffer_load_dwordx4 v4, s[36:39], s64 offen  lds
  s_add_u32 m0, s61, 17408
  s_add_u32 s64, s63, 10240
  buffer_load_dwordx4 v5, s[36:39], s64 offen  lds
  s_add_u32 m0, s61, 18432
  s_add_u32 s64, s63, 0
  buffer_load_dwordx4 v4, s[40:43], s64 offen  lds
  s_add_u32 m0, s61, 19456
  s_add_u32 s64, s63, 10240
  buffer_load_dwordx4 v5, s[40:43], s64 offen  lds
  s_add_u32 m0, s61, 20480
  s_add_u32 s64, s63, 20480
  buffer_load_dwordx4 v4, s[36:39], s64 offen  lds
  s_add_u32 m0, s61, 21504
  s_add_u32 s64, s63, 30720
  buffer_load_dwordx4 v5, s[36:39], s64 offen  lds
  s_add_u32 m0, s61, 22528
  s_add_u32 s64, s63, 20480
  buffer_load_dwordx4 v4, s[40:43], s64 offen  lds
  s_add_u32 m0, s61, 23552
  s_add_u32 s64, s63, 30720
  buffer_load_dwordx4 v5, s[40:43], s64 offen  lds
  s_add_u32 s60, s60, 1
  s_cmp_eq_u32 s60, 10
  s_cselect_b32 s60, 0, s60
  s_add_u32 s61, s61, 40960
  s_cmp_eq_u32 s61, 122880
  s_cselect_b32 s61, 0, s61
  s_waitcnt vmcnt(8)
  s_barrier
  s_lshl_b32 s63, s60, 7
  s_add_u32 m0, s61, 16384
  s_add_u32 s64, s63, 0
  buffer_load_dwordx4 v4, s[36:39], s64 offen  lds
  s_add_u32 m0, s61, 17408
  s_add_u32 s64, s63, 10240
  buffer_load_dwordx4 v5, s[36:39], s64 offen  lds
  s_add_u32 m0, s61, 18432
  s_add_u32 s64, s63, 0
  buffer_load_dwordx4 v4, s[40:43], s64 offen  lds
  s_add_u32 m0, s61, 19456
  s_add_u32 s64, s63, 10240
  buffer_load_dwordx4 v5, s[40:43], s64 offen  lds
  s_add_u32 m0, s61, 20480
  s_add_u32 s64, s63, 20480
  buffer_load_dwordx4 v4, s[36:39], s64 offen  lds
  s_add_u32 m0, s61, 21504
  s_add_u32 s64, s63, 30720
  buffer_load_dwordx4 v5, s[36:39], s64 offen  lds
  s_add_u32 m0, s61, 22528
  s_add_u32 s64, s63, 20480
  buffer_load_dwordx4 v4, s[40:43], s64 offen  lds
  s_add_u32 m0, s61, 23552
  s_add_u32 s64, s63, 30720
  buffer_load_dwordx4 v5, s[40:43], s64 offen  lds
  s_add_u32 s60, s60, 1
  s_cmp_eq_u32 s60, 10
  s_cselect_b32 s60, 0, s60
  s_add_u32 s61, s61, 40960
  s_cmp_eq_u32 s61, 122880
  s_cselect_b32 s61, 0, s61
  s_waitcnt vmcnt(8)
  s_barrier
  s_lshl_b32 s63, s60, 7
  s_add_u32 m0, s61, 16384
  s_add_u32 s64, s63, 0
  buffer_load_dwordx4 v4, s[36:39], s64 offen  lds
  s_add_u32 m0, s61, 17408
  s_add_u32 s64, s63, 10240
  buffer_load_dwordx4 v5, s[36:39], s64 offen  lds
  s_add_u32 m0, s61, 18432
  s_add_u32 s64, s63, 0
  buffer_load_dwordx4 v4, s[40:43], s64 offen  lds
  s_add_u32 m0, s61, 19456
  s_add_u32 s64, s63, 10240
  buffer_load_dwordx4 v5, s[40:43], s64 offen  lds
  s_add_u32 m0, s61, 20480
  s_add_u32 s64, s63, 20480
  buffer_load_dwordx4 v4, s[36:39], s64 offen  lds
  s_add_u32 m0, s61, 21504
  s_add_u32 s64, s63, 30720
  buffer_load_dwordx4 v5, s[36:39], s64 offen  lds
  s_add_u32 m0, s61, 22528
  s_add_u32 s64, s63, 20480
  buffer_load_dwordx4 v4, s[40:43], s64 offen  lds
  s_add_u32 m0, s61, 23552
  s_add_u32 s64, s63, 30720
  buffer_load_dwordx4 v5, s[40:43], s64 offen  lds
  s_add_u32 s60, s60, 1
  s_cmp_eq_u32 s60, 10
  s_cselect_b32 s60, 0, s60
  s_add_u32 s61, s61, 40960
  s_cmp_eq_u32 s61, 122880
  s_cselect_b32 s61, 0, s61
  s_waitcnt vmcnt(8)
  s_barrier
  s_lshl_b32 s63, s60, 7
  s_add_u32 m0, s61, 16384
  s_add_u32 s64, s63, 0
  buffer_load_dwordx4 v4, s[36:39], s64 offen  lds
  s_add_u32 m0, s61, 17408
  s_add_u32 s64, s63, 10240
  buffer_load_dwordx4 v5, s[36:39], s64 offen  lds
  s_add_u32 m0, s61, 18432
  s_add_u32 s64, s63, 0
  buffer_load_dwordx4 v4, s[40:43], s64 offen  lds
  s_add_u32 m0, s61, 19456
  s_add_u32 s64, s63, 10240
  buffer_load_dwordx4 v5, s[40:43], s64 offen  lds
  s_add_u32 m0, s61, 20480
  s_add_u32 s64, s63, 20480
  buffer_load_dwordx4 v4, s[36:39], s64 offen  lds
  s_add_u32 m0, s61, 21504
  s_add_u32 s64, s63, 30720
  buffer_load_dwordx4 v5, s[36:39], s64 offen  lds
  s_add_u32 m0, s61, 22528
  s_add_u32 s64, s63, 20480
  buffer_load_dwordx4 v4, s[40:43], s64 offen  lds
  s_add_u32 m0, s61, 23552
  s_add_u32 s64, s63, 30720
  buffer_load_dwordx4 v5, s[40:43], s64 offen  lds
  s_add_u32 s60, s60, 1
  s_cmp_eq_u32 s60, 10
  s_cselect_b32 s60, 0, s60
  s_add_u32 s61, s61, 40960
  s_cmp_eq_u32 s61, 122880
  s_cselect_b32 s61, 0, s61
  s_waitcnt vmcnt(8)
  s_barrier
  s_waitcnt vmcnt(0)
  s_barrier
  s_barrier
  s_branch K2_loader
K1_ldw:
  s_mov_b32 s36, s10
  s_and_b32 s37, s11, 0xffff
  s_mov_b32 s38, 1966080
  s_mov_b32 s39, 0x20000

  v_lshrrev_b32 v1, 3, v0
  v_mul_u32_u24 v1, 3072, v1
  s_lshl_b32 s63, s33, 7
  v_add_u32 v1, s63, v1
  v_and_b32 v2, 7, v0
  v_bfe_u32 v3, v0, 4, 1
  v_lshlrev_b32 v3, 1, v3
  v_xor_b32 v2, v2, v3
  v_lshl_add_u32 v4, v2, 4, v1
  v_xor_b32 v2, 4, v2
  v_lshl_add_u32 v5, v2, 4, v1

  s_mov_b32 s44, s12
  s_and_b32 s45, s13, 0xffff
  s_mov_b32 s46, 1048576
  s_mov_b32 s47, 0x20000
  s_cmp_eq_u32 s31, 1
  s_cbranch_scc1 K1_ldwY
  v_lshrrev_b32 v20, 3, v0
  s_mul_i32 s60, s29, 40
  v_add_u32 v20, s60, v20
  v_mul_u32_u24 v20, 3072, v20
  s_lshl_b32 s60, s33, 7
  v_add_u32 v20, s60, v20
  v_and_b32 v22, 7, v0
  v_lshl_add_u32 v20, v22, 4, v20
  v_lshlrev_b32 v21, 2, v22
  v_bfe_u32 v22, v0, 4, 1
  v_lshl_add_u32 v21, v22, 1, v21
  v_lshrrev_b32 v22, 5, v0
  v_add_u32 v21, v21, v22
  v_lshlrev_b32 v21, 4, v21
  s_lshl_b32 s60, s33, 4
  s_add_u32 s60, s60, s29
  s_lshl_b32 s60, s60, 9
  s_add_u32 s60, s60, 262144
  v_add_u32 v21, s60, v21
  v_add_u32 v19, 73728, v20
  s_movk_i32 s61, 0
  s_lshl_b32 s61, s61, 10
  buffer_load_dwordx4 v[24:27], v20, s[36:39], s61 offen offset:0
  s_movk_i32 s61, 24
  s_lshl_b32 s61, s61, 10
  buffer_load_dwordx4 v[28:31], v20, s[36:39], s61 offen offset:0
  s_movk_i32 s61, 48
  s_lshl_b32 s61, s61, 10
  buffer_load_dwordx4 v[32:35], v20, s[36:39], s61 offen offset:0
  s_movk_i32 s61, 72
  s_lshl_b32 s61, s61, 10
  buffer_load_dwordx4 v[36:39], v20, s[36:39], s61 offen offset:0
  s_movk_i32 s61, 96
  s_lshl_b32 s61, s61, 10
  buffer_load_dwordx4 v[40:43], v20, s[36:39], s61 offen offset:0
  s_mov_b32 s60, s34
  s_mov_b32 s61, 0
  s_mul_i32 s63, s60, 196608
  s_add_u32 m0, s61, 28672
  s_add_u32 s64, s63, 0
  buffer_load_dwordx4 v4, s[36:39], s64 offen  lds
  s_add_u32 m0, s61, 29696
  s_add_u32 s64, s63, 24576
  buffer_load_dwordx4 v5, s[36:39], s64 offen  lds
  s_add_u32 m0, s61, 30720
  s_add_u32 s64, s63, 49152
  buffer_load_dwordx4 v4, s[36:39], s64 offen  lds
  s_add_u32 m0, s61, 31744
  s_add_u32 s64, s63, 73728
  buffer_load_dwordx4 v5, s[36:39], s64 offen  lds
  s_add_u32 m0, s61, 32768
  s_add_u32 s64, s63, 98304
  buffer_load_dwordx4 v4, s[36:39], s64 offen  lds
  s_add_u32 m0, s61, 33792
  s_add_u32 s64, s63, 122880
  buffer_load_dwordx4 v5, s[36:39], s64 offen  lds
  s_add_u32 m0, s61, 34816
  s_add_u32 s64, s63, 147456
  buffer_load_dwordx4 v4, s[36:39], s64 offen  lds
  s_add_u32 m0, s61, 35840
  s_add_u32 s64, s63, 172032
  buffer_load_dwordx4 v5, s[36:39], s64 offen  lds
  s_add_u32 s60, s60, 1
  s_cmp_eq_u32 s60, 10
  s_cselect_b32 s60, 0, s60
  s_add_u32 s61, s61, 40960
  s_cmp_eq_u32 s61, 122880
  s_cselect_b32 s61, 0, s61
  s_barrier
  s_waitcnt vmcnt(8)
  v_mov_b32 v23, 122912
  ds_read_b32 v23, v23
  s_waitcnt lgkmcnt(0)
  v_lshlrev_b32 v64, 16, v24
  v_and_b32 v65, 0xffff0000, v24
  v_lshlrev_b32 v66, 16, v25
  v_and_b32 v67, 0xffff0000, v25
  v_lshlrev_b32 v68, 16, v26
  v_and_b32 v69, 0xffff0000, v26
  v_lshlrev_b32 v70, 16, v27
  v_and_b32 v71, 0xffff0000, v27
  v_lshlrev_b32 v72, 16, v28
  v_and_b32 v73, 0xffff0000, v28
  v_add_f32 v64, v64, v72
  v_add_f32 v65, v65, v73
  v_lshlrev_b32 v72, 16, v29
  v_and_b32 v73, 0xffff0000, v29
  v_add_f32 v66, v66, v72
  v_add_f32 v67, v67, v73
  v_lshlrev_b32 v72, 16, v30
  v_and_b32 v73, 0xffff0000, v30
  v_add_f32 v68, v68, v72
  v_add_f32 v69, v69, v73
  v_lshlrev_b32 v72, 16, v31
  v_and_b32 v73, 0xffff0000, v31
  v_add_f32 v70, v70, v72
  v_add_f32 v71, v71, v73
  v_lshlrev_b32 v72, 16, v32
  v_and_b32 v73, 0xffff0000, v32
  v_add_f32 v64, v64, v72
  v_add_f32 v65, v65, v73
  v_lshlrev_b32 v72, 16, v33
  v_and_b32 v73, 0xffff0000, v33
  v_add_f32 v66, v66, v72
  v_add_f32 v67, v67, v73
  v_lshlrev_b32 v72, 16, v34
  v_and_b32 v73, 0xffff0000, v34
  v_add_f32 v68, v68, v72
  v_add_f32 v69, v69, v73
  v_lshlrev_b32 v72, 16, v35
  v_and_b32 v73, 0xffff0000, v35
  v_add_f32 v70, v70, v72
  v_add_f32 v71, v71, v73
  v_lshlrev_b32 v72, 16, v36
  v_and_b32 v73, 0xffff0000, v36
  v_add_f32 v64, v64, v72
  v_add_f32 v65, v65, v73
  v_lshlrev_b32 v72, 16, v37
  v_and_b32 v73, 0xffff0000, v37
  v_add_f32 v66, v66, v72
  v_add_f32 v67, v67, v73
  v_lshlrev_b32 v72, 16, v38
  v_and_b32 v73, 0xffff0000, v38
  v_add_f32 v68, v68, v72
  v_add_f32 v69, v69, v73
  v_lshlrev_b32 v72, 16, v39
  v_and_b32 v73, 0xffff0000, v39
  v_add_f32 v70, v70, v72
  v_add_f32 v71, v71, v73
  v_lshlrev_b32 v72, 16, v40
  v_and_b32 v73, 0xffff0000, v40
  v_add_f32 v64, v64, v72
  v_add_f32 v65, v65, v73
  v_lshlrev_b32 v72, 16, v41
  v_and_b32 v73, 0xffff0000, v41
  v_add_f32 v66, v66, v72
  v_add_f32 v67, v67, v73
  v_lshlrev_b32 v72, 16, v42
  v_and_b32 v73, 0xffff0000, v42
  v_add_f32 v68, v68, v72
  v_add_f32 v69, v69, v73
  v_lshlrev_b32 v72, 16, v43
  v_and_b32 v73, 0xffff0000, v43
  v_add_f32 v70, v70, v72
  v_add_f32 v71, v71, v73
  s_nop 1
  v_permlane16_swap_b32 v64, v68
  v_permlane16_swap_b32 v65, v69
  v_permlane16_swap_b32 v66, v70
  v_permlane16_swap_b32 v67, v71
  s_nop 1
  v_add_f32 v64, v64, v68
  v_add_f32 v65, v65, v69
  v_add_f32 v66, v66, v70
  v_add_f32 v67, v67, v71
  s_nop 1
  v_permlane32_swap_b32 v64, v66
  v_permlane32_swap_b32 v65, v67
  s_nop 1
  v_add_f32 v64, v64, v66
  v_add_f32 v65, v65, v67
  s_nop 1
  v_add_f32_dpp v76, v64, v64 row_ror:8 row_mask:0xf bank_mask:0xf
  v_add_f32_dpp v78, v65, v65 row_ror:8 row_mask:0xf bank_mask:0xf
  v_mov_b32 v77, v23
  v_mov_b32 v79, v23
  s_mov_b32 exec_lo, 0x00ff00ff
  s_mov_b32 exec_hi, 0x00ff00ff
  s_movk_i32 s63, 0
  buffer_store_dwordx4 v[76:79], v21, s[44:47], s63 offen sc1
  s_mov_b64 exec, -1
  s_nop 1
  s_mul_i32 s63, s60, 196608
  s_add_u32 m0, s61, 28672
  s_add_u32 s64, s63, 0
  buffer_load_dwordx4 v4, s[36:39], s64 offen  lds
  s_add_u32 m0, s61, 29696
  s_add_u32 s64, s63, 24576
  buffer_load_dwordx4 v5, s[36:39], s64 offen  lds
  s_add_u32 m0, s61, 30720
  s_add_u32 s64, s63, 49152
  buffer_load_dwordx4 v4, s[36:39], s64 offen  lds
  s_add_u32 m0, s61, 31744
  s_add_u32 s64, s63, 73728
  buffer_load_dwordx4 v5, s[36:39], s64 offen  lds
  s_add_u32 m0, s61, 32768
  s_add_u32 s64, s63, 98304
  buffer_load_dwordx4 v4, s[36:39], s64 offen  lds
  s_add_u32 m0, s61, 33792
  s_add_u32 s64, s63, 122880
  buffer_load_dwordx4 v5, s[36:39], s64 offen  lds
  s_add_u32 m0, s61, 34816
  s_add_u32 s64, s63, 147456
  buffer_load_dwordx4 v4, s[36:39], s64 offen  lds
  s_add_u32 m0, s61, 35840
  s_add_u32 s64, s63, 172032
  buffer_load_dwordx4 v5, s[36:39], s64 offen  lds
  s_add_u32 s60, s60, 1
  s_cmp_eq_u32 s60, 10
  s_cselect_b32 s60, 0, s60
  s_add_u32 s61, s61, 40960
  s_cmp_eq_u32 s61, 122880
  s_cselect_b32 s61, 0, s61
  s_waitcnt vmcnt(9)
  s_barrier
  s_mul_i32 s63, s60, 196608
  s_add_u32 m0, s61, 28672
  s_add_u32 s64, s63, 0
  buffer_load_dwordx4 v4, s[36:39], s64 offen  lds
  s_add_u32 m0, s61, 29696
  s_add_u32 s64, s63, 24576
  buffer_load_dwordx4 v5, s[36:39], s64 offen  lds
  s_add_u32 m0, s61, 30720
  s_add_u32 s64, s63, 49152
  buffer_load_dwordx4 v4, s[36:39], s64 offen  lds
  s_add_u32 m0, s61, 31744
  s_add_u32 s64, s63, 73728
  buffer_load_dwordx4 v5, s[36:39], s64 offen  lds
  s_add_u32 m0, s61, 32768
  s_add_u32 s64, s63, 98304
  buffer_load_dwordx4 v4, s[36:39], s64 offen  lds
  s_add_u32 m0, s61, 33792
  s_add_u32 s64, s63, 122880
  buffer_load_dwordx4 v5, s[36:39], s64 offen  lds
  s_add_u32 m0, s61, 34816
  s_add_u32 s64, s63, 147456
  buffer_load_dwordx4 v4, s[36:39], s64 offen  lds
  s_add_u32 m0, s61, 35840
  s_add_u32 s64, s63, 172032
  buffer_load_dwordx4 v5, s[36:39], s64 offen  lds
  s_add_u32 s60, s60, 1
  s_cmp_eq_u32 s60, 10
  s_cselect_b32 s60, 0, s60
  s_add_u32 s61, s61, 40960
  s_cmp_eq_u32 s61, 122880
  s_cselect_b32 s61, 0, s61
  s_waitcnt vmcnt(8)
  s_barrier
  s_mul_i32 s63, s60, 196608
  s_add_u32 m0, s61, 28672
  s_add_u32 s64, s63, 0
  buffer_load_dwordx4 v4, s[36:39], s64 offen  lds
  s_add_u32 m0, s61, 29696
  s_add_u32 s64, s63, 24576
  buffer_load_dwordx4 v5, s[36:39], s64 offen  lds
  s_add_u32 m0, s61, 30720
  s_add_u32 s64, s63, 49152
  buffer_load_dwordx4 v4, s[36:39], s64 offen  lds
  s_add_u32 m0, s61, 31744
  s_add_u32 s64, s63, 73728
  buffer_load_dwordx4 v5, s[36:39], s64 offen  lds
  s_add_u32 m0, s61, 32768
  s_add_u32 s64, s63, 98304
  buffer_load_dwordx4 v4, s[36:39], s64 offen  lds
  s_add_u32 m0, s61, 33792
  s_add_u32 s64, s63, 122880
  buffer_load_dwordx4 v5, s[36:39], s64 offen  lds
  s_add_u32 m0, s61, 34816
  s_add_u32 s64, s63, 147456
  buffer_load_dwordx4 v4, s[36:39], s64 offen  lds
  s_add_u32 m0, s61, 35840
  s_add_u32 s64, s63, 172032
  buffer_load_dwordx4 v5, s[36:39], s64 offen  lds
  s_add_u32 s60, s60, 1
  s_cmp_eq_u32 s60, 10
  s_cselect_b32 s60, 0, s60
  s_add_u32 s61, s61, 40960
  s_cmp_eq_u32 s61, 122880
  s_cselect_b32 s61, 0, s61
  s_waitcnt vmcnt(8)
  s_barrier
  s_mul_i32 s63, s60, 196608
  s_add_u32 m0, s61, 28672
  s_add_u32 s64, s63, 0
  buffer_load_dwordx4 v4, s[36:39], s64 offen  lds
  s_add_u32 m0, s61, 29696
  s_add_u32 s64, s63, 24576
  buffer_load_dwordx4 v5, s[36:39], s64 offen  lds
  s_add_u32 m0, s61, 30720
  s_add_u32 s64, s63, 49152
  buffer_load_dwordx4 v4, s[36:39], s64 offen  lds
  s_add_u32 m0, s61, 31744
  s_add_u32 s64, s63, 73728
  buffer_load_dwordx4 v5, s[36:39], s64 offen  lds
  s_add_u32 m0, s61, 32768
  s_add_u32 s64, s63, 98304
  buffer_load_dwordx4 v4, s[36:39], s64 offen  lds
  s_add_u32 m0, s61, 33792
  s_add_u32 s64, s63, 122880
  buffer_load_dwordx4 v5, s[36:39], s64 offen  lds
  s_add_u32 m0, s61, 34816
  s_add_u32 s64, s63, 147456
  buffer_load_dwordx4 v4, s[36:39], s64 offen  lds
  s_add_u32 m0, s61, 35840
  s_add_u32 s64, s63, 172032
  buffer_load_dwordx4 v5, s[36:39], s64 offen  lds
  s_add_u32 s60, s60, 1
  s_cmp_eq_u32 s60, 10
  s_cselect_b32 s60, 0, s60
  s_add_u32 s61, s61, 40960
  s_cmp_eq_u32 s61, 122880
  s_cselect_b32 s61, 0, s61
  s_waitcnt vmcnt(8)
  s_barrier
  s_mul_i32 s63, s60, 196608
  s_add_u32 m0, s61, 28672
  s_add_u32 s64, s63, 0
  buffer_load_dwordx4 v4, s[36:39], s64 offen  lds
  s_add_u32 m0, s61, 29696
  s_add_u32 s64, s63, 24576
  buffer_load_dwordx4 v5, s[36:39], s64 offen  lds
  s_add_u32 m0, s61, 30720
  s_add_u32 s64, s63, 49152
  buffer_load_dwordx4 v4, s[36:39], s64 offen  lds
  s_add_u32 m0, s61, 31744
  s_add_u32 s64, s63, 73728
  buffer_load_dwordx4 v5, s[36:39], s64 offen  lds
  s_add_u32 m0, s61, 32768
  s_add_u32 s64, s63, 98304
  buffer_load_dwordx4 v4, s[36:39], s64 offen  lds
  s_add_u32 m0, s61, 33792
  s_add_u32 s64, s63, 122880
  buffer_load_dwordx4 v5, s[36:39], s64 offen  lds
  s_add_u32 m0, s61, 34816
  s_add_u32 s64, s63, 147456
  buffer_load_dwordx4 v4, s[36:39], s64 offen  lds
  s_add_u32 m0, s61, 35840
  s_add_u32 s64, s63, 172032
  buffer_load_dwordx4 v5, s[36:39], s64 offen  lds
  s_add_u32 s60, s60, 1
  s_cmp_eq_u32 s60, 10
  s_cselect_b32 s60, 0, s60
  s_add_u32 s61, s61, 40960
  s_cmp_eq_u32 s61, 122880
  s_cselect_b32 s61, 0, s61
  s_waitcnt vmcnt(8)
  s_barrier
  s_mul_i32 s63, s60, 196608
  s_add_u32 m0, s61, 28672
  s_add_u32 s64, s63, 0
  buffer_load_dwordx4 v4, s[36:39], s64 offen  lds
  s_add_u32 m0, s61, 29696
  s_add_u32 s64, s63, 24576
  buffer_load_dwordx4 v5, s[36:39], s64 offen  lds
  s_add_u32 m0, s61, 30720
  s_add_u32 s64, s63, 49152
  buffer_load_dwordx4 v4, s[36:39], s64 offen  lds
  s_add_u32 m0, s61, 31744
  s_add_u32 s64, s63, 73728
  buffer_load_dwordx4 v5, s[36:39], s64 offen  lds
  s_add_u32 m0, s61, 32768
  s_add_u32 s64, s63, 98304
  buffer_load_dwordx4 v4, s[36:39], s64 offen  lds
  s_add_u32 m0, s61, 33792
  s_add_u32 s64, s63, 122880
  buffer_load_dwordx4 v5, s[36:39], s64 offen  lds
  s_add_u32 m0, s61, 34816
  s_add_u32 s64, s63, 147456
  buffer_load_dwordx4 v4, s[36:39], s64 offen  lds
  s_add_u32 m0, s61, 35840
  s_add_u32 s64, s63, 172032
  buffer_load_dwordx4 v5, s[36:39], s64 offen  lds
  s_add_u32 s60, s60, 1
  s_cmp_eq_u32 s60, 10
  s_cselect_b32 s60, 0, s60
  s_add_u32 s61, s61, 40960
  s_cmp_eq_u32 s61, 122880
  s_cselect_b32 s61, 0, s61
  s_waitcnt vmcnt(8)
  s_barrier
  s_mul_i32 s63, s60, 196608
  s_add_u32 m0, s61, 28672
  s_add_u32 s64, s63, 0
  buffer_load_dwordx4 v4, s[36:39], s64 offen  lds
  s_add_u32 m0, s61, 29696
  s_add_u32 s64, s63, 24576
  buffer_load_dwordx4 v5, s[36:39], s64 offen  lds
  s_add_u32 m0, s61, 30720
  s_add_u32 s64, s63, 49152
  buffer_load_dwordx4 v4, s[36:39], s64 offen  lds
  s_add_u32 m0, s61, 31744
  s_add_u32 s64, s63, 73728
  buffer_load_dwordx4 v5, s[36:39], s64 offen  lds
  s_add_u32 m0, s61, 32768
  s_add_u32 s64, s63, 98304
  buffer_load_dwordx4 v4, s[36:39], s64 offen  lds
  s_add_u32 m0, s61, 33792
  s_add_u32 s64, s63, 122880
  buffer_load_dwordx4 v5, s[36:39], s64 offen  lds
  s_add_u32 m0, s61, 34816
  s_add_u32 s64, s63, 147456
  buffer_load_dwordx4 v4, s[36:39], s64 offen  lds
  s_add_u32 m0, s61, 35840
  s_add_u32 s64, s63, 172032
  buffer_load_dwordx4 v5, s[36:39], s64 offen  lds
  s_add_u32 s60, s60, 1
  s_cmp_eq_u32 s60, 10
  s_cselect_b32 s60, 0, s60
  s_add_u32 s61, s61, 40960
  s_cmp_eq_u32 s61, 122880
  s_cselect_b32 s61, 0, s61
  s_waitcnt vmcnt(8)
  s_barrier
  s_mul_i32 s63, s60, 196608
  s_add_u32 m0, s61, 28672
  s_add_u32 s64, s63, 0
  buffer_load_dwordx4 v4, s[36:39], s64 offen  lds
  s_add_u32 m0, s61, 29696
  s_add_u32 s64, s63, 24576
  buffer_load_dwordx4 v5, s[36:39], s64 offen  lds
  s_add_u32 m0, s61, 30720
  s_add_u32 s64, s63, 49152
  buffer_load_dwordx4 v4, s[36:39], s64 offen  lds
  s_add_u32 m0, s61, 31744
  s_add_u32 s64, s63, 73728
  buffer_load_dwordx4 v5, s[36:39], s64 offen  lds
  s_add_u32 m0, s61, 32768
  s_add_u32 s64, s63, 98304
  buffer_load_dwordx4 v4, s[36:39], s64 offen  lds
  s_add_u32 m0, s61, 33792
  s_add_u32 s64, s63, 122880
  buffer_load_dwordx4 v5, s[36:39], s64 offen  lds
  s_add_u32 m0, s61, 34816
  s_add_u32 s64, s63, 147456
  buffer_load_dwordx4 v4, s[36:39], s64 offen  lds
  s_add_u32 m0, s61, 35840
  s_add_u32 s64, s63, 172032
  buffer_load_dwordx4 v5, s[36:39], s64 offen  lds
  s_add_u32 s60, s60, 1
  s_cmp_eq_u32 s60, 10
  s_cselect_b32 s60, 0, s60
  s_add_u32 s61, s61, 40960
  s_cmp_eq_u32 s61, 122880
  s_cselect_b32 s61, 0, s61
  s_waitcnt vmcnt(8)
  s_barrier
  s_mul_i32 s63, s60, 196608
  s_add_u32 m0, s61, 28672
  s_add_u32 s64, s63, 0
  buffer_load_dwordx4 v4, s[36:39], s64 offen  lds
  s_add_u32 m0, s61, 29696
  s_add_u32 s64, s63, 24576
  buffer_load_dwordx4 v5, s[36:39], s64 offen  lds
  s_add_u32 m0, s61, 30720
  s_add_u32 s64, s63, 49152
  buffer_load_dwordx4 v4, s[36:39], s64 offen  lds
  s_add_u32 m0, s61, 31744
  s_add_u32 s64, s63, 73728
  buffer_load_dwordx4 v5, s[36:39], s64 offen  lds
  s_add_u32 m0, s61, 32768
  s_add_u32 s64, s63, 98304
  buffer_load_dwordx4 v4, s[36:39], s64 offen  lds
  s_add_u32 m0, s61, 33792
  s_add_u32 s64, s63, 122880
  buffer_load_dwordx4 v5, s[36:39], s64 offen  lds
  s_add_u32 m0, s61, 34816
  s_add_u32 s64, s63, 147456
  buffer_load_dwordx4 v4, s[36:39], s64 offen  lds
  s_add_u32 m0, s61, 35840
  s_add_u32 s64, s63, 172032
  buffer_load_dwordx4 v5, s[36:39], s64 offen  lds
  s_add_u32 s60, s60, 1
  s_cmp_eq_u32 s60, 10
  s_cselect_b32 s60, 0, s60
  s_add_u32 s61, s61, 40960
  s_cmp_eq_u32 s61, 122880
  s_cselect_b32 s61, 0, s61
  s_waitcnt vmcnt(8)
  s_barrier
  s_waitcnt vmcnt(0)
  s_barrier
  s_barrier
  s_branch K2_loader
K1_ldwY:
  v_lshrrev_b32 v20, 3, v0
  s_mul_i32 s60, s29, 40
  v_add_u32 v20, s60, v20
  v_mul_u32_u24 v20, 3072, v20
  s_lshl_b32 s60, s33, 7
  v_add_u32 v20, s60, v20
  v_and_b32 v22, 7, v0
  v_lshl_add_u32 v20, v22, 4, v20
  v_lshlrev_b32 v21, 2, v22
  v_bfe_u32 v22, v0, 4, 1
  v_lshl_add_u32 v21, v22, 1, v21
  v_lshrrev_b32 v22, 5, v0
  v_add_u32 v21, v21, v22
  v_lshlrev_b32 v21, 4, v21
  s_lshl_b32 s60, s33, 4
  s_add_u32 s60, s60, s29
  s_lshl_b32 s60, s60, 9
  s_add_u32 s60, s60, 262144
  v_add_u32 v21, s60, v21
  v_add_u32 v19, 73728, v20
  s_movk_i32 s61, 0
  s_lshl_b32 s61, s61, 10
  buffer_load_dwordx4 v[24:27], v20, s[36:39], s61 offen offset:0
  s_movk_i32 s61, 24
  s_lshl_b32 s61, s61, 10
  buffer_load_dwordx4 v[28:31], v20, s[36:39], s61 offen offset:0
  s_movk_i32 s61, 48
  s_lshl_b32 s61, s61, 10
  buffer_load_dwordx4 v[32:35], v20, s[36:39], s61 offen offset:0
  s_movk_i32 s61, 72
  s_lshl_b32 s61, s61, 10
  buffer_load_dwordx4 v[36:39], v20, s[36:39], s61 offen offset:0
  s_movk_i32 s61, 96
  s_lshl_b32 s61, s61, 10
  buffer_load_dwordx4 v[40:43], v20, s[36:39], s61 offen offset:0
  s_movk_i32 s61, 0
  s_lshl_b32 s61, s61, 10
  buffer_load_dwordx4 v[44:47], v20, s[36:39], s61 offen offset:128
  s_movk_i32 s61, 24
  s_lshl_b32 s61, s61, 10
  buffer_load_dwordx4 v[48:51], v20, s[36:39], s61 offen offset:128
  s_movk_i32 s61, 48
  s_lshl_b32 s61, s61, 10
  buffer_load_dwordx4 v[52:55], v20, s[36:39], s61 offen offset:128
  s_movk_i32 s61, 72
  s_lshl_b32 s61, s61, 10
  buffer_load_dwordx4 v[56:59], v20, s[36:39], s61 offen offset:128
  s_movk_i32 s61, 96
  s_lshl_b32 s61, s61, 10
  buffer_load_dwordx4 v[60:63], v20, s[36:39], s61 offen offset:128
  s_mov_b32 s60, s34
  s_mov_b32 s61, 0
  s_mul_i32 s63, s60, 196608
  s_add_u32 m0, s61, 24576
  s_add_u32 s64, s63, 0
  buffer_load_dwordx4 v4, s[36:39], s64 offen  lds
  s_add_u32 m0, s61, 25600
  s_add_u32 s64, s63, 24576
  buffer_load_dwordx4 v5, s[36:39], s64 offen  lds
  s_add_u32 m0, s61, 26624
  s_add_u32 s64, s63, 49152
  buffer_load_dwordx4 v4, s[36:39], s64 offen  lds
  s_add_u32 m0, s61, 27648
  s_add_u32 s64, s63, 73728
  buffer_load_dwordx4 v5, s[36:39], s64 offen  lds
  s_add_u32 m0, s61, 28672
  s_add_u32 s64, s63, 98304
  buffer_load_dwordx4 v4, s[36:39], s64 offen  lds
  s_add_u32 m0, s61, 29696
  s_add_u32 s64, s63, 122880
  buffer_load_dwordx4 v5, s[36:39], s64 offen  lds
  s_add_u32 m0, s61, 30720
  s_add_u32 s64, s63, 147456
  buffer_load_dwordx4 v4, s[36:39], s64 offen  lds
  s_add_u32 m0, s61, 31744
  s_add_u32 s64, s63, 172032
  buffer_load_dwordx4 v5, s[36:39], s64 offen  lds
  s_add_u32 m0, s61, 32768
  s_add_u32 s64, s63, 128
  buffer_load_dwordx4 v4, s[36:39], s64 offen  lds
  s_add_u32 m0, s61, 33792
  s_add_u32 s64, s63, 24704
  buffer_load_dwordx4 v5, s[36:39], s64 offen  lds
  s_add_u32 m0, s61, 34816
  s_add_u32 s64, s63, 49280
  buffer_load_dwordx4 v4, s[36:39], s64 offen  lds
  s_add_u32 m0, s61, 35840
  s_add_u32 s64, s63, 73856
  buffer_load_dwordx4 v5, s[36:39], s64 offen  lds
  s_add_u32 m0, s61, 36864
  s_add_u32 s64, s63, 98432
  buffer_load_dwordx4 v4, s[36:39], s64 offen  lds
  s_add_u32 m0, s61, 37888
  s_add_u32 s64, s63, 123008
  buffer_load_dwordx4 v5, s[36:39], s64 offen  lds
  s_add_u32 m0, s61, 38912
  s_add_u32 s64, s63, 147584
  buffer_load_dwordx4 v4, s[36:39], s64 offen  lds
  s_add_u32 m0, s61, 39936
  s_add_u32 s64, s63, 172160
  buffer_load_dwordx4 v5, s[36:39], s64 offen  lds
  s_add_u32 s60, s60, 1
  s_cmp_eq_u32 s60, 10
  s_cselect_b32 s60, 0, s60
  s_add_u32 s61, s61, 40960
  s_cmp_eq_u32 s61, 122880
  s_cselect_b32 s61, 0, s61
  s_barrier
  s_waitcnt vmcnt(16)
  v_mov_b32 v23, 122912
  ds_read_b32 v23, v23
  s_waitcnt lgkmcnt(0)
  v_lshlrev_b32 v64, 16, v24
  v_and_b32 v65, 0xffff0000, v24
  v_lshlrev_b32 v66, 16, v25
  v_and_b32 v67, 0xffff0000, v25
  v_lshlrev_b32 v68, 16, v26
  v_and_b32 v69, 0xffff0000, v26
  v_lshlrev_b32 v70, 16, v27
  v_and_b32 v71, 0xffff0000, v27
  v_lshlrev_b32 v72, 16, v28
  v_and_b32 v73, 0xffff0000, v28
  v_add_f32 v64, v64, v72
  v_add_f32 v65, v65, v73
  v_lshlrev_b32 v72, 16, v29
  v_and_b32 v73, 0xffff0000, v29
  v_add_f32 v66, v66, v72
  v_add_f32 v67, v67, v73
  v_lshlrev_b32 v72, 16, v30
  v_and_b32 v73, 0xffff0000, v30
  v_add_f32 v68, v68, v72
  v_add_f32 v69, v69, v73
  v_lshlrev_b32 v72, 16, v31
  v_and_b32 v73, 0xffff0000, v31
  v_add_f32 v70, v70, v72
  v_add_f32 v71, v71, v73
  v_lshlrev_b32 v72, 16, v32
  v_and_b32 v73, 0xffff0000, v32
  v_add_f32 v64, v64, v72
  v_add_f32 v65, v65, v73
  v_lshlrev_b32 v72, 16, v33
  v_and_b32 v73, 0xffff0000, v33
  v_add_f32 v66, v66, v72
  v_add_f32 v67, v67, v73
  v_lshlrev_b32 v72, 16, v34
  v_and_b32 v73, 0xffff0000, v34
  v_add_f32 v68, v68, v72
  v_add_f32 v69, v69, v73
  v_lshlrev_b32 v72, 16, v35
  v_and_b32 v73, 0xffff0000, v35
  v_add_f32 v70, v70, v72
  v_add_f32 v71, v71, v73
  v_lshlrev_b32 v72, 16, v36
  v_and_b32 v73, 0xffff0000, v36
  v_add_f32 v64, v64, v72
  v_add_f32 v65, v65, v73
  v_lshlrev_b32 v72, 16, v37
  v_and_b32 v73, 0xffff0000, v37
  v_add_f32 v66, v66, v72
  v_add_f32 v67, v67, v73
  v_lshlrev_b32 v72, 16, v38
  v_and_b32 v73, 0xffff0000, v38
  v_add_f32 v68, v68, v72
  v_add_f32 v69, v69, v73
  v_lshlrev_b32 v72, 16, v39
  v_and_b32 v73, 0xffff0000, v39
  v_add_f32 v70, v70, v72
  v_add_f32 v71, v71, v73
  v_lshlrev_b32 v72, 16, v40
  v_and_b32 v73, 0xffff0000, v40
  v_add_f32 v64, v64, v72
  v_add_f32 v65, v65, v73
  v_lshlrev_b32 v72, 16, v41
  v_and_b32 v73, 0xffff0000, v41
  v_add_f32 v66, v66, v72
  v_add_f32 v67, v67, v73
  v_lshlrev_b32 v72, 16, v42
  v_and_b32 v73, 0xffff0000, v42
  v_add_f32 v68, v68, v72
  v_add_f32 v69, v69, v73
  v_lshlrev_b32 v72, 16, v43
  v_and_b32 v73, 0xffff0000, v43
  v_add_f32 v70, v70, v72
  v_add_f32 v71, v71, v73
  s_nop 1
  v_permlane16_swap_b32 v64, v68
  v_permlane16_swap_b32 v65, v69
  v_permlane16_swap_b32 v66, v70
  v_permlane16_swap_b32 v67, v71
  s_nop 1
  v_add_f32 v64, v64, v68
  v_add_f32 v65, v65, v69
  v_add_f32 v66, v66, v70
  v_add_f32 v67, v67, v71
  s_nop 1
  v_permlane32_swap_b32 v64, v66
  v_permlane32_swap_b32 v65, v67
  s_nop 1
  v_add_f32 v64, v64, v66
  v_add_f32 v65, v65, v67
  s_nop 1
  v_add_f32_dpp v76, v64, v64 row_ror:8 row_mask:0xf bank_mask:0xf
  v_add_f32_dpp v78, v65, v65 row_ror:8 row_mask:0xf bank_mask:0xf
  v_mov_b32 v77, v23
  v_mov_b32 v79, v23
  s_mov_b32 exec_lo, 0x00ff00ff
  s_mov_b32 exec_hi, 0x00ff00ff
  s_movk_i32 s63, 0
  buffer_store_dwordx4 v[76:79], v21, s[44:47], s63 offen sc1
  s_mov_b64 exec, -1
  s_nop 1
  v_lshlrev_b32 v64, 16, v44
  v_and_b32 v65, 0xffff0000, v44
  v_lshlrev_b32 v66, 16, v45
  v_and_b32 v67, 0xffff0000, v45
  v_lshlrev_b32 v68, 16, v46
  v_and_b32 v69, 0xffff0000, v46
  v_lshlrev_b32 v70, 16, v47
  v_and_b32 v71, 0xffff0000, v47
  v_lshlrev_b32 v72, 16, v48
  v_and_b32 v73, 0xffff0000, v48
  v_add_f32 v64, v64, v72
  v_add_f32 v65, v65, v73
  v_lshlrev_b32 v72, 16, v49
  v_and_b32 v73, 0xffff0000, v49
  v_add_f32 v66, v66, v72
  v_add_f32 v67, v67, v73
  v_lshlrev_b32 v72, 16, v50
  v_and_b32 v73, 0xffff0000, v50
  v_add_f32 v68, v68, v72
  v_add_f32 v69, v69, v73
  v_lshlrev_b32 v72, 16, v51
  v_and_b32 v73, 0xffff0000, v51
  v_add_f32 v70, v70, v72
  v_add_f32 v71, v71, v73
  v_lshlrev_b32 v72, 16, v52
  v_and_b32 v73, 0xffff0000, v52
  v_add_f32 v64, v64, v72
  v_add_f32 v65, v65, v73
  v_lshlrev_b32 v72, 16, v53
  v_and_b32 v73, 0xffff0000, v53
  v_add_f32 v66, v66, v72
  v_add_f32 v67, v67, v73
  v_lshlrev_b32 v72, 16, v54
  v_and_b32 v73, 0xffff0000, v54
  v_add_f32 v68, v68, v72
  v_add_f32 v69, v69, v73
  v_lshlrev_b32 v72, 16, v55
  v_and_b32 v73, 0xffff0000, v55
  v_add_f32 v70, v70, v72
  v_add_f32 v71, v71, v73
  v_lshlrev_b32 v72, 16, v56
  v_and_b32 v73, 0xffff0000, v56
  v_add_f32 v64, v64, v72
  v_add_f32 v65, v65, v73
  v_lshlrev_b32 v72, 16, v57
  v_and_b32 v73, 0xffff0000, v57
  v_add_f32 v66, v66, v72
  v_add_f32 v67, v67, v73
  v_lshlrev_b32 v72, 16, v58
  v_and_b32 v73, 0xffff0000, v58
  v_add_f32 v68, v68, v72
  v_add_f32 v69, v69, v73
  v_lshlrev_b32 v72, 16, v59
  v_and_b32 v73, 0xffff0000, v59
  v_add_f32 v70, v70, v72
  v_add_f32 v71, v71, v73
  v_lshlrev_b32 v72, 16, v60
  v_and_b32 v73, 0xffff0000, v60
  v_add_f32 v64, v64, v72
  v_add_f32 v65, v65, v73
  v_lshlrev_b32 v72, 16, v61
  v_and_b32 v73, 0xffff0000, v61
  v_add_f32 v66, v66, v72
  v_add_f32 v67, v67, v73
  v_lshlrev_b32 v72, 16, v62
  v_and_b32 v73, 0xffff0000, v62
  v_add_f32 v68, v68, v72
  v_add_f32 v69, v69, v73
  v_lshlrev_b32 v72, 16, v63
  v_and_b32 v73, 0xffff0000, v63
  v_add_f32 v70, v70, v72
  v_add_f32 v71, v71, v73
  s_nop 1
  v_permlane16_swap_b32 v64, v68
  v_permlane16_swap_b32 v65, v69
  v_permlane16_swap_b32 v66, v70
  v_permlane16_swap_b32 v67, v71
  s_nop 1
  v_add_f32 v64, v64, v68
  v_add_f32 v65, v65, v69
  v_add_f32 v66, v66, v70
  v_add_f32 v67, v67, v71
  s_nop 1
  v_permlane32_swap_b32 v64, v66
  v_permlane32_swap_b32 v65, v67
  s_nop 1
  v_add_f32 v64, v64, v66
  v_add_f32 v65, v65, v67
  s_nop 1
  v_add_f32_dpp v76, v64, v64 row_ror:8 row_mask:0xf bank_mask:0xf
  v_add_f32_dpp v78, v65, v65 row_ror:8 row_mask:0xf bank_mask:0xf
  v_mov_b32 v77, v23
  v_mov_b32 v79, v23
  s_mov_b32 exec_lo, 0x00ff00ff
  s_mov_b32 exec_hi, 0x00ff00ff
  s_movk_i32 s63, 8192
  buffer_store_dwordx4 v[76:79], v21, s[44:47], s63 offen sc1
  s_mov_b64 exec, -1
  s_nop 1
  s_mul_i32 s63, s60, 196608
  s_add_u32 m0, s61, 24576
  s_add_u32 s64, s63, 0
  buffer_load_dwordx4 v4, s[36:39], s64 offen  lds
  s_add_u32 m0, s61, 25600
  s_add_u32 s64, s63, 24576
  buffer_load_dwordx4 v5, s[36:39], s64 offen  lds
  s_add_u32 m0, s61, 26624
  s_add_u32 s64, s63, 49152
  buffer_load_dwordx4 v4, s[36:39], s64 offen  lds
  s_add_u32 m0, s61, 27648
  s_add_u32 s64, s63, 73728
  buffer_load_dwordx4 v5, s[36:39], s64 offen  lds
  s_add_u32 m0, s61, 28672
  s_add_u32 s64, s63, 98304
  buffer_load_dwordx4 v4, s[36:39], s64 offen  lds
  s_add_u32 m0, s61, 29696
  s_add_u32 s64, s63, 122880
  buffer_load_dwordx4 v5, s[36:39], s64 offen  lds
  s_add_u32 m0, s61, 30720
  s_add_u32 s64, s63, 147456
  buffer_load_dwordx4 v4, s[36:39], s64 offen  lds
  s_add_u32 m0, s61, 31744
  s_add_u32 s64, s63, 172032
  buffer_load_dwordx4 v5, s[36:39], s64 offen  lds
  s_add_u32 m0, s61, 32768
  s_add_u32 s64, s63, 128
  buffer_load_dwordx4 v4, s[36:39], s64 offen  lds
  s_add_u32 m0, s61, 33792
  s_add_u32 s64, s63, 24704
  buffer_load_dwordx4 v5, s[36:39], s64 offen  lds
  s_add_u32 m0, s61, 34816
  s_add_u32 s64, s63, 49280
  buffer_load_dwordx4 v4, s[36:39], s64 offen  lds
  s_add_u32 m0, s61, 35840
  s_add_u32 s64, s63, 73856
  buffer_load_dwordx4 v5, s[36:39], s64 offen  lds
  s_add_u32 m0, s61, 36864
  s_add_u32 s64, s63, 98432
  buffer_load_dwordx4 v4, s[36:39], s64 offen  lds
  s_add_u32 m0, s61, 37888
  s_add_u32 s64, s63, 123008
  buffer_load_dwordx4 v5, s[36:39], s64 offen  lds
  s_add_u32 m0, s61, 38912
  s_add_u32 s64, s63, 147584
  buffer_load_dwordx4 v4, s[36:39], s64 offen  lds
  s_add_u32 m0, s61, 39936
  s_add_u32 s64, s63, 172160
  buffer_load_dwordx4 v5, s[36:39], s64 offen  lds
  s_add_u32 s60, s60, 1
  s_cmp_eq_u32 s60, 10
  s_cselect_b32 s60, 0, s60
  s_add_u32 s61, s61, 40960
  s_cmp_eq_u32 s61, 122880
  s_cselect_b32 s61, 0, s61
  s_waitcnt vmcnt(18)
  s_barrier
  s_mul_i32 s63, s60, 196608
  s_add_u32 m0, s61, 24576
  s_add_u32 s64, s63, 0
  buffer_load_dwordx4 v4, s[36:39], s64 offen  lds
  s_add_u32 m0, s61, 25600
  s_add_u32 s64, s63, 24576
  buffer_load_dwordx4 v5, s[36:39], s64 offen  lds
  s_add_u32 m0, s61, 26624
  s_add_u32 s64, s63, 49152
  buffer_load_dwordx4 v4, s[36:39], s64 offen  lds
  s_add_u32 m0, s61, 27648
  s_add_u32 s64, s63, 73728
  buffer_load_dwordx4 v5, s[36:39], s64 offen  lds
  s_add_u32 m0, s61, 28672
  s_add_u32 s64, s63, 98304
  buffer_load_dwordx4 v4, s[36:39], s64 offen  lds
  s_add_u32 m0, s61, 29696
  s_add_u32 s64, s63, 122880
  buffer_load_dwordx4 v5, s[36:39], s64 offen  lds
  s_add_u32 m0, s61, 30720
  s_add_u32 s64, s63, 147456
  buffer_load_dwordx4 v4, s[36:39], s64 offen  lds
  s_add_u32 m0, s61, 31744
  s_add_u32 s64, s63, 172032
  buffer_load_dwordx4 v5, s[36:39], s64 offen  lds
  s_add_u32 m0, s61, 32768
  s_add_u32 s64, s63, 128
  buffer_load_dwordx4 v4, s[36:39], s64 offen  lds
  s_add_u32 m0, s61, 33792
  s_add_u32 s64, s63, 24704
  buffer_load_dwordx4 v5, s[36:39], s64 offen  lds
  s_add_u32 m0, s61, 34816
  s_add_u32 s64, s63, 49280
  buffer_load_dwordx4 v4, s[36:39], s64 offen  lds
  s_add_u32 m0, s61, 35840
  s_add_u32 s64, s63, 73856
  buffer_load_dwordx4 v5, s[36:39], s64 offen  lds
  s_add_u32 m0, s61, 36864
  s_add_u32 s64, s63, 98432
  buffer_load_dwordx4 v4, s[36:39], s64 offen  lds
  s_add_u32 m0, s61, 37888
  s_add_u32 s64, s63, 123008
  buffer_load_dwordx4 v5, s[36:39], s64 offen  lds
  s_add_u32 m0, s61, 38912
  s_add_u32 s64, s63, 147584
  buffer_load_dwordx4 v4, s[36:39], s64 offen  lds
  s_add_u32 m0, s61, 39936
  s_add_u32 s64, s63, 172160
  buffer_load_dwordx4 v5, s[36:39], s64 offen  lds
  s_add_u32 s60, s60, 1
  s_cmp_eq_u32 s60, 10
  s_cselect_b32 s60, 0, s60
  s_add_u32 s61, s61, 40960
  s_cmp_eq_u32 s61, 122880
  s_cselect_b32 s61, 0, s61
  s_waitcnt vmcnt(16)
  s_barrier
  s_mul_i32 s63, s60, 196608
  s_add_u32 m0, s61, 24576
  s_add_u32 s64, s63, 0
  buffer_load_dwordx4 v4, s[36:39], s64 offen  lds
  s_add_u32 m0, s61, 25600
  s_add_u32 s64, s63, 24576
  buffer_load_dwordx4 v5, s[36:39], s64 offen  lds
  s_add_u32 m0, s61, 26624
  s_add_u32 s64, s63, 49152
  buffer_load_dwordx4 v4, s[36:39], s64 offen  lds
  s_add_u32 m0, s61, 27648
  s_add_u32 s64, s63, 73728
  buffer_load_dwordx4 v5, s[36:39], s64 offen  lds
  s_add_u32 m0, s61, 28672
  s_add_u32 s64, s63, 98304
  buffer_load_dwordx4 v4, s[36:39], s64 offen  lds
  s_add_u32 m0, s61, 29696
  s_add_u32 s64, s63, 122880
  buffer_load_dwordx4 v5, s[36:39], s64 offen  lds
  s_add_u32 m0, s61, 30720
  s_add_u32 s64, s63, 147456
  buffer_load_dwordx4 v4, s[36:39], s64 offen  lds
  s_add_u32 m0, s61, 31744
  s_add_u32 s64, s63, 172032
  buffer_load_dwordx4 v5, s[36:39], s64 offen  lds
  s_add_u32 m0, s61, 32768
  s_add_u32 s64, s63, 128
  buffer_load_dwordx4 v4, s[36:39], s64 offen  lds
  s_add_u32 m0, s61, 33792
  s_add_u32 s64, s63, 24704
  buffer_load_dwordx4 v5, s[36:39], s64 offen  lds
  s_add_u32 m0, s61, 34816
  s_add_u32 s64, s63, 49280
  buffer_load_dwordx4 v4, s[36:39], s64 offen  lds
  s_add_u32 m0, s61, 35840
  s_add_u32 s64, s63, 73856
  buffer_load_dwordx4 v5, s[36:39], s64 offen  lds
  s_add_u32 m0, s61, 36864
  s_add_u32 s64, s63, 98432
  buffer_load_dwordx4 v4, s[36:39], s64 offen  lds
  s_add_u32 m0, s61, 37888
  s_add_u32 s64, s63, 123008
  buffer_load_dwordx4 v5, s[36:39], s64 offen  lds
  s_add_u32 m0, s61, 38912
  s_add_u32 s64, s63, 147584
  buffer_load_dwordx4 v4, s[36:39], s64 offen  lds
  s_add_u32 m0, s61, 39936
  s_add_u32 s64, s63, 172160
  buffer_load_dwordx4 v5, s[36:39], s64 offen  lds
  s_add_u32 s60, s60, 1
  s_cmp_eq_u32 s60, 10
  s_cselect_b32 s60, 0, s60
  s_add_u32 s61, s61, 40960
  s_cmp_eq_u32 s61, 122880
  s_cselect_b32 s61, 0, s61
  s_waitcnt vmcnt(16)
  s_barrier
  s_mul_i32 s63, s60, 196608
  s_add_u32 m0, s61, 24576
  s_add_u32 s64, s63, 0
  buffer_load_dwordx4 v4, s[36:39], s64 offen  lds
  s_add_u32 m0, s61, 25600
  s_add_u32 s64, s63, 24576
  buffer_load_dwordx4 v5, s[36:39], s64 offen  lds
  s_add_u32 m0, s61, 26624
  s_add_u32 s64, s63, 49152
  buffer_load_dwordx4 v4, s[36:39], s64 offen  lds
  s_add_u32 m0, s61, 27648
  s_add_u32 s64, s63, 73728
  buffer_load_dwordx4 v5, s[36:39], s64 offen  lds
  s_add_u32 m0, s61, 28672
  s_add_u32 s64, s63, 98304
  buffer_load_dwordx4 v4, s[36:39], s64 offen  lds
  s_add_u32 m0, s61, 29696
  s_add_u32 s64, s63, 122880
  buffer_load_dwordx4 v5, s[36:39], s64 offen  lds
  s_add_u32 m0, s61, 30720
  s_add_u32 s64, s63, 147456
  buffer_load_dwordx4 v4, s[36:39], s64 offen  lds
  s_add_u32 m0, s61, 31744
  s_add_u32 s64, s63, 172032
  buffer_load_dwordx4 v5, s[36:39], s64 offen  lds
  s_add_u32 m0, s61, 32768
  s_add_u32 s64, s63, 128
  buffer_load_dwordx4 v4, s[36:39], s64 offen  lds
  s_add_u32 m0, s61, 33792
  s_add_u32 s64, s63, 24704
  buffer_load_dwordx4 v5, s[36:39], s64 offen  lds
  s_add_u32 m0, s61, 34816
  s_add_u32 s64, s63, 49280
  buffer_load_dwordx4 v4, s[36:39], s64 offen  lds
  s_add_u32 m0, s61, 35840
  s_add_u32 s64, s63, 73856
  buffer_load_dwordx4 v5, s[36:39], s64 offen  lds
  s_add_u32 m0, s61, 36864
  s_add_u32 s64, s63, 98432
  buffer_load_dwordx4 v4, s[36:39], s64 offen  lds
  s_add_u32 m0, s61, 37888
  s_add_u32 s64, s63, 123008
  buffer_load_dwordx4 v5, s[36:39], s64 offen  lds
  s_add_u32 m0, s61, 38912
  s_add_u32 s64, s63, 147584
  buffer_load_dwordx4 v4, s[36:39], s64 offen  lds
  s_add_u32 m0, s61, 39936
  s_add_u32 s64, s63, 172160
  buffer_load_dwordx4 v5, s[36:39], s64 offen  lds
  s_add_u32 s60, s60, 1
  s_cmp_eq_u32 s60, 10
  s_cselect_b32 s60, 0, s60
  s_add_u32 s61, s61, 40960
  s_cmp_eq_u32 s61, 122880
  s_cselect_b32 s61, 0, s61
  s_waitcnt vmcnt(16)
  s_barrier
  s_mul_i32 s63, s60, 196608
  s_add_u32 m0, s61, 24576
  s_add_u32 s64, s63, 0
  buffer_load_dwordx4 v4, s[36:39], s64 offen  lds
  s_add_u32 m0, s61, 25600
  s_add_u32 s64, s63, 24576
  buffer_load_dwordx4 v5, s[36:39], s64 offen  lds
  s_add_u32 m0, s61, 26624
  s_add_u32 s64, s63, 49152
  buffer_load_dwordx4 v4, s[36:39], s64 offen  lds
  s_add_u32 m0, s61, 27648
  s_add_u32 s64, s63, 73728
  buffer_load_dwordx4 v5, s[36:39], s64 offen  lds
  s_add_u32 m0, s61, 28672
  s_add_u32 s64, s63, 98304
  buffer_load_dwordx4 v4, s[36:39], s64 offen  lds
  s_add_u32 m0, s61, 29696
  s_add_u32 s64, s63, 122880
  buffer_load_dwordx4 v5, s[36:39], s64 offen  lds
  s_add_u32 m0, s61, 30720
  s_add_u32 s64, s63, 147456
  buffer_load_dwordx4 v4, s[36:39], s64 offen  lds
  s_add_u32 m0, s61, 31744
  s_add_u32 s64, s63, 172032
  buffer_load_dwordx4 v5, s[36:39], s64 offen  lds
  s_add_u32 m0, s61, 32768
  s_add_u32 s64, s63, 128
  buffer_load_dwordx4 v4, s[36:39], s64 offen  lds
  s_add_u32 m0, s61, 33792
  s_add_u32 s64, s63, 24704
  buffer_load_dwordx4 v5, s[36:39], s64 offen  lds
  s_add_u32 m0, s61, 34816
  s_add_u32 s64, s63, 49280
  buffer_load_dwordx4 v4, s[36:39], s64 offen  lds
  s_add_u32 m0, s61, 35840
  s_add_u32 s64, s63, 73856
  buffer_load_dwordx4 v5, s[36:39], s64 offen  lds
  s_add_u32 m0, s61, 36864
  s_add_u32 s64, s63, 98432
  buffer_load_dwordx4 v4, s[36:39], s64 offen  lds
  s_add_u32 m0, s61, 37888
  s_add_u32 s64, s63, 123008
  buffer_load_dwordx4 v5, s[36:39], s64 offen  lds
  s_add_u32 m0, s61, 38912
  s_add_u32 s64, s63, 147584
  buffer_load_dwordx4 v4, s[36:39], s64 offen  lds
  s_add_u32 m0, s61, 39936
  s_add_u32 s64, s63, 172160
  buffer_load_dwordx4 v5, s[36:39], s64 offen  lds
  s_add_u32 s60, s60, 1
  s_cmp_eq_u32 s60, 10
  s_cselect_b32 s60, 0, s60
  s_add_u32 s61, s61, 40960
  s_cmp_eq_u32 s61, 122880
  s_cselect_b32 s61, 0, s61
  s_waitcnt vmcnt(16)
  s_barrier
  s_mul_i32 s63, s60, 196608
  s_add_u32 m0, s61, 24576
  s_add_u32 s64, s63, 0
  buffer_load_dwordx4 v4, s[36:39], s64 offen  lds
  s_add_u32 m0, s61, 25600
  s_add_u32 s64, s63, 24576
  buffer_load_dwordx4 v5, s[36:39], s64 offen  lds
  s_add_u32 m0, s61, 26624
  s_add_u32 s64, s63, 49152
  buffer_load_dwordx4 v4, s[36:39], s64 offen  lds
  s_add_u32 m0, s61, 27648
  s_add_u32 s64, s63, 73728
  buffer_load_dwordx4 v5, s[36:39], s64 offen  lds
  s_add_u32 m0, s61, 28672
  s_add_u32 s64, s63, 98304
  buffer_load_dwordx4 v4, s[36:39], s64 offen  lds
  s_add_u32 m0, s61, 29696
  s_add_u32 s64, s63, 122880
  buffer_load_dwordx4 v5, s[36:39], s64 offen  lds
  s_add_u32 m0, s61, 30720
  s_add_u32 s64, s63, 147456
  buffer_load_dwordx4 v4, s[36:39], s64 offen  lds
  s_add_u32 m0, s61, 31744
  s_add_u32 s64, s63, 172032
  buffer_load_dwordx4 v5, s[36:39], s64 offen  lds
  s_add_u32 m0, s61, 32768
  s_add_u32 s64, s63, 128
  buffer_load_dwordx4 v4, s[36:39], s64 offen  lds
  s_add_u32 m0, s61, 33792
  s_add_u32 s64, s63, 24704
  buffer_load_dwordx4 v5, s[36:39], s64 offen  lds
  s_add_u32 m0, s61, 34816
  s_add_u32 s64, s63, 49280
  buffer_load_dwordx4 v4, s[36:39], s64 offen  lds
  s_add_u32 m0, s61, 35840
  s_add_u32 s64, s63, 73856
  buffer_load_dwordx4 v5, s[36:39], s64 offen  lds
  s_add_u32 m0, s61, 36864
  s_add_u32 s64, s63, 98432
  buffer_load_dwordx4 v4, s[36:39], s64 offen  lds
  s_add_u32 m0, s61, 37888
  s_add_u32 s64, s63, 123008
  buffer_load_dwordx4 v5, s[36:39], s64 offen  lds
  s_add_u32 m0, s61, 38912
  s_add_u32 s64, s63, 147584
  buffer_load_dwordx4 v4, s[36:39], s64 offen  lds
  s_add_u32 m0, s61, 39936
  s_add_u32 s64, s63, 172160
  buffer_load_dwordx4 v5, s[36:39], s64 offen  lds
  s_add_u32 s60, s60, 1
  s_cmp_eq_u32 s60, 10
  s_cselect_b32 s60, 0, s60
  s_add_u32 s61, s61, 40960
  s_cmp_eq_u32 s61, 122880
  s_cselect_b32 s61, 0, s61
  s_waitcnt vmcnt(16)
  s_barrier
  s_mul_i32 s63, s60, 196608
  s_add_u32 m0, s61, 24576
  s_add_u32 s64, s63, 0
  buffer_load_dwordx4 v4, s[36:39], s64 offen  lds
  s_add_u32 m0, s61, 25600
  s_add_u32 s64, s63, 24576
  buffer_load_dwordx4 v5, s[36:39], s64 offen  lds
  s_add_u32 m0, s61, 26624
  s_add_u32 s64, s63, 49152
  buffer_load_dwordx4 v4, s[36:39], s64 offen  lds
  s_add_u32 m0, s61, 27648
  s_add_u32 s64, s63, 73728
  buffer_load_dwordx4 v5, s[36:39], s64 offen  lds
  s_add_u32 m0, s61, 28672
  s_add_u32 s64, s63, 98304
  buffer_load_dwordx4 v4, s[36:39], s64 offen  lds
  s_add_u32 m0, s61, 29696
  s_add_u32 s64, s63, 122880
  buffer_load_dwordx4 v5, s[36:39], s64 offen  lds
  s_add_u32 m0, s61, 30720
  s_add_u32 s64, s63, 147456
  buffer_load_dwordx4 v4, s[36:39], s64 offen  lds
  s_add_u32 m0, s61, 31744
  s_add_u32 s64, s63, 172032
  buffer_load_dwordx4 v5, s[36:39], s64 offen  lds
  s_add_u32 m0, s61, 32768
  s_add_u32 s64, s63, 128
  buffer_load_dwordx4 v4, s[36:39], s64 offen  lds
  s_add_u32 m0, s61, 33792
  s_add_u32 s64, s63, 24704
  buffer_load_dwordx4 v5, s[36:39], s64 offen  lds
  s_add_u32 m0, s61, 34816
  s_add_u32 s64, s63, 49280
  buffer_load_dwordx4 v4, s[36:39], s64 offen  lds
  s_add_u32 m0, s61, 35840
  s_add_u32 s64, s63, 73856
  buffer_load_dwordx4 v5, s[36:39], s64 offen  lds
  s_add_u32 m0, s61, 36864
  s_add_u32 s64, s63, 98432
  buffer_load_dwordx4 v4, s[36:39], s64 offen  lds
  s_add_u32 m0, s61, 37888
  s_add_u32 s64, s63, 123008
  buffer_load_dwordx4 v5, s[36:39], s64 offen  lds
  s_add_u32 m0, s61, 38912
  s_add_u32 s64, s63, 147584
  buffer_load_dwordx4 v4, s[36:39], s64 offen  lds
  s_add_u32 m0, s61, 39936
  s_add_u32 s64, s63, 172160
  buffer_load_dwordx4 v5, s[36:39], s64 offen  lds
  s_add_u32 s60, s60, 1
  s_cmp_eq_u32 s60, 10
  s_cselect_b32 s60, 0, s60
  s_add_u32 s61, s61, 40960
  s_cmp_eq_u32 s61, 122880
  s_cselect_b32 s61, 0, s61
  s_waitcnt vmcnt(16)
  s_barrier
  s_mul_i32 s63, s60, 196608
  s_add_u32 m0, s61, 24576
  s_add_u32 s64, s63, 0
  buffer_load_dwordx4 v4, s[36:39], s64 offen  lds
  s_add_u32 m0, s61, 25600
  s_add_u32 s64, s63, 24576
  buffer_load_dwordx4 v5, s[36:39], s64 offen  lds
  s_add_u32 m0, s61, 26624
  s_add_u32 s64, s63, 49152
  buffer_load_dwordx4 v4, s[36:39], s64 offen  lds
  s_add_u32 m0, s61, 27648
  s_add_u32 s64, s63, 73728
  buffer_load_dwordx4 v5, s[36:39], s64 offen  lds
  s_add_u32 m0, s61, 28672
  s_add_u32 s64, s63, 98304
  buffer_load_dwordx4 v4, s[36:39], s64 offen  lds
  s_add_u32 m0, s61, 29696
  s_add_u32 s64, s63, 122880
  buffer_load_dwordx4 v5, s[36:39], s64 offen  lds
  s_add_u32 m0, s61, 30720
  s_add_u32 s64, s63, 147456
  buffer_load_dwordx4 v4, s[36:39], s64 offen  lds
  s_add_u32 m0, s61, 31744
  s_add_u32 s64, s63, 172032
  buffer_load_dwordx4 v5, s[36:39], s64 offen  lds
  s_add_u32 m0, s61, 32768
  s_add_u32 s64, s63, 128
  buffer_load_dwordx4 v4, s[36:39], s64 offen  lds
  s_add_u32 m0, s61, 33792
  s_add_u32 s64, s63, 24704
  buffer_load_dwordx4 v5, s[36:39], s64 offen  lds
  s_add_u32 m0, s61, 34816
  s_add_u32 s64, s63, 49280
  buffer_load_dwordx4 v4, s[36:39], s64 offen  lds
  s_add_u32 m0, s61, 35840
  s_add_u32 s64, s63, 73856
  buffer_load_dwordx4 v5, s[36:39], s64 offen  lds
  s_add_u32 m0, s61, 36864
  s_add_u32 s64, s63, 98432
  buffer_load_dwordx4 v4, s[36:39], s64 offen  lds
  s_add_u32 m0, s61, 37888
  s_add_u32 s64, s63, 123008
  buffer_load_dwordx4 v5, s[36:39], s64 offen  lds
  s_add_u32 m0, s61, 38912
  s_add_u32 s64, s63, 147584
  buffer_load_dwordx4 v4, s[36:39], s64 offen  lds
  s_add_u32 m0, s61, 39936
  s_add_u32 s64, s63, 172160
  buffer_load_dwordx4 v5, s[36:39], s64 offen  lds
  s_add_u32 s60, s60, 1
  s_cmp_eq_u32 s60, 10
  s_cselect_b32 s60, 0, s60
  s_add_u32 s61, s61, 40960
  s_cmp_eq_u32 s61, 122880
  s_cselect_b32 s61, 0, s61
  s_waitcnt vmcnt(16)
  s_barrier
  s_mul_i32 s63, s60, 196608
  s_add_u32 m0, s61, 24576
  s_add_u32 s64, s63, 0
  buffer_load_dwordx4 v4, s[36:39], s64 offen  lds
  s_add_u32 m0, s61, 25600
  s_add_u32 s64, s63, 24576
  buffer_load_dwordx4 v5, s[36:39], s64 offen  lds
  s_add_u32 m0, s61, 26624
  s_add_u32 s64, s63, 49152
  buffer_load_dwordx4 v4, s[36:39], s64 offen  lds
  s_add_u32 m0, s61, 27648
  s_add_u32 s64, s63, 73728
  buffer_load_dwordx4 v5, s[36:39], s64 offen  lds
  s_add_u32 m0, s61, 28672
  s_add_u32 s64, s63, 98304
  buffer_load_dwordx4 v4, s[36:39], s64 offen  lds
  s_add_u32 m0, s61, 29696
  s_add_u32 s64, s63, 122880
  buffer_load_dwordx4 v5, s[36:39], s64 offen  lds
  s_add_u32 m0, s61, 30720
  s_add_u32 s64, s63, 147456
  buffer_load_dwordx4 v4, s[36:39], s64 offen  lds
  s_add_u32 m0, s61, 31744
  s_add_u32 s64, s63, 172032
  buffer_load_dwordx4 v5, s[36:39], s64 offen  lds
  s_add_u32 m0, s61, 32768
  s_add_u32 s64, s63, 128
  buffer_load_dwordx4 v4, s[36:39], s64 offen  lds
  s_add_u32 m0, s61, 33792
  s_add_u32 s64, s63, 24704
  buffer_load_dwordx4 v5, s[36:39], s64 offen  lds
  s_add_u32 m0, s61, 34816
  s_add_u32 s64, s63, 49280
  buffer_load_dwordx4 v4, s[36:39], s64 offen  lds
  s_add_u32 m0, s61, 35840
  s_add_u32 s64, s63, 73856
  buffer_load_dwordx4 v5, s[36:39], s64 offen  lds
  s_add_u32 m0, s61, 36864
  s_add_u32 s64, s63, 98432
  buffer_load_dwordx4 v4, s[36:39], s64 offen  lds
  s_add_u32 m0, s61, 37888
  s_add_u32 s64, s63, 123008
  buffer_load_dwordx4 v5, s[36:39], s64 offen  lds
  s_add_u32 m0, s61, 38912
  s_add_u32 s64, s63, 147584
  buffer_load_dwordx4 v4, s[36:39], s64 offen  lds
  s_add_u32 m0, s61, 39936
  s_add_u32 s64, s63, 172160
  buffer_load_dwordx4 v5, s[36:39], s64 offen  lds
  s_add_u32 s60, s60, 1
  s_cmp_eq_u32 s60, 10
  s_cselect_b32 s60, 0, s60
  s_add_u32 s61, s61, 40960
  s_cmp_eq_u32 s61, 122880
  s_cselect_b32 s61, 0, s61
  s_waitcnt vmcnt(16)
  s_barrier
  s_waitcnt vmcnt(0)
  s_barrier
  s_barrier
  s_branch K2_loader
K1_relay:
  s_endpgm
K1_compute:
  s_add_u32 s40, s12, 1048576
  s_addc_u32 s41, s13, 0
  s_and_b32 s41, s41, 0xffff
  s_mov_b32 s42, 11534336
  s_mov_b32 s43, 0x20000
  s_mov_b32 s44, s12
  s_and_b32 s45, s13, 0xffff
  s_mov_b32 s46, 1048576
  s_mov_b32 s47, 0x20000

  s_and_b32 s66, s28, 1
  s_lshr_b32 s69, s28, 1
  v_and_b32 v1, 15, v0
  v_lshlrev_b32 v1, 7, v1
  v_lshrrev_b32 v8, 4, v0
  v_bfe_u32 v9, v0, 1, 3
  v_xor_b32 v9, v8, v9
  v_lshl_add_u32 v1, v9, 4, v1
  s_lshl_b32 s60, s66, 13
  v_add_u32 v2, s60, v1
  v_xor_b32 v3, 64, v2
  s_lshl_b32 s60, s29, 1
  s_add_u32 s60, s60, s66
  s_mul_i32 s60, s60, 360448
  v_lshlrev_b32 v10, 4, v0
  v_add_u32 v10, s60, v10
  s_cmp_eq_u32 s31, 1
  s_cselect_b32 s67, s69, s69
  s_lshl_b32 s60, s67, 12
  s_add_u32 s60, s60, 16384
  v_add_u32 v4, s60, v1
  v_xor_b32 v5, 64, v4
  s_add_u32 s68, s32, s67
  s_add_u32 s68, s68, 48
  s_lshl_b32 s68, s68, 10
  s_cmp_eq_u32 s31, 0
  s_cselect_b32 s60, s69, 0
  s_cmp_lg_u32 s60, 0
  s_cbranch_scc1 K1_Q

  s_mul_i32 s64, s69, s31
  s_add_u32 s65, s33, s64
  s_lshl_b32 s65, s65, 11
  s_lshl_b32 s60, s64, 13
  s_movk_i32 s61, 28672
  s_cmp_eq_u32 s31, 1
  s_cselect_b32 s61, 24576, s61
  s_add_u32 s60, s60, s61
  s_lshl_b32 s64, s64, 8
  v_and_b32 v1, 15, v0
  v_lshrrev_b32 v9, 2, v1
  v_lshl_add_u32 v9, v8, 3, v9
  v_lshlrev_b32 v9, 7, v9
  v_and_b32 v7, 3, v1
  v_lshl_add_u32 v9, v7, 3, v9
  v_bfe_u32 v7, v1, 3, 1
  v_and_b32 v1, 1, v8
  v_lshl_add_u32 v7, v1, 1, v7
  v_lshl_add_u32 v9, v7, 5, v9
  v_add_u32 v6, s60, v9
  v_xor_b32 v7, 32, v6
  v_xor_b32 v8, 64, v6
  v_xor_b32 v9, 96, v6

  v_mov_b32 v12, 0
  v_mov_b32 v13, 0
  v_mov_b32 v14, 0
  v_mov_b32 v15, 0
  v_mov_b32 v16, 0
  v_mov_b32 v17, 0
  v_mov_b32 v18, 0
  v_mov_b32 v19, 0
  v_mov_b32 v20, 0
  v_mov_b32 v21, 0
  v_mov_b32 v22, 0
  v_mov_b32 v23, 0
  v_mov_b32 v24, 0
  v_mov_b32 v25, 0
  v_mov_b32 v26, 0
  v_mov_b32 v27, 0
  v_mov_b32 v28, 0
  v_mov_b32 v29, 0
  v_mov_b32 v30, 0
  v_mov_b32 v31, 0
  v_mov_b32 v32, 0
  v_mov_b32 v33, 0
  v_mov_b32 v34, 0
  v_mov_b32 v35, 0
  v_mov_b32 v36, 0
  v_mov_b32 v37, 0
  v_mov_b32 v38, 0
  v_mov_b32 v39, 0
  v_mov_b32 v40, 0
  v_mov_b32 v41, 0
  v_mov_b32 v42, 0
  v_mov_b32 v43, 0
  v_mov_b32 v44, 0
  v_mov_b32 v45, 0
  v_mov_b32 v46, 0
  v_mov_b32 v47, 0
  v_mov_b32 v48, 0
  v_mov_b32 v49, 0
  v_mov_b32 v50, 0
  v_mov_b32 v51, 0
  v_mov_b32 v52, 0
  v_mov_b32 v53, 0
  v_mov_b32 v54, 0
  v_mov_b32 v55, 0
  v_mov_b32 v56, 0
  v_mov_b32 v57, 0
  v_mov_b32 v58, 0
  v_mov_b32 v59, 0
  v_mov_b32 v60, 0
  v_mov_b32 v61, 0
  v_mov_b32 v62, 0
  v_mov_b32 v63, 0
  v_mov_b32 v64, 0
  v_mov_b32 v65, 0
  v_mov_b32 v66, 0
  v_mov_b32 v67, 0
  v_mov_b32 v68, 0
  v_mov_b32 v69, 0
  v_mov_b32 v70, 0
  v_mov_b32 v71, 0
  v_mov_b32 v72, 0
  v_mov_b32 v73, 0
  v_mov_b32 v74, 0
  v_mov_b32 v75, 0
  v_mov_b32 v76, 0
  v_mov_b32 v77, 0
  v_mov_b32 v78, 0
  v_mov_b32 v79, 0
  v_mov_b32 v80, 0
  v_mov_b32 v81, 0
  v_mov_b32 v82, 0
  v_mov_b32 v83, 0
  v_mov_b32 v84, 0
  v_mov_b32 v85, 0
  v_mov_b32 v86, 0
  v_mov_b32 v87, 0
  v_mov_b32 v88, 0
  v_mov_b32 v89, 0
  v_mov_b32 v90, 0
  v_mov_b32 v91, 0
  v_mov_b32 v92, 0
  v_mov_b32 v93, 0
  v_mov_b32 v94, 0
  v_mov_b32 v95, 0
  v_mov_b32 v96, 0
  v_mov_b32 v97, 0
  v_mov_b32 v98, 0
  v_mov_b32 v99, 0
  v_mov_b32 v100, 0
  v_mov_b32 v101, 0
  v_mov_b32 v102, 0
  v_mov_b32 v103, 0
  v_mov_b32 v104, 0
  v_mov_b32 v105, 0
  v_mov_b32 v106, 0
  v_mov_b32 v107, 0
  s_barrier
  s_barrier
  ds_read_b128 v[108:111], v2
  ds_read_b128 v[124:127], v4 offset:0
  ds_read_b128 v[128:131], v4 offset:2048
  ds_read_b128 v[112:115], v2 offset:2048
  ds_read_b128 v[116:119], v2 offset:4096
  ds_read_b128 v[120:123], v2 offset:6144
  ds_read_b64_tr_b16 v[132:133], v6 offset:0
  ds_read_b64_tr_b16 v[134:135], v6 offset:512
  ds_read_b64_tr_b16 v[136:137], v7 offset:0
  ds_read_b64_tr_b16 v[138:139], v7 offset:512
  ds_read_b64_tr_b16 v[140:141], v8 offset:0
  ds_read_b64_tr_b16 v[142:143], v8 offset:512
  ds_read_b64_tr_b16 v[144:145], v9 offset:0
  ds_read_b64_tr_b16 v[146:147], v9 offset:512
  s_waitcnt lgkmcnt(0)
  v_mfma_f32_16x16x32_bf16 v[12:15], v[108:111], v[124:127], v[12:15]
  ds_read_b128 v[148:151], v3
  v_mfma_f32_16x16x32_bf16 v[28:31], v[108:111], v[128:131], v[28:31]
  ds_read_b128 v[164:167], v5 offset:0
  v_mfma_f32_16x16x32_bf16 v[16:19], v[112:115], v[124:127], v[16:19]
  ds_read_b128 v[168:171], v5 offset:2048
  v_mfma_f32_16x16x32_bf16 v[32:35], v[112:115], v[128:131], v[32:35]
  ds_read_b128 v[152:155], v3 offset:2048
  v_mfma_f32_16x16x32_bf16 v[20:23], v[116:119], v[124:127], v[20:23]
  ds_read_b128 v[156:159], v3 offset:4096
  v_mfma_f32_16x16x32_bf16 v[36:39], v[116:119], v[128:131], v[36:39]
  ds_read_b128 v[160:163], v3 offset:6144
  v_mfma_f32_16x16x32_bf16 v[24:27], v[120:123], v[124:127], v[24:27]
  ds_read_b64_tr_b16 v[172:173], v6 offset:4096
  v_mfma_f32_16x16x32_bf16 v[40:43], v[120:123], v[128:131], v[40:43]
  ds_read_b64_tr_b16 v[174:175], v6 offset:4608
  v_mfma_f32_16x16x32_bf16 v[44:47], v[132:135], v[108:111], v[44:47]
  ds_read_b64_tr_b16 v[176:177], v7 offset:4096
  v_mfma_f32_16x16x32_bf16 v[48:51], v[132:135], v[112:115], v[48:51]
  ds_read_b64_tr_b16 v[178:179], v7 offset:4608
  v_mfma_f32_16x16x32_bf16 v[52:55], v[132:135], v[116:119], v[52:55]
  ds_read_b64_tr_b16 v[180:181], v8 offset:4096
  v_mfma_f32_16x16x32_bf16 v[56:59], v[132:135], v[120:123], v[56:59]
  ds_read_b64_tr_b16 v[182:183], v8 offset:4608
  v_mfma_f32_16x16x32_bf16 v[60:63], v[136:139], v[108:111], v[60:63]
  ds_read_b64_tr_b16 v[184:185], v9 offset:4096
  v_mfma_f32_16x16x32_bf16 v[64:67], v[136:139], v[112:115], v[64:67]
  ds_read_b64_tr_b16 v[186:187], v9 offset:4608
  v_mfma_f32_16x16x32_bf16 v[68:71], v[136:139], v[116:119], v[68:71]
  v_add_u32 v2, 40960, v2
  v_mfma_f32_16x16x32_bf16 v[72:75], v[136:139], v[120:123], v[72:75]
  v_add_u32 v3, 40960, v3
  v_mfma_f32_16x16x32_bf16 v[76:79], v[140:143], v[108:111], v[76:79]
  v_add_u32 v4, 40960, v4
  v_mfma_f32_16x16x32_bf16 v[80:83], v[140:143], v[112:115], v[80:83]
  v_add_u32 v5, 40960, v5
  v_mfma_f32_16x16x32_bf16 v[84:87], v[140:143], v[116:119], v[84:87]
  v_add_u32 v6, 40960, v6
  v_mfma_f32_16x16x32_bf16 v[88:91], v[140:143], v[120:123], v[88:91]
  v_add_u32 v7, 40960, v7
  v_mfma_f32_16x16x32_bf16 v[92:95], v[144:147], v[108:111], v[92:95]
  v_add_u32 v8, 40960, v8
  v_mfma_f32_16x16x32_bf16 v[96:99], v[144:147], v[112:115], v[96:99]
  v_add_u32 v9, 40960, v9
  v_mfma_f32_16x16x32_bf16 v[100:103], v[144:147], v[116:119], v[100:103]
  v_mfma_f32_16x16x32_bf16 v[104:107], v[144:147], v[120:123], v[104:107]
  s_waitcnt lgkmcnt(0)
  s_barrier
  v_mfma_f32_16x16x32_bf16 v[12:15], v[148:151], v[164:167], v[12:15]
  ds_read_b128 v[108:111], v2
  v_mfma_f32_16x16x32_bf16 v[28:31], v[148:151], v[168:171], v[28:31]
  ds_read_b128 v[124:127], v4 offset:0
  v_mfma_f32_16x16x32_bf16 v[16:19], v[152:155], v[164:167], v[16:19]
  ds_read_b128 v[128:131], v4 offset:2048
  v_mfma_f32_16x16x32_bf16 v[32:35], v[152:155], v[168:171], v[32:35]
  ds_read_b128 v[112:115], v2 offset:2048
  v_mfma_f32_16x16x32_bf16 v[20:23], v[156:159], v[164:167], v[20:23]
  ds_read_b128 v[116:119], v2 offset:4096
  v_mfma_f32_16x16x32_bf16 v[36:39], v[156:159], v[168:171], v[36:39]
  ds_read_b128 v[120:123], v2 offset:6144
  v_mfma_f32_16x16x32_bf16 v[24:27], v[160:163], v[164:167], v[24:27]
  ds_read_b64_tr_b16 v[132:133], v6 offset:0
  v_mfma_f32_16x16x32_bf16 v[40:43], v[160:163], v[168:171], v[40:43]
  ds_read_b64_tr_b16 v[134:135], v6 offset:512
  v_mfma_f32_16x16x32_bf16 v[44:47], v[172:175], v[148:151], v[44:47]
  ds_read_b64_tr_b16 v[136:137], v7 offset:0
  v_mfma_f32_16x16x32_bf16 v[48:51], v[172:175], v[152:155], v[48:51]
  ds_read_b64_tr_b16 v[138:139], v7 offset:512
  v_mfma_f32_16x16x32_bf16 v[52:55], v[172:175], v[156:159], v[52:55]
  ds_read_b64_tr_b16 v[140:141], v8 offset:0
  v_mfma_f32_16x16x32_bf16 v[56:59], v[172:175], v[160:163], v[56:59]
  ds_read_b64_tr_b16 v[142:143], v8 offset:512
  v_mfma_f32_16x16x32_bf16 v[60:63], v[176:179], v[148:151], v[60:63]
  ds_read_b64_tr_b16 v[144:145], v9 offset:0
  v_mfma_f32_16x16x32_bf16 v[64:67], v[176:179], v[152:155], v[64:67]
  ds_read_b64_tr_b16 v[146:147], v9 offset:512
  v_mfma_f32_16x16x32_bf16 v[68:71], v[176:179], v[156:159], v[68:71]
  v_mfma_f32_16x16x32_bf16 v[72:75], v[176:179], v[160:163], v[72:75]
  v_mfma_f32_16x16x32_bf16 v[76:79], v[180:183], v[148:151], v[76:79]
  v_mfma_f32_16x16x32_bf16 v[80:83], v[180:183], v[152:155], v[80:83]
  v_mfma_f32_16x16x32_bf16 v[84:87], v[180:183], v[156:159], v[84:87]
  v_mfma_f32_16x16x32_bf16 v[88:91], v[180:183], v[160:163], v[88:91]
  v_mfma_f32_16x16x32_bf16 v[92:95], v[184:187], v[148:151], v[92:95]
  v_mfma_f32_16x16x32_bf16 v[96:99], v[184:187], v[152:155], v[96:99]
  v_mfma_f32_16x16x32_bf16 v[100:103], v[184:187], v[156:159], v[100:103]
  v_mfma_f32_16x16x32_bf16 v[104:107], v[184:187], v[160:163], v[104:107]
  s_waitcnt lgkmcnt(0)
  v_mfma_f32_16x16x32_bf16 v[12:15], v[108:111], v[124:127], v[12:15]
  ds_read_b128 v[148:151], v3
  v_mfma_f32_16x16x32_bf16 v[28:31], v[108:111], v[128:131], v[28:31]
  ds_read_b128 v[164:167], v5 offset:0
  v_mfma_f32_16x16x32_bf16 v[16:19], v[112:115], v[124:127], v[16:19]
  ds_read_b128 v[168:171], v5 offset:2048
  v_mfma_f32_16x16x32_bf16 v[32:35], v[112:115], v[128:131], v[32:35]
  ds_read_b128 v[152:155], v3 offset:2048
  v_mfma_f32_16x16x32_bf16 v[20:23], v[116:119], v[124:127], v[20:23]
  ds_read_b128 v[156:159], v3 offset:4096
  v_mfma_f32_16x16x32_bf16 v[36:39], v[116:119], v[128:131], v[36:39]
  ds_read_b128 v[160:163], v3 offset:6144
  v_mfma_f32_16x16x32_bf16 v[24:27], v[120:123], v[124:127], v[24:27]
  ds_read_b64_tr_b16 v[172:173], v6 offset:4096
  v_mfma_f32_16x16x32_bf16 v[40:43], v[120:123], v[128:131], v[40:43]
  ds_read_b64_tr_b16 v[174:175], v6 offset:4608
  v_mfma_f32_16x16x32_bf16 v[44:47], v[132:135], v[108:111], v[44:47]
  ds_read_b64_tr_b16 v[176:177], v7 offset:4096
  v_mfma_f32_16x16x32_bf16 v[48:51], v[132:135], v[112:115], v[48:51]
  ds_read_b64_tr_b16 v[178:179], v7 offset:4608
  v_mfma_f32_16x16x32_bf16 v[52:55], v[132:135], v[116:119], v[52:55]
  ds_read_b64_tr_b16 v[180:181], v8 offset:4096
  v_mfma_f32_16x16x32_bf16 v[56:59], v[132:135], v[120:123], v[56:59]
  ds_read_b64_tr_b16 v[182:183], v8 offset:4608
  v_mfma_f32_16x16x32_bf16 v[60:63], v[136:139], v[108:111], v[60:63]
  ds_read_b64_tr_b16 v[184:185], v9 offset:4096
  v_mfma_f32_16x16x32_bf16 v[64:67], v[136:139], v[112:115], v[64:67]
  ds_read_b64_tr_b16 v[186:187], v9 offset:4608
  v_mfma_f32_16x16x32_bf16 v[68:71], v[136:139], v[116:119], v[68:71]
  v_add_u32 v2, 40960, v2
  v_mfma_f32_16x16x32_bf16 v[72:75], v[136:139], v[120:123], v[72:75]
  v_add_u32 v3, 40960, v3
  v_mfma_f32_16x16x32_bf16 v[76:79], v[140:143], v[108:111], v[76:79]
  v_add_u32 v4, 40960, v4
  v_mfma_f32_16x16x32_bf16 v[80:83], v[140:143], v[112:115], v[80:83]
  v_add_u32 v5, 40960, v5
  v_mfma_f32_16x16x32_bf16 v[84:87], v[140:143], v[116:119], v[84:87]
  v_add_u32 v6, 40960, v6
  v_mfma_f32_16x16x32_bf16 v[88:91], v[140:143], v[120:123], v[88:91]
  v_add_u32 v7, 40960, v7
  v_mfma_f32_16x16x32_bf16 v[92:95], v[144:147], v[108:111], v[92:95]
  v_add_u32 v8, 40960, v8
  v_mfma_f32_16x16x32_bf16 v[96:99], v[144:147], v[112:115], v[96:99]
  v_add_u32 v9, 40960, v9
  v_mfma_f32_16x16x32_bf16 v[100:103], v[144:147], v[116:119], v[100:103]
  v_mfma_f32_16x16x32_bf16 v[104:107], v[144:147], v[120:123], v[104:107]
  s_waitcnt lgkmcnt(0)
  s_barrier
  v_mfma_f32_16x16x32_bf16 v[12:15], v[148:151], v[164:167], v[12:15]
  ds_read_b128 v[108:111], v2
  v_mfma_f32_16x16x32_bf16 v[28:31], v[148:151], v[168:171], v[28:31]
  ds_read_b128 v[124:127], v4 offset:0
  v_mfma_f32_16x16x32_bf16 v[16:19], v[152:155], v[164:167], v[16:19]
  ds_read_b128 v[128:131], v4 offset:2048
  v_mfma_f32_16x16x32_bf16 v[32:35], v[152:155], v[168:171], v[32:35]
  ds_read_b128 v[112:115], v2 offset:2048
  v_mfma_f32_16x16x32_bf16 v[20:23], v[156:159], v[164:167], v[20:23]
  ds_read_b128 v[116:119], v2 offset:4096
  v_mfma_f32_16x16x32_bf16 v[36:39], v[156:159], v[168:171], v[36:39]
  ds_read_b128 v[120:123], v2 offset:6144
  v_mfma_f32_16x16x32_bf16 v[24:27], v[160:163], v[164:167], v[24:27]
  ds_read_b64_tr_b16 v[132:133], v6 offset:0
  v_mfma_f32_16x16x32_bf16 v[40:43], v[160:163], v[168:171], v[40:43]
  ds_read_b64_tr_b16 v[134:135], v6 offset:512
  v_mfma_f32_16x16x32_bf16 v[44:47], v[172:175], v[148:151], v[44:47]
  ds_read_b64_tr_b16 v[136:137], v7 offset:0
  v_mfma_f32_16x16x32_bf16 v[48:51], v[172:175], v[152:155], v[48:51]
  ds_read_b64_tr_b16 v[138:139], v7 offset:512
  v_mfma_f32_16x16x32_bf16 v[52:55], v[172:175], v[156:159], v[52:55]
  ds_read_b64_tr_b16 v[140:141], v8 offset:0
  v_mfma_f32_16x16x32_bf16 v[56:59], v[172:175], v[160:163], v[56:59]
  ds_read_b64_tr_b16 v[142:143], v8 offset:512
  v_mfma_f32_16x16x32_bf16 v[60:63], v[176:179], v[148:151], v[60:63]
  ds_read_b64_tr_b16 v[144:145], v9 offset:0
  v_mfma_f32_16x16x32_bf16 v[64:67], v[176:179], v[152:155], v[64:67]
  ds_read_b64_tr_b16 v[146:147], v9 offset:512
  v_mfma_f32_16x16x32_bf16 v[68:71], v[176:179], v[156:159], v[68:71]
  v_mfma_f32_16x16x32_bf16 v[72:75], v[176:179], v[160:163], v[72:75]
  v_mfma_f32_16x16x32_bf16 v[76:79], v[180:183], v[148:151], v[76:79]
  v_mfma_f32_16x16x32_bf16 v[80:83], v[180:183], v[152:155], v[80:83]
  v_mfma_f32_16x16x32_bf16 v[84:87], v[180:183], v[156:159], v[84:87]
  v_mfma_f32_16x16x32_bf16 v[88:91], v[180:183], v[160:163], v[88:91]
  v_mfma_f32_16x16x32_bf16 v[92:95], v[184:187], v[148:151], v[92:95]
  v_mfma_f32_16x16x32_bf16 v[96:99], v[184:187], v[152:155], v[96:99]
  v_mfma_f32_16x16x32_bf16 v[100:103], v[184:187], v[156:159], v[100:103]
  v_mfma_f32_16x16x32_bf16 v[104:107], v[184:187], v[160:163], v[104:107]
  s_waitcnt lgkmcnt(0)
  v_mfma_f32_16x16x32_bf16 v[12:15], v[108:111], v[124:127], v[12:15]
  ds_read_b128 v[148:151], v3
  v_mfma_f32_16x16x32_bf16 v[28:31], v[108:111], v[128:131], v[28:31]
  ds_read_b128 v[164:167], v5 offset:0
  v_mfma_f32_16x16x32_bf16 v[16:19], v[112:115], v[124:127], v[16:19]
  ds_read_b128 v[168:171], v5 offset:2048
  v_mfma_f32_16x16x32_bf16 v[32:35], v[112:115], v[128:131], v[32:35]
  ds_read_b128 v[152:155], v3 offset:2048
  v_mfma_f32_16x16x32_bf16 v[20:23], v[116:119], v[124:127], v[20:23]
  ds_read_b128 v[156:159], v3 offset:4096
  v_mfma_f32_16x16x32_bf16 v[36:39], v[116:119], v[128:131], v[36:39]
  ds_read_b128 v[160:163], v3 offset:6144
  v_mfma_f32_16x16x32_bf16 v[24:27], v[120:123], v[124:127], v[24:27]
  ds_read_b64_tr_b16 v[172:173], v6 offset:4096
  v_mfma_f32_16x16x32_bf16 v[40:43], v[120:123], v[128:131], v[40:43]
  ds_read_b64_tr_b16 v[174:175], v6 offset:4608
  v_mfma_f32_16x16x32_bf16 v[44:47], v[132:135], v[108:111], v[44:47]
  ds_read_b64_tr_b16 v[176:177], v7 offset:4096
  v_mfma_f32_16x16x32_bf16 v[48:51], v[132:135], v[112:115], v[48:51]
  ds_read_b64_tr_b16 v[178:179], v7 offset:4608
  v_mfma_f32_16x16x32_bf16 v[52:55], v[132:135], v[116:119], v[52:55]
  ds_read_b64_tr_b16 v[180:181], v8 offset:4096
  v_mfma_f32_16x16x32_bf16 v[56:59], v[132:135], v[120:123], v[56:59]
  ds_read_b64_tr_b16 v[182:183], v8 offset:4608
  v_mfma_f32_16x16x32_bf16 v[60:63], v[136:139], v[108:111], v[60:63]
  ds_read_b64_tr_b16 v[184:185], v9 offset:4096
  v_mfma_f32_16x16x32_bf16 v[64:67], v[136:139], v[112:115], v[64:67]
  ds_read_b64_tr_b16 v[186:187], v9 offset:4608
  v_mfma_f32_16x16x32_bf16 v[68:71], v[136:139], v[116:119], v[68:71]
  v_subrev_u32 v2, 81920, v2
  v_mfma_f32_16x16x32_bf16 v[72:75], v[136:139], v[120:123], v[72:75]
  v_subrev_u32 v3, 81920, v3
  v_mfma_f32_16x16x32_bf16 v[76:79], v[140:143], v[108:111], v[76:79]
  v_subrev_u32 v4, 81920, v4
  v_mfma_f32_16x16x32_bf16 v[80:83], v[140:143], v[112:115], v[80:83]
  v_subrev_u32 v5, 81920, v5
  v_mfma_f32_16x16x32_bf16 v[84:87], v[140:143], v[116:119], v[84:87]
  v_subrev_u32 v6, 81920, v6
  v_mfma_f32_16x16x32_bf16 v[88:91], v[140:143], v[120:123], v[88:91]
  v_subrev_u32 v7, 81920, v7
  v_mfma_f32_16x16x32_bf16 v[92:95], v[144:147], v[108:111], v[92:95]
  v_subrev_u32 v8, 81920, v8
  v_mfma_f32_16x16x32_bf16 v[96:99], v[144:147], v[112:115], v[96:99]
  v_subrev_u32 v9, 81920, v9
  v_mfma_f32_16x16x32_bf16 v[100:103], v[144:147], v[116:119], v[100:103]
  v_mfma_f32_16x16x32_bf16 v[104:107], v[144:147], v[120:123], v[104:107]
  s_waitcnt lgkmcnt(0)
  s_barrier
  v_mfma_f32_16x16x32_bf16 v[12:15], v[148:151], v[164:167], v[12:15]
  ds_read_b128 v[108:111], v2
  v_mfma_f32_16x16x32_bf16 v[28:31], v[148:151], v[168:171], v[28:31]
  ds_read_b128 v[124:127], v4 offset:0
  v_mfma_f32_16x16x32_bf16 v[16:19], v[152:155], v[164:167], v[16:19]
  ds_read_b128 v[128:131], v4 offset:2048
  v_mfma_f32_16x16x32_bf16 v[32:35], v[152:155], v[168:171], v[32:35]
  ds_read_b128 v[112:115], v2 offset:2048
  v_mfma_f32_16x16x32_bf16 v[20:23], v[156:159], v[164:167], v[20:23]
  ds_read_b128 v[116:119], v2 offset:4096
  v_mfma_f32_16x16x32_bf16 v[36:39], v[156:159], v[168:171], v[36:39]
  ds_read_b128 v[120:123], v2 offset:6144
  v_mfma_f32_16x16x32_bf16 v[24:27], v[160:163], v[164:167], v[24:27]
  ds_read_b64_tr_b16 v[132:133], v6 offset:0
  v_mfma_f32_16x16x32_bf16 v[40:43], v[160:163], v[168:171], v[40:43]
  ds_read_b64_tr_b16 v[134:135], v6 offset:512
  v_mfma_f32_16x16x32_bf16 v[44:47], v[172:175], v[148:151], v[44:47]
  ds_read_b64_tr_b16 v[136:137], v7 offset:0
  v_mfma_f32_16x16x32_bf16 v[48:51], v[172:175], v[152:155], v[48:51]
  ds_read_b64_tr_b16 v[138:139], v7 offset:512
  v_mfma_f32_16x16x32_bf16 v[52:55], v[172:175], v[156:159], v[52:55]
  ds_read_b64_tr_b16 v[140:141], v8 offset:0
  v_mfma_f32_16x16x32_bf16 v[56:59], v[172:175], v[160:163], v[56:59]
  ds_read_b64_tr_b16 v[142:143], v8 offset:512
  v_mfma_f32_16x16x32_bf16 v[60:63], v[176:179], v[148:151], v[60:63]
  ds_read_b64_tr_b16 v[144:145], v9 offset:0
  v_mfma_f32_16x16x32_bf16 v[64:67], v[176:179], v[152:155], v[64:67]
  ds_read_b64_tr_b16 v[146:147], v9 offset:512
  v_mfma_f32_16x16x32_bf16 v[68:71], v[176:179], v[156:159], v[68:71]
  v_mfma_f32_16x16x32_bf16 v[72:75], v[176:179], v[160:163], v[72:75]
  v_mfma_f32_16x16x32_bf16 v[76:79], v[180:183], v[148:151], v[76:79]
  v_mfma_f32_16x16x32_bf16 v[80:83], v[180:183], v[152:155], v[80:83]
  v_mfma_f32_16x16x32_bf16 v[84:87], v[180:183], v[156:159], v[84:87]
  v_mfma_f32_16x16x32_bf16 v[88:91], v[180:183], v[160:163], v[88:91]
  v_mfma_f32_16x16x32_bf16 v[92:95], v[184:187], v[148:151], v[92:95]
  v_mfma_f32_16x16x32_bf16 v[96:99], v[184:187], v[152:155], v[96:99]
  v_mfma_f32_16x16x32_bf16 v[100:103], v[184:187], v[156:159], v[100:103]
  v_mfma_f32_16x16x32_bf16 v[104:107], v[184:187], v[160:163], v[104:107]
  s_waitcnt lgkmcnt(0)
  v_mfma_f32_16x16x32_bf16 v[12:15], v[108:111], v[124:127], v[12:15]
  ds_read_b128 v[148:151], v3
  v_mfma_f32_16x16x32_bf16 v[28:31], v[108:111], v[128:131], v[28:31]
  ds_read_b128 v[164:167], v5 offset:0
  v_mfma_f32_16x16x32_bf16 v[16:19], v[112:115], v[124:127], v[16:19]
  ds_read_b128 v[168:171], v5 offset:2048
  v_mfma_f32_16x16x32_bf16 v[32:35], v[112:115], v[128:131], v[32:35]
  ds_read_b128 v[152:155], v3 offset:2048
  v_mfma_f32_16x16x32_bf16 v[20:23], v[116:119], v[124:127], v[20:23]
  ds_read_b128 v[156:159], v3 offset:4096
  v_mfma_f32_16x16x32_bf16 v[36:39], v[116:119], v[128:131], v[36:39]
  ds_read_b128 v[160:163], v3 offset:6144
  v_mfma_f32_16x16x32_bf16 v[24:27], v[120:123], v[124:127], v[24:27]
  ds_read_b64_tr_b16 v[172:173], v6 offset:4096
  v_mfma_f32_16x16x32_bf16 v[40:43], v[120:123], v[128:131], v[40:43]
  ds_read_b64_tr_b16 v[174:175], v6 offset:4608
  v_mfma_f32_16x16x32_bf16 v[44:47], v[132:135], v[108:111], v[44:47]
  ds_read_b64_tr_b16 v[176:177], v7 offset:4096
  v_mfma_f32_16x16x32_bf16 v[48:51], v[132:135], v[112:115], v[48:51]
  ds_read_b64_tr_b16 v[178:179], v7 offset:4608
  v_mfma_f32_16x16x32_bf16 v[52:55], v[132:135], v[116:119], v[52:55]
  ds_read_b64_tr_b16 v[180:181], v8 offset:4096
  v_mfma_f32_16x16x32_bf16 v[56:59], v[132:135], v[120:123], v[56:59]
  ds_read_b64_tr_b16 v[182:183], v8 offset:4608
  v_mfma_f32_16x16x32_bf16 v[60:63], v[136:139], v[108:111], v[60:63]
  ds_read_b64_tr_b16 v[184:185], v9 offset:4096
  v_mfma_f32_16x16x32_bf16 v[64:67], v[136:139], v[112:115], v[64:67]
  ds_read_b64_tr_b16 v[186:187], v9 offset:4608
  v_mfma_f32_16x16x32_bf16 v[68:71], v[136:139], v[116:119], v[68:71]
  v_add_u32 v2, 40960, v2
  v_mfma_f32_16x16x32_bf16 v[72:75], v[136:139], v[120:123], v[72:75]
  v_add_u32 v3, 40960, v3
  v_mfma_f32_16x16x32_bf16 v[76:79], v[140:143], v[108:111], v[76:79]
  v_add_u32 v4, 40960, v4
  v_mfma_f32_16x16x32_bf16 v[80:83], v[140:143], v[112:115], v[80:83]
  v_add_u32 v5, 40960, v5
  v_mfma_f32_16x16x32_bf16 v[84:87], v[140:143], v[116:119], v[84:87]
  v_add_u32 v6, 40960, v6
  v_mfma_f32_16x16x32_bf16 v[88:91], v[140:143], v[120:123], v[88:91]
  v_add_u32 v7, 40960, v7
  v_mfma_f32_16x16x32_bf16 v[92:95], v[144:147], v[108:111], v[92:95]
  v_add_u32 v8, 40960, v8
  v_mfma_f32_16x16x32_bf16 v[96:99], v[144:147], v[112:115], v[96:99]
  v_add_u32 v9, 40960, v9
  v_mfma_f32_16x16x32_bf16 v[100:103], v[144:147], v[116:119], v[100:103]
  v_mfma_f32_16x16x32_bf16 v[104:107], v[144:147], v[120:123], v[104:107]
  s_waitcnt lgkmcnt(0)
  s_barrier
  v_mfma_f32_16x16x32_bf16 v[12:15], v[148:151], v[164:167], v[12:15]
  ds_read_b128 v[108:111], v2
  v_mfma_f32_16x16x32_bf16 v[28:31], v[148:151], v[168:171], v[28:31]
  ds_read_b128 v[124:127], v4 offset:0
  v_mfma_f32_16x16x32_bf16 v[16:19], v[152:155], v[164:167], v[16:19]
  ds_read_b128 v[128:131], v4 offset:2048
  v_mfma_f32_16x16x32_bf16 v[32:35], v[152:155], v[168:171], v[32:35]
  ds_read_b128 v[112:115], v2 offset:2048
  v_mfma_f32_16x16x32_bf16 v[20:23], v[156:159], v[164:167], v[20:23]
  ds_read_b128 v[116:119], v2 offset:4096
  v_mfma_f32_16x16x32_bf16 v[36:39], v[156:159], v[168:171], v[36:39]
  ds_read_b128 v[120:123], v2 offset:6144
  v_mfma_f32_16x16x32_bf16 v[24:27], v[160:163], v[164:167], v[24:27]
  ds_read_b64_tr_b16 v[132:133], v6 offset:0
  v_mfma_f32_16x16x32_bf16 v[40:43], v[160:163], v[168:171], v[40:43]
  ds_read_b64_tr_b16 v[134:135], v6 offset:512
  v_mfma_f32_16x16x32_bf16 v[44:47], v[172:175], v[148:151], v[44:47]
  ds_read_b64_tr_b16 v[136:137], v7 offset:0
  v_mfma_f32_16x16x32_bf16 v[48:51], v[172:175], v[152:155], v[48:51]
  ds_read_b64_tr_b16 v[138:139], v7 offset:512
  v_mfma_f32_16x16x32_bf16 v[52:55], v[172:175], v[156:159], v[52:55]
  ds_read_b64_tr_b16 v[140:141], v8 offset:0
  v_mfma_f32_16x16x32_bf16 v[56:59], v[172:175], v[160:163], v[56:59]
  ds_read_b64_tr_b16 v[142:143], v8 offset:512
  v_mfma_f32_16x16x32_bf16 v[60:63], v[176:179], v[148:151], v[60:63]
  ds_read_b64_tr_b16 v[144:145], v9 offset:0
  v_mfma_f32_16x16x32_bf16 v[64:67], v[176:179], v[152:155], v[64:67]
  ds_read_b64_tr_b16 v[146:147], v9 offset:512
  v_mfma_f32_16x16x32_bf16 v[68:71], v[176:179], v[156:159], v[68:71]
  v_mfma_f32_16x16x32_bf16 v[72:75], v[176:179], v[160:163], v[72:75]
  v_mfma_f32_16x16x32_bf16 v[76:79], v[180:183], v[148:151], v[76:79]
  v_mfma_f32_16x16x32_bf16 v[80:83], v[180:183], v[152:155], v[80:83]
  v_mfma_f32_16x16x32_bf16 v[84:87], v[180:183], v[156:159], v[84:87]
  v_mfma_f32_16x16x32_bf16 v[88:91], v[180:183], v[160:163], v[88:91]
  v_mfma_f32_16x16x32_bf16 v[92:95], v[184:187], v[148:151], v[92:95]
  v_mfma_f32_16x16x32_bf16 v[96:99], v[184:187], v[152:155], v[96:99]
  v_mfma_f32_16x16x32_bf16 v[100:103], v[184:187], v[156:159], v[100:103]
  v_mfma_f32_16x16x32_bf16 v[104:107], v[184:187], v[160:163], v[104:107]
  s_waitcnt lgkmcnt(0)
  v_mfma_f32_16x16x32_bf16 v[12:15], v[108:111], v[124:127], v[12:15]
  ds_read_b128 v[148:151], v3
  v_mfma_f32_16x16x32_bf16 v[28:31], v[108:111], v[128:131], v[28:31]
  ds_read_b128 v[164:167], v5 offset:0
  v_mfma_f32_16x16x32_bf16 v[16:19], v[112:115], v[124:127], v[16:19]
  ds_read_b128 v[168:171], v5 offset:2048
  v_mfma_f32_16x16x32_bf16 v[32:35], v[112:115], v[128:131], v[32:35]
  ds_read_b128 v[152:155], v3 offset:2048
  v_mfma_f32_16x16x32_bf16 v[20:23], v[116:119], v[124:127], v[20:23]
  ds_read_b128 v[156:159], v3 offset:4096
  v_mfma_f32_16x16x32_bf16 v[36:39], v[116:119], v[128:131], v[36:39]
  ds_read_b128 v[160:163], v3 offset:6144
  v_mfma_f32_16x16x32_bf16 v[24:27], v[120:123], v[124:127], v[24:27]
  ds_read_b64_tr_b16 v[172:173], v6 offset:4096
  v_mfma_f32_16x16x32_bf16 v[40:43], v[120:123], v[128:131], v[40:43]
  ds_read_b64_tr_b16 v[174:175], v6 offset:4608
  v_mfma_f32_16x16x32_bf16 v[44:47], v[132:135], v[108:111], v[44:47]
  ds_read_b64_tr_b16 v[176:177], v7 offset:4096
  v_mfma_f32_16x16x32_bf16 v[48:51], v[132:135], v[112:115], v[48:51]
  ds_read_b64_tr_b16 v[178:179], v7 offset:4608
  v_mfma_f32_16x16x32_bf16 v[52:55], v[132:135], v[116:119], v[52:55]
  ds_read_b64_tr_b16 v[180:181], v8 offset:4096
  v_mfma_f32_16x16x32_bf16 v[56:59], v[132:135], v[120:123], v[56:59]
  ds_read_b64_tr_b16 v[182:183], v8 offset:4608
  v_mfma_f32_16x16x32_bf16 v[60:63], v[136:139], v[108:111], v[60:63]
  ds_read_b64_tr_b16 v[184:185], v9 offset:4096
  v_mfma_f32_16x16x32_bf16 v[64:67], v[136:139], v[112:115], v[64:67]
  ds_read_b64_tr_b16 v[186:187], v9 offset:4608
  v_mfma_f32_16x16x32_bf16 v[68:71], v[136:139], v[116:119], v[68:71]
  v_add_u32 v2, 40960, v2
  v_mfma_f32_16x16x32_bf16 v[72:75], v[136:139], v[120:123], v[72:75]
  v_add_u32 v3, 40960, v3
  v_mfma_f32_16x16x32_bf16 v[76:79], v[140:143], v[108:111], v[76:79]
  v_add_u32 v4, 40960, v4
  v_mfma_f32_16x16x32_bf16 v[80:83], v[140:143], v[112:115], v[80:83]
  v_add_u32 v5, 40960, v5
  v_mfma_f32_16x16x32_bf16 v[84:87], v[140:143], v[116:119], v[84:87]
  v_add_u32 v6, 40960, v6
  v_mfma_f32_16x16x32_bf16 v[88:91], v[140:143], v[120:123], v[88:91]
  v_add_u32 v7, 40960, v7
  v_mfma_f32_16x16x32_bf16 v[92:95], v[144:147], v[108:111], v[92:95]
  v_add_u32 v8, 40960, v8
  v_mfma_f32_16x16x32_bf16 v[96:99], v[144:147], v[112:115], v[96:99]
  v_add_u32 v9, 40960, v9
  v_mfma_f32_16x16x32_bf16 v[100:103], v[144:147], v[116:119], v[100:103]
  v_mfma_f32_16x16x32_bf16 v[104:107], v[144:147], v[120:123], v[104:107]
  s_waitcnt lgkmcnt(0)
  s_barrier
  v_mfma_f32_16x16x32_bf16 v[12:15], v[148:151], v[164:167], v[12:15]
  ds_read_b128 v[108:111], v2
  v_mfma_f32_16x16x32_bf16 v[28:31], v[148:151], v[168:171], v[28:31]
  ds_read_b128 v[124:127], v4 offset:0
  v_mfma_f32_16x16x32_bf16 v[16:19], v[152:155], v[164:167], v[16:19]
  ds_read_b128 v[128:131], v4 offset:2048
  v_mfma_f32_16x16x32_bf16 v[32:35], v[152:155], v[168:171], v[32:35]
  ds_read_b128 v[112:115], v2 offset:2048
  v_mfma_f32_16x16x32_bf16 v[20:23], v[156:159], v[164:167], v[20:23]
  ds_read_b128 v[116:119], v2 offset:4096
  v_mfma_f32_16x16x32_bf16 v[36:39], v[156:159], v[168:171], v[36:39]
  ds_read_b128 v[120:123], v2 offset:6144
  v_mfma_f32_16x16x32_bf16 v[24:27], v[160:163], v[164:167], v[24:27]
  ds_read_b64_tr_b16 v[132:133], v6 offset:0
  v_mfma_f32_16x16x32_bf16 v[40:43], v[160:163], v[168:171], v[40:43]
  ds_read_b64_tr_b16 v[134:135], v6 offset:512
  v_mfma_f32_16x16x32_bf16 v[44:47], v[172:175], v[148:151], v[44:47]
  ds_read_b64_tr_b16 v[136:137], v7 offset:0
  v_mfma_f32_16x16x32_bf16 v[48:51], v[172:175], v[152:155], v[48:51]
  ds_read_b64_tr_b16 v[138:139], v7 offset:512
  v_mfma_f32_16x16x32_bf16 v[52:55], v[172:175], v[156:159], v[52:55]
  ds_read_b64_tr_b16 v[140:141], v8 offset:0
  v_mfma_f32_16x16x32_bf16 v[56:59], v[172:175], v[160:163], v[56:59]
  ds_read_b64_tr_b16 v[142:143], v8 offset:512
  v_mfma_f32_16x16x32_bf16 v[60:63], v[176:179], v[148:151], v[60:63]
  ds_read_b64_tr_b16 v[144:145], v9 offset:0
  v_mfma_f32_16x16x32_bf16 v[64:67], v[176:179], v[152:155], v[64:67]
  ds_read_b64_tr_b16 v[146:147], v9 offset:512
  v_mfma_f32_16x16x32_bf16 v[68:71], v[176:179], v[156:159], v[68:71]
  v_mfma_f32_16x16x32_bf16 v[72:75], v[176:179], v[160:163], v[72:75]
  v_mfma_f32_16x16x32_bf16 v[76:79], v[180:183], v[148:151], v[76:79]
  v_mfma_f32_16x16x32_bf16 v[80:83], v[180:183], v[152:155], v[80:83]
  v_mfma_f32_16x16x32_bf16 v[84:87], v[180:183], v[156:159], v[84:87]
  v_mfma_f32_16x16x32_bf16 v[88:91], v[180:183], v[160:163], v[88:91]
  v_mfma_f32_16x16x32_bf16 v[92:95], v[184:187], v[148:151], v[92:95]
  v_mfma_f32_16x16x32_bf16 v[96:99], v[184:187], v[152:155], v[96:99]
  v_mfma_f32_16x16x32_bf16 v[100:103], v[184:187], v[156:159], v[100:103]
  v_mfma_f32_16x16x32_bf16 v[104:107], v[184:187], v[160:163], v[104:107]
  s_waitcnt lgkmcnt(0)
  v_mfma_f32_16x16x32_bf16 v[12:15], v[108:111], v[124:127], v[12:15]
  ds_read_b128 v[148:151], v3
  v_mfma_f32_16x16x32_bf16 v[28:31], v[108:111], v[128:131], v[28:31]
  ds_read_b128 v[164:167], v5 offset:0
  v_mfma_f32_16x16x32_bf16 v[16:19], v[112:115], v[124:127], v[16:19]
  ds_read_b128 v[168:171], v5 offset:2048
  v_mfma_f32_16x16x32_bf16 v[32:35], v[112:115], v[128:131], v[32:35]
  ds_read_b128 v[152:155], v3 offset:2048
  v_mfma_f32_16x16x32_bf16 v[20:23], v[116:119], v[124:127], v[20:23]
  ds_read_b128 v[156:159], v3 offset:4096
  v_mfma_f32_16x16x32_bf16 v[36:39], v[116:119], v[128:131], v[36:39]
  ds_read_b128 v[160:163], v3 offset:6144
  v_mfma_f32_16x16x32_bf16 v[24:27], v[120:123], v[124:127], v[24:27]
  ds_read_b64_tr_b16 v[172:173], v6 offset:4096
  v_mfma_f32_16x16x32_bf16 v[40:43], v[120:123], v[128:131], v[40:43]
  ds_read_b64_tr_b16 v[174:175], v6 offset:4608
  v_mfma_f32_16x16x32_bf16 v[44:47], v[132:135], v[108:111], v[44:47]
  ds_read_b64_tr_b16 v[176:177], v7 offset:4096
  v_mfma_f32_16x16x32_bf16 v[48:51], v[132:135], v[112:115], v[48:51]
  ds_read_b64_tr_b16 v[178:179], v7 offset:4608
  v_mfma_f32_16x16x32_bf16 v[52:55], v[132:135], v[116:119], v[52:55]
  ds_read_b64_tr_b16 v[180:181], v8 offset:4096
  v_mfma_f32_16x16x32_bf16 v[56:59], v[132:135], v[120:123], v[56:59]
  ds_read_b64_tr_b16 v[182:183], v8 offset:4608
  v_mfma_f32_16x16x32_bf16 v[60:63], v[136:139], v[108:111], v[60:63]
  ds_read_b64_tr_b16 v[184:185], v9 offset:4096
  v_mfma_f32_16x16x32_bf16 v[64:67], v[136:139], v[112:115], v[64:67]
  ds_read_b64_tr_b16 v[186:187], v9 offset:4608
  v_mfma_f32_16x16x32_bf16 v[68:71], v[136:139], v[116:119], v[68:71]
  v_subrev_u32 v2, 81920, v2
  v_mfma_f32_16x16x32_bf16 v[72:75], v[136:139], v[120:123], v[72:75]
  v_subrev_u32 v3, 81920, v3
  v_mfma_f32_16x16x32_bf16 v[76:79], v[140:143], v[108:111], v[76:79]
  v_subrev_u32 v4, 81920, v4
  v_mfma_f32_16x16x32_bf16 v[80:83], v[140:143], v[112:115], v[80:83]
  v_subrev_u32 v5, 81920, v5
  v_mfma_f32_16x16x32_bf16 v[84:87], v[140:143], v[116:119], v[84:87]
  v_subrev_u32 v6, 81920, v6
  v_mfma_f32_16x16x32_bf16 v[88:91], v[140:143], v[120:123], v[88:91]
  v_subrev_u32 v7, 81920, v7
  v_mfma_f32_16x16x32_bf16 v[92:95], v[144:147], v[108:111], v[92:95]
  v_subrev_u32 v8, 81920, v8
  v_mfma_f32_16x16x32_bf16 v[96:99], v[144:147], v[112:115], v[96:99]
  v_subrev_u32 v9, 81920, v9
  v_mfma_f32_16x16x32_bf16 v[100:103], v[144:147], v[116:119], v[100:103]
  v_mfma_f32_16x16x32_bf16 v[104:107], v[144:147], v[120:123], v[104:107]
  s_waitcnt lgkmcnt(0)
  s_barrier
  v_mfma_f32_16x16x32_bf16 v[12:15], v[148:151], v[164:167], v[12:15]
  ds_read_b128 v[108:111], v2
  v_mfma_f32_16x16x32_bf16 v[28:31], v[148:151], v[168:171], v[28:31]
  ds_read_b128 v[124:127], v4 offset:0
  v_mfma_f32_16x16x32_bf16 v[16:19], v[152:155], v[164:167], v[16:19]
  ds_read_b128 v[128:131], v4 offset:2048
  v_mfma_f32_16x16x32_bf16 v[32:35], v[152:155], v[168:171], v[32:35]
  ds_read_b128 v[112:115], v2 offset:2048
  v_mfma_f32_16x16x32_bf16 v[20:23], v[156:159], v[164:167], v[20:23]
  ds_read_b128 v[116:119], v2 offset:4096
  v_mfma_f32_16x16x32_bf16 v[36:39], v[156:159], v[168:171], v[36:39]
  ds_read_b128 v[120:123], v2 offset:6144
  v_mfma_f32_16x16x32_bf16 v[24:27], v[160:163], v[164:167], v[24:27]
  ds_read_b64_tr_b16 v[132:133], v6 offset:0
  v_mfma_f32_16x16x32_bf16 v[40:43], v[160:163], v[168:171], v[40:43]
  ds_read_b64_tr_b16 v[134:135], v6 offset:512
  v_mfma_f32_16x16x32_bf16 v[44:47], v[172:175], v[148:151], v[44:47]
  ds_read_b64_tr_b16 v[136:137], v7 offset:0
  v_mfma_f32_16x16x32_bf16 v[48:51], v[172:175], v[152:155], v[48:51]
  ds_read_b64_tr_b16 v[138:139], v7 offset:512
  v_mfma_f32_16x16x32_bf16 v[52:55], v[172:175], v[156:159], v[52:55]
  ds_read_b64_tr_b16 v[140:141], v8 offset:0
  v_mfma_f32_16x16x32_bf16 v[56:59], v[172:175], v[160:163], v[56:59]
  ds_read_b64_tr_b16 v[142:143], v8 offset:512
  v_mfma_f32_16x16x32_bf16 v[60:63], v[176:179], v[148:151], v[60:63]
  ds_read_b64_tr_b16 v[144:145], v9 offset:0
  v_mfma_f32_16x16x32_bf16 v[64:67], v[176:179], v[152:155], v[64:67]
  ds_read_b64_tr_b16 v[146:147], v9 offset:512
  v_mfma_f32_16x16x32_bf16 v[68:71], v[176:179], v[156:159], v[68:71]
  v_mfma_f32_16x16x32_bf16 v[72:75], v[176:179], v[160:163], v[72:75]
  v_mfma_f32_16x16x32_bf16 v[76:79], v[180:183], v[148:151], v[76:79]
  v_mfma_f32_16x16x32_bf16 v[80:83], v[180:183], v[152:155], v[80:83]
  v_mfma_f32_16x16x32_bf16 v[84:87], v[180:183], v[156:159], v[84:87]
  v_mfma_f32_16x16x32_bf16 v[88:91], v[180:183], v[160:163], v[88:91]
  v_mfma_f32_16x16x32_bf16 v[92:95], v[184:187], v[148:151], v[92:95]
  v_mfma_f32_16x16x32_bf16 v[96:99], v[184:187], v[152:155], v[96:99]
  v_mfma_f32_16x16x32_bf16 v[100:103], v[184:187], v[156:159], v[100:103]
  v_mfma_f32_16x16x32_bf16 v[104:107], v[184:187], v[160:163], v[104:107]
  s_waitcnt lgkmcnt(0)
  v_mfma_f32_16x16x32_bf16 v[12:15], v[108:111], v[124:127], v[12:15]
  ds_read_b128 v[148:151], v3
  v_mfma_f32_16x16x32_bf16 v[28:31], v[108:111], v[128:131], v[28:31]
  ds_read_b128 v[164:167], v5 offset:0
  v_mfma_f32_16x16x32_bf16 v[16:19], v[112:115], v[124:127], v[16:19]
  ds_read_b128 v[168:171], v5 offset:2048
  v_mfma_f32_16x16x32_bf16 v[32:35], v[112:115], v[128:131], v[32:35]
  ds_read_b128 v[152:155], v3 offset:2048
  v_mfma_f32_16x16x32_bf16 v[20:23], v[116:119], v[124:127], v[20:23]
  ds_read_b128 v[156:159], v3 offset:4096
  v_mfma_f32_16x16x32_bf16 v[36:39], v[116:119], v[128:131], v[36:39]
  ds_read_b128 v[160:163], v3 offset:6144
  v_mfma_f32_16x16x32_bf16 v[24:27], v[120:123], v[124:127], v[24:27]
  ds_read_b64_tr_b16 v[172:173], v6 offset:4096
  v_mfma_f32_16x16x32_bf16 v[40:43], v[120:123], v[128:131], v[40:43]
  ds_read_b64_tr_b16 v[174:175], v6 offset:4608
  v_mfma_f32_16x16x32_bf16 v[44:47], v[132:135], v[108:111], v[44:47]
  ds_read_b64_tr_b16 v[176:177], v7 offset:4096
  v_mfma_f32_16x16x32_bf16 v[48:51], v[132:135], v[112:115], v[48:51]
  ds_read_b64_tr_b16 v[178:179], v7 offset:4608
  v_mfma_f32_16x16x32_bf16 v[52:55], v[132:135], v[116:119], v[52:55]
  ds_read_b64_tr_b16 v[180:181], v8 offset:4096
  v_mfma_f32_16x16x32_bf16 v[56:59], v[132:135], v[120:123], v[56:59]
  ds_read_b64_tr_b16 v[182:183], v8 offset:4608
  v_mfma_f32_16x16x32_bf16 v[60:63], v[136:139], v[108:111], v[60:63]
  ds_read_b64_tr_b16 v[184:185], v9 offset:4096
  v_mfma_f32_16x16x32_bf16 v[64:67], v[136:139], v[112:115], v[64:67]
  ds_read_b64_tr_b16 v[186:187], v9 offset:4608
  v_mfma_f32_16x16x32_bf16 v[68:71], v[136:139], v[116:119], v[68:71]
  v_add_u32 v2, 40960, v2
  v_mfma_f32_16x16x32_bf16 v[72:75], v[136:139], v[120:123], v[72:75]
  v_add_u32 v3, 40960, v3
  v_mfma_f32_16x16x32_bf16 v[76:79], v[140:143], v[108:111], v[76:79]
  v_add_u32 v4, 40960, v4
  v_mfma_f32_16x16x32_bf16 v[80:83], v[140:143], v[112:115], v[80:83]
  v_add_u32 v5, 40960, v5
  v_mfma_f32_16x16x32_bf16 v[84:87], v[140:143], v[116:119], v[84:87]
  v_add_u32 v6, 40960, v6
  v_mfma_f32_16x16x32_bf16 v[88:91], v[140:143], v[120:123], v[88:91]
  v_add_u32 v7, 40960, v7
  v_mfma_f32_16x16x32_bf16 v[92:95], v[144:147], v[108:111], v[92:95]
  v_add_u32 v8, 40960, v8
  v_mfma_f32_16x16x32_bf16 v[96:99], v[144:147], v[112:115], v[96:99]
  v_add_u32 v9, 40960, v9
  v_mfma_f32_16x16x32_bf16 v[100:103], v[144:147], v[116:119], v[100:103]
  v_mfma_f32_16x16x32_bf16 v[104:107], v[144:147], v[120:123], v[104:107]
  s_waitcnt lgkmcnt(0)
  s_barrier
  v_mfma_f32_16x16x32_bf16 v[12:15], v[148:151], v[164:167], v[12:15]
  ds_read_b128 v[108:111], v2
  v_mfma_f32_16x16x32_bf16 v[28:31], v[148:151], v[168:171], v[28:31]
  ds_read_b128 v[124:127], v4 offset:0
  v_mfma_f32_16x16x32_bf16 v[16:19], v[152:155], v[164:167], v[16:19]
  ds_read_b128 v[128:131], v4 offset:2048
  v_mfma_f32_16x16x32_bf16 v[32:35], v[152:155], v[168:171], v[32:35]
  ds_read_b128 v[112:115], v2 offset:2048
  v_mfma_f32_16x16x32_bf16 v[20:23], v[156:159], v[164:167], v[20:23]
  ds_read_b128 v[116:119], v2 offset:4096
  v_mfma_f32_16x16x32_bf16 v[36:39], v[156:159], v[168:171], v[36:39]
  ds_read_b128 v[120:123], v2 offset:6144
  v_mfma_f32_16x16x32_bf16 v[24:27], v[160:163], v[164:167], v[24:27]
  ds_read_b64_tr_b16 v[132:133], v6 offset:0
  v_mfma_f32_16x16x32_bf16 v[40:43], v[160:163], v[168:171], v[40:43]
  ds_read_b64_tr_b16 v[134:135], v6 offset:512
  v_mfma_f32_16x16x32_bf16 v[44:47], v[172:175], v[148:151], v[44:47]
  ds_read_b64_tr_b16 v[136:137], v7 offset:0
  v_mfma_f32_16x16x32_bf16 v[48:51], v[172:175], v[152:155], v[48:51]
  ds_read_b64_tr_b16 v[138:139], v7 offset:512
  v_mfma_f32_16x16x32_bf16 v[52:55], v[172:175], v[156:159], v[52:55]
  ds_read_b64_tr_b16 v[140:141], v8 offset:0
  v_mfma_f32_16x16x32_bf16 v[56:59], v[172:175], v[160:163], v[56:59]
  ds_read_b64_tr_b16 v[142:143], v8 offset:512
  v_mfma_f32_16x16x32_bf16 v[60:63], v[176:179], v[148:151], v[60:63]
  ds_read_b64_tr_b16 v[144:145], v9 offset:0
  v_mfma_f32_16x16x32_bf16 v[64:67], v[176:179], v[152:155], v[64:67]
  ds_read_b64_tr_b16 v[146:147], v9 offset:512
  v_mfma_f32_16x16x32_bf16 v[68:71], v[176:179], v[156:159], v[68:71]
  v_mfma_f32_16x16x32_bf16 v[72:75], v[176:179], v[160:163], v[72:75]
  v_mfma_f32_16x16x32_bf16 v[76:79], v[180:183], v[148:151], v[76:79]
  v_mfma_f32_16x16x32_bf16 v[80:83], v[180:183], v[152:155], v[80:83]
  v_mfma_f32_16x16x32_bf16 v[84:87], v[180:183], v[156:159], v[84:87]
  v_mfma_f32_16x16x32_bf16 v[88:91], v[180:183], v[160:163], v[88:91]
  v_mfma_f32_16x16x32_bf16 v[92:95], v[184:187], v[148:151], v[92:95]
  v_mfma_f32_16x16x32_bf16 v[96:99], v[184:187], v[152:155], v[96:99]
  v_mfma_f32_16x16x32_bf16 v[100:103], v[184:187], v[156:159], v[100:103]
  v_mfma_f32_16x16x32_bf16 v[104:107], v[184:187], v[160:163], v[104:107]
  s_waitcnt lgkmcnt(0)
  v_mfma_f32_16x16x32_bf16 v[12:15], v[108:111], v[124:127], v[12:15]
  ds_read_b128 v[148:151], v3
  v_mfma_f32_16x16x32_bf16 v[28:31], v[108:111], v[128:131], v[28:31]
  ds_read_b128 v[164:167], v5 offset:0
  v_mfma_f32_16x16x32_bf16 v[16:19], v[112:115], v[124:127], v[16:19]
  ds_read_b128 v[168:171], v5 offset:2048
  v_mfma_f32_16x16x32_bf16 v[32:35], v[112:115], v[128:131], v[32:35]
  ds_read_b128 v[152:155], v3 offset:2048
  v_mfma_f32_16x16x32_bf16 v[20:23], v[116:119], v[124:127], v[20:23]
  ds_read_b128 v[156:159], v3 offset:4096
  v_mfma_f32_16x16x32_bf16 v[36:39], v[116:119], v[128:131], v[36:39]
  ds_read_b128 v[160:163], v3 offset:6144
  v_mfma_f32_16x16x32_bf16 v[24:27], v[120:123], v[124:127], v[24:27]
  ds_read_b64_tr_b16 v[172:173], v6 offset:4096
  v_mfma_f32_16x16x32_bf16 v[40:43], v[120:123], v[128:131], v[40:43]
  ds_read_b64_tr_b16 v[174:175], v6 offset:4608
  v_mfma_f32_16x16x32_bf16 v[44:47], v[132:135], v[108:111], v[44:47]
  ds_read_b64_tr_b16 v[176:177], v7 offset:4096
  v_mfma_f32_16x16x32_bf16 v[48:51], v[132:135], v[112:115], v[48:51]
  ds_read_b64_tr_b16 v[178:179], v7 offset:4608
  v_mfma_f32_16x16x32_bf16 v[52:55], v[132:135], v[116:119], v[52:55]
  ds_read_b64_tr_b16 v[180:181], v8 offset:4096
  v_mfma_f32_16x16x32_bf16 v[56:59], v[132:135], v[120:123], v[56:59]
  ds_read_b64_tr_b16 v[182:183], v8 offset:4608
  v_mfma_f32_16x16x32_bf16 v[60:63], v[136:139], v[108:111], v[60:63]
  ds_read_b64_tr_b16 v[184:185], v9 offset:4096
  v_mfma_f32_16x16x32_bf16 v[64:67], v[136:139], v[112:115], v[64:67]
  ds_read_b64_tr_b16 v[186:187], v9 offset:4608
  v_mfma_f32_16x16x32_bf16 v[68:71], v[136:139], v[116:119], v[68:71]
  v_add_u32 v2, 40960, v2
  v_mfma_f32_16x16x32_bf16 v[72:75], v[136:139], v[120:123], v[72:75]
  v_add_u32 v3, 40960, v3
  v_mfma_f32_16x16x32_bf16 v[76:79], v[140:143], v[108:111], v[76:79]
  v_add_u32 v4, 40960, v4
  v_mfma_f32_16x16x32_bf16 v[80:83], v[140:143], v[112:115], v[80:83]
  v_add_u32 v5, 40960, v5
  v_mfma_f32_16x16x32_bf16 v[84:87], v[140:143], v[116:119], v[84:87]
  v_add_u32 v6, 40960, v6
  v_mfma_f32_16x16x32_bf16 v[88:91], v[140:143], v[120:123], v[88:91]
  v_add_u32 v7, 40960, v7
  v_mfma_f32_16x16x32_bf16 v[92:95], v[144:147], v[108:111], v[92:95]
  v_add_u32 v8, 40960, v8
  v_mfma_f32_16x16x32_bf16 v[96:99], v[144:147], v[112:115], v[96:99]
  v_add_u32 v9, 40960, v9
  v_mfma_f32_16x16x32_bf16 v[100:103], v[144:147], v[116:119], v[100:103]
  v_mfma_f32_16x16x32_bf16 v[104:107], v[144:147], v[120:123], v[104:107]
  s_waitcnt lgkmcnt(0)
  s_barrier
  v_mfma_f32_16x16x32_bf16 v[12:15], v[148:151], v[164:167], v[12:15]
  ds_read_b128 v[108:111], v2
  v_mfma_f32_16x16x32_bf16 v[28:31], v[148:151], v[168:171], v[28:31]
  ds_read_b128 v[124:127], v4 offset:0
  v_mfma_f32_16x16x32_bf16 v[16:19], v[152:155], v[164:167], v[16:19]
  ds_read_b128 v[128:131], v4 offset:2048
  v_mfma_f32_16x16x32_bf16 v[32:35], v[152:155], v[168:171], v[32:35]
  ds_read_b128 v[112:115], v2 offset:2048
  v_mfma_f32_16x16x32_bf16 v[20:23], v[156:159], v[164:167], v[20:23]
  ds_read_b128 v[116:119], v2 offset:4096
  v_mfma_f32_16x16x32_bf16 v[36:39], v[156:159], v[168:171], v[36:39]
  ds_read_b128 v[120:123], v2 offset:6144
  v_mfma_f32_16x16x32_bf16 v[24:27], v[160:163], v[164:167], v[24:27]
  ds_read_b64_tr_b16 v[132:133], v6 offset:0
  v_mfma_f32_16x16x32_bf16 v[40:43], v[160:163], v[168:171], v[40:43]
  ds_read_b64_tr_b16 v[134:135], v6 offset:512
  v_mfma_f32_16x16x32_bf16 v[44:47], v[172:175], v[148:151], v[44:47]
  ds_read_b64_tr_b16 v[136:137], v7 offset:0
  v_mfma_f32_16x16x32_bf16 v[48:51], v[172:175], v[152:155], v[48:51]
  ds_read_b64_tr_b16 v[138:139], v7 offset:512
  v_mfma_f32_16x16x32_bf16 v[52:55], v[172:175], v[156:159], v[52:55]
  ds_read_b64_tr_b16 v[140:141], v8 offset:0
  v_mfma_f32_16x16x32_bf16 v[56:59], v[172:175], v[160:163], v[56:59]
  ds_read_b64_tr_b16 v[142:143], v8 offset:512
  v_mfma_f32_16x16x32_bf16 v[60:63], v[176:179], v[148:151], v[60:63]
  ds_read_b64_tr_b16 v[144:145], v9 offset:0
  v_mfma_f32_16x16x32_bf16 v[64:67], v[176:179], v[152:155], v[64:67]
  ds_read_b64_tr_b16 v[146:147], v9 offset:512
  v_mfma_f32_16x16x32_bf16 v[68:71], v[176:179], v[156:159], v[68:71]
  v_mfma_f32_16x16x32_bf16 v[72:75], v[176:179], v[160:163], v[72:75]
  v_mfma_f32_16x16x32_bf16 v[76:79], v[180:183], v[148:151], v[76:79]
  v_mfma_f32_16x16x32_bf16 v[80:83], v[180:183], v[152:155], v[80:83]
  v_mfma_f32_16x16x32_bf16 v[84:87], v[180:183], v[156:159], v[84:87]
  v_mfma_f32_16x16x32_bf16 v[88:91], v[180:183], v[160:163], v[88:91]
  v_mfma_f32_16x16x32_bf16 v[92:95], v[184:187], v[148:151], v[92:95]
  v_mfma_f32_16x16x32_bf16 v[96:99], v[184:187], v[152:155], v[96:99]
  v_mfma_f32_16x16x32_bf16 v[100:103], v[184:187], v[156:159], v[100:103]
  v_mfma_f32_16x16x32_bf16 v[104:107], v[184:187], v[160:163], v[104:107]
  s_waitcnt lgkmcnt(0)
  v_mfma_f32_16x16x32_bf16 v[12:15], v[108:111], v[124:127], v[12:15]
  ds_read_b128 v[148:151], v3
  v_mfma_f32_16x16x32_bf16 v[28:31], v[108:111], v[128:131], v[28:31]
  ds_read_b128 v[164:167], v5 offset:0
  v_mfma_f32_16x16x32_bf16 v[16:19], v[112:115], v[124:127], v[16:19]
  ds_read_b128 v[168:171], v5 offset:2048
  v_mfma_f32_16x16x32_bf16 v[32:35], v[112:115], v[128:131], v[32:35]
  ds_read_b128 v[152:155], v3 offset:2048
  v_mfma_f32_16x16x32_bf16 v[20:23], v[116:119], v[124:127], v[20:23]
  ds_read_b128 v[156:159], v3 offset:4096
  v_mfma_f32_16x16x32_bf16 v[36:39], v[116:119], v[128:131], v[36:39]
  ds_read_b128 v[160:163], v3 offset:6144
  v_mfma_f32_16x16x32_bf16 v[24:27], v[120:123], v[124:127], v[24:27]
  ds_read_b64_tr_b16 v[172:173], v6 offset:4096
  v_mfma_f32_16x16x32_bf16 v[40:43], v[120:123], v[128:131], v[40:43]
  ds_read_b64_tr_b16 v[174:175], v6 offset:4608
  v_mfma_f32_16x16x32_bf16 v[44:47], v[132:135], v[108:111], v[44:47]
  ds_read_b64_tr_b16 v[176:177], v7 offset:4096
  v_mfma_f32_16x16x32_bf16 v[48:51], v[132:135], v[112:115], v[48:51]
  ds_read_b64_tr_b16 v[178:179], v7 offset:4608
  v_mfma_f32_16x16x32_bf16 v[52:55], v[132:135], v[116:119], v[52:55]
  ds_read_b64_tr_b16 v[180:181], v8 offset:4096
  v_mfma_f32_16x16x32_bf16 v[56:59], v[132:135], v[120:123], v[56:59]
  ds_read_b64_tr_b16 v[182:183], v8 offset:4608
  v_mfma_f32_16x16x32_bf16 v[60:63], v[136:139], v[108:111], v[60:63]
  ds_read_b64_tr_b16 v[184:185], v9 offset:4096
  v_mfma_f32_16x16x32_bf16 v[64:67], v[136:139], v[112:115], v[64:67]
  ds_read_b64_tr_b16 v[186:187], v9 offset:4608
  v_mfma_f32_16x16x32_bf16 v[68:71], v[136:139], v[116:119], v[68:71]
  v_subrev_u32 v2, 81920, v2
  v_mfma_f32_16x16x32_bf16 v[72:75], v[136:139], v[120:123], v[72:75]
  v_subrev_u32 v3, 81920, v3
  v_mfma_f32_16x16x32_bf16 v[76:79], v[140:143], v[108:111], v[76:79]
  v_subrev_u32 v4, 81920, v4
  v_mfma_f32_16x16x32_bf16 v[80:83], v[140:143], v[112:115], v[80:83]
  v_subrev_u32 v5, 81920, v5
  v_mfma_f32_16x16x32_bf16 v[84:87], v[140:143], v[116:119], v[84:87]
  v_subrev_u32 v6, 81920, v6
  v_mfma_f32_16x16x32_bf16 v[88:91], v[140:143], v[120:123], v[88:91]
  v_subrev_u32 v7, 81920, v7
  v_mfma_f32_16x16x32_bf16 v[92:95], v[144:147], v[108:111], v[92:95]
  v_subrev_u32 v8, 81920, v8
  v_mfma_f32_16x16x32_bf16 v[96:99], v[144:147], v[112:115], v[96:99]
  v_subrev_u32 v9, 81920, v9
  v_mfma_f32_16x16x32_bf16 v[100:103], v[144:147], v[116:119], v[100:103]
  v_mfma_f32_16x16x32_bf16 v[104:107], v[144:147], v[120:123], v[104:107]
  s_waitcnt lgkmcnt(0)
  s_barrier
  v_mfma_f32_16x16x32_bf16 v[12:15], v[148:151], v[164:167], v[12:15]
  ds_read_b128 v[108:111], v2
  v_mfma_f32_16x16x32_bf16 v[28:31], v[148:151], v[168:171], v[28:31]
  ds_read_b128 v[124:127], v4 offset:0
  v_mfma_f32_16x16x32_bf16 v[16:19], v[152:155], v[164:167], v[16:19]
  ds_read_b128 v[128:131], v4 offset:2048
  v_mfma_f32_16x16x32_bf16 v[32:35], v[152:155], v[168:171], v[32:35]
  ds_read_b128 v[112:115], v2 offset:2048
  v_mfma_f32_16x16x32_bf16 v[20:23], v[156:159], v[164:167], v[20:23]
  ds_read_b128 v[116:119], v2 offset:4096
  v_mfma_f32_16x16x32_bf16 v[36:39], v[156:159], v[168:171], v[36:39]
  ds_read_b128 v[120:123], v2 offset:6144
  v_mfma_f32_16x16x32_bf16 v[24:27], v[160:163], v[164:167], v[24:27]
  ds_read_b64_tr_b16 v[132:133], v6 offset:0
  v_mfma_f32_16x16x32_bf16 v[40:43], v[160:163], v[168:171], v[40:43]
  ds_read_b64_tr_b16 v[134:135], v6 offset:512
  v_mfma_f32_16x16x32_bf16 v[44:47], v[172:175], v[148:151], v[44:47]
  ds_read_b64_tr_b16 v[136:137], v7 offset:0
  v_mfma_f32_16x16x32_bf16 v[48:51], v[172:175], v[152:155], v[48:51]
  ds_read_b64_tr_b16 v[138:139], v7 offset:512
  v_mfma_f32_16x16x32_bf16 v[52:55], v[172:175], v[156:159], v[52:55]
  ds_read_b64_tr_b16 v[140:141], v8 offset:0
  v_mfma_f32_16x16x32_bf16 v[56:59], v[172:175], v[160:163], v[56:59]
  ds_read_b64_tr_b16 v[142:143], v8 offset:512
  v_mfma_f32_16x16x32_bf16 v[60:63], v[176:179], v[148:151], v[60:63]
  ds_read_b64_tr_b16 v[144:145], v9 offset:0
  v_mfma_f32_16x16x32_bf16 v[64:67], v[176:179], v[152:155], v[64:67]
  ds_read_b64_tr_b16 v[146:147], v9 offset:512
  v_mfma_f32_16x16x32_bf16 v[68:71], v[176:179], v[156:159], v[68:71]
  v_mfma_f32_16x16x32_bf16 v[72:75], v[176:179], v[160:163], v[72:75]
  v_mfma_f32_16x16x32_bf16 v[76:79], v[180:183], v[148:151], v[76:79]
  v_mfma_f32_16x16x32_bf16 v[80:83], v[180:183], v[152:155], v[80:83]
  v_mfma_f32_16x16x32_bf16 v[84:87], v[180:183], v[156:159], v[84:87]
  v_mfma_f32_16x16x32_bf16 v[88:91], v[180:183], v[160:163], v[88:91]
  v_mfma_f32_16x16x32_bf16 v[92:95], v[184:187], v[148:151], v[92:95]
  v_mfma_f32_16x16x32_bf16 v[96:99], v[184:187], v[152:155], v[96:99]
  v_mfma_f32_16x16x32_bf16 v[100:103], v[184:187], v[156:159], v[100:103]
  v_mfma_f32_16x16x32_bf16 v[104:107], v[184:187], v[160:163], v[104:107]
  s_waitcnt lgkmcnt(0)
  v_mfma_f32_16x16x32_bf16 v[12:15], v[108:111], v[124:127], v[12:15]
  ds_read_b128 v[148:151], v3
  v_mfma_f32_16x16x32_bf16 v[28:31], v[108:111], v[128:131], v[28:31]
  ds_read_b128 v[164:167], v5 offset:0
  v_mfma_f32_16x16x32_bf16 v[16:19], v[112:115], v[124:127], v[16:19]
  ds_read_b128 v[168:171], v5 offset:2048
  v_mfma_f32_16x16x32_bf16 v[32:35], v[112:115], v[128:131], v[32:35]
  ds_read_b128 v[152:155], v3 offset:2048
  v_mfma_f32_16x16x32_bf16 v[20:23], v[116:119], v[124:127], v[20:23]
  ds_read_b128 v[156:159], v3 offset:4096
  v_mfma_f32_16x16x32_bf16 v[36:39], v[116:119], v[128:131], v[36:39]
  ds_read_b128 v[160:163], v3 offset:6144
  v_mfma_f32_16x16x32_bf16 v[24:27], v[120:123], v[124:127], v[24:27]
  ds_read_b64_tr_b16 v[172:173], v6 offset:4096
  v_mfma_f32_16x16x32_bf16 v[40:43], v[120:123], v[128:131], v[40:43]
  ds_read_b64_tr_b16 v[174:175], v6 offset:4608
  v_mfma_f32_16x16x32_bf16 v[44:47], v[132:135], v[108:111], v[44:47]
  ds_read_b64_tr_b16 v[176:177], v7 offset:4096
  v_mfma_f32_16x16x32_bf16 v[48:51], v[132:135], v[112:115], v[48:51]
  ds_read_b64_tr_b16 v[178:179], v7 offset:4608
  v_mfma_f32_16x16x32_bf16 v[52:55], v[132:135], v[116:119], v[52:55]
  ds_read_b64_tr_b16 v[180:181], v8 offset:4096
  v_mfma_f32_16x16x32_bf16 v[56:59], v[132:135], v[120:123], v[56:59]
  ds_read_b64_tr_b16 v[182:183], v8 offset:4608
  v_mfma_f32_16x16x32_bf16 v[60:63], v[136:139], v[108:111], v[60:63]
  ds_read_b64_tr_b16 v[184:185], v9 offset:4096
  v_mfma_f32_16x16x32_bf16 v[64:67], v[136:139], v[112:115], v[64:67]
  ds_read_b64_tr_b16 v[186:187], v9 offset:4608
  v_mfma_f32_16x16x32_bf16 v[68:71], v[136:139], v[116:119], v[68:71]
  v_mfma_f32_16x16x32_bf16 v[72:75], v[136:139], v[120:123], v[72:75]
  v_mfma_f32_16x16x32_bf16 v[76:79], v[140:143], v[108:111], v[76:79]
  v_mfma_f32_16x16x32_bf16 v[80:83], v[140:143], v[112:115], v[80:83]
  v_mfma_f32_16x16x32_bf16 v[84:87], v[140:143], v[116:119], v[84:87]
  v_mfma_f32_16x16x32_bf16 v[88:91], v[140:143], v[120:123], v[88:91]
  v_mfma_f32_16x16x32_bf16 v[92:95], v[144:147], v[108:111], v[92:95]
  v_mfma_f32_16x16x32_bf16 v[96:99], v[144:147], v[112:115], v[96:99]
  v_mfma_f32_16x16x32_bf16 v[100:103], v[144:147], v[116:119], v[100:103]
  v_mfma_f32_16x16x32_bf16 v[104:107], v[144:147], v[120:123], v[104:107]
  s_waitcnt lgkmcnt(0)
  s_barrier
  v_mfma_f32_16x16x32_bf16 v[12:15], v[148:151], v[164:167], v[12:15]
  v_mfma_f32_16x16x32_bf16 v[28:31], v[148:151], v[168:171], v[28:31]
  v_mfma_f32_16x16x32_bf16 v[16:19], v[152:155], v[164:167], v[16:19]
  v_mfma_f32_16x16x32_bf16 v[32:35], v[152:155], v[168:171], v[32:35]
  v_mfma_f32_16x16x32_bf16 v[20:23], v[156:159], v[164:167], v[20:23]
  v_mfma_f32_16x16x32_bf16 v[36:39], v[156:159], v[168:171], v[36:39]
  v_mfma_f32_16x16x32_bf16 v[24:27], v[160:163], v[164:167], v[24:27]
  v_mfma_f32_16x16x32_bf16 v[40:43], v[160:163], v[168:171], v[40:43]
  v_mfma_f32_16x16x32_bf16 v[44:47], v[172:175], v[148:151], v[44:47]
  v_mfma_f32_16x16x32_bf16 v[48:51], v[172:175], v[152:155], v[48:51]
  v_mfma_f32_16x16x32_bf16 v[52:55], v[172:175], v[156:159], v[52:55]
  v_mfma_f32_16x16x32_bf16 v[56:59], v[172:175], v[160:163], v[56:59]
  v_mfma_f32_16x16x32_bf16 v[60:63], v[176:179], v[148:151], v[60:63]
  v_mfma_f32_16x16x32_bf16 v[64:67], v[176:179], v[152:155], v[64:67]
  v_mfma_f32_16x16x32_bf16 v[68:71], v[176:179], v[156:159], v[68:71]
  v_mfma_f32_16x16x32_bf16 v[72:75], v[176:179], v[160:163], v[72:75]
  v_mfma_f32_16x16x32_bf16 v[76:79], v[180:183], v[148:151], v[76:79]
  v_mfma_f32_16x16x32_bf16 v[80:83], v[180:183], v[152:155], v[80:83]
  v_mfma_f32_16x16x32_bf16 v[84:87], v[180:183], v[156:159], v[84:87]
  v_mfma_f32_16x16x32_bf16 v[88:91], v[180:183], v[160:163], v[88:91]
  v_mfma_f32_16x16x32_bf16 v[92:95], v[184:187], v[148:151], v[92:95]
  v_mfma_f32_16x16x32_bf16 v[96:99], v[184:187], v[152:155], v[96:99]
  v_mfma_f32_16x16x32_bf16 v[100:103], v[184:187], v[156:159], v[100:103]
  v_mfma_f32_16x16x32_bf16 v[104:107], v[184:187], v[160:163], v[104:107]
  v_mov_b32 v9, 122880
K1_tp_1:
  ds_read_b32 v7, v9 offset:0
  s_waitcnt lgkmcnt(0)
  v_readfirstlane_b32 s60, v7
  s_cmp_eq_u32 s60, 0
  s_cbranch_scc1 K1_tp_1
  s_nop 7

  v_and_b32 v1, 15, v0
  v_lshlrev_b32 v1, 4, v1
  s_lshl_b32 s60, s66, 8
  v_add_u32 v1, s60, v1
  v_add_u32 v1, 124160, v1
  ds_read_b128 v[166:169], v1
  ds_read_b128 v[170:173], v1 offset:512
  v_lshrrev_b32 v1, 4, v0
  v_lshlrev_b32 v1, 4, v1
  v_add_u32 v1, s64, v1
  v_add_u32 v1, 131712, v1

  ds_read_b128 v[174:177], v1 offset:0
  ds_read_b128 v[190:193], v1 offset:512
  ds_read_b128 v[178:181], v1 offset:64
  ds_read_b128 v[194:197], v1 offset:576
  ds_read_b128 v[182:185], v1 offset:128
  ds_read_b128 v[198:201], v1 offset:640
  ds_read_b128 v[186:189], v1 offset:192
  ds_read_b128 v[202:205], v1 offset:704
  s_waitcnt lgkmcnt(0)
  v_pk_fma_f32 v[206:207], v[170:171], v[174:175], v[190:191] op_sel_hi:[0,1,1] neg_lo:[1,0,0] neg_hi:[1,0,0]
  v_pk_fma_f32 v[206:207], v[166:167], v[44:45], v[206:207] op_sel_hi:[0,1,1]
  v_pk_fma_f32 v[208:209], v[170:171], v[176:177], v[192:193] op_sel_hi:[0,1,1] neg_lo:[1,0,0] neg_hi:[1,0,0]
  v_pk_fma_f32 v[208:209], v[166:167], v[46:47], v[208:209] op_sel_hi:[0,1,1]
  v_max_f32 v210, 0, v206
  v_max_f32 v211, 0, v207
  v_max_f32 v212, 0, v208
  v_max_f32 v213, 0, v209
  v_pk_mul_f32 v[206:207], v[206:207], v[210:211]
  v_pk_mul_f32 v[208:209], v[208:209], v[212:213]
  v_cvt_pk_bf16_f32 v214, v206, v207
  v_cvt_pk_bf16_f32 v215, v208, v209
  v_pk_fma_f32 v[206:207], v[170:171], v[178:179], v[194:195] op_sel_hi:[0,1,1] neg_lo:[1,0,0] neg_hi:[1,0,0]
  v_pk_fma_f32 v[206:207], v[166:167], v[60:61], v[206:207] op_sel_hi:[0,1,1]
  v_pk_fma_f32 v[208:209], v[170:171], v[180:181], v[196:197] op_sel_hi:[0,1,1] neg_lo:[1,0,0] neg_hi:[1,0,0]
  v_pk_fma_f32 v[208:209], v[166:167], v[62:63], v[208:209] op_sel_hi:[0,1,1]
  v_max_f32 v210, 0, v206
  v_max_f32 v211, 0, v207
  v_max_f32 v212, 0, v208
  v_max_f32 v213, 0, v209
  v_pk_mul_f32 v[206:207], v[206:207], v[210:211]
  v_pk_mul_f32 v[208:209], v[208:209], v[212:213]
  v_cvt_pk_bf16_f32 v216, v206, v207
  v_cvt_pk_bf16_f32 v217, v208, v209
  s_add_u32 s60, s65, 0
  buffer_store_dwordx4 v[214:217], v10, s[40:43], s60 offen sc1
  v_pk_fma_f32 v[206:207], v[170:171], v[174:175], v[190:191] op_sel:[1,0,0] neg_lo:[1,0,0] neg_hi:[1,0,0]
  v_pk_fma_f32 v[206:207], v[166:167], v[48:49], v[206:207] op_sel:[1,0,0]
  v_pk_fma_f32 v[208:209], v[170:171], v[176:177], v[192:193] op_sel:[1,0,0] neg_lo:[1,0,0] neg_hi:[1,0,0]
  v_pk_fma_f32 v[208:209], v[166:167], v[50:51], v[208:209] op_sel:[1,0,0]
  v_max_f32 v210, 0, v206
  v_max_f32 v211, 0, v207
  v_max_f32 v212, 0, v208
  v_max_f32 v213, 0, v209
  v_pk_mul_f32 v[206:207], v[206:207], v[210:211]
  v_pk_mul_f32 v[208:209], v[208:209], v[212:213]
  v_cvt_pk_bf16_f32 v218, v206, v207
  v_cvt_pk_bf16_f32 v219, v208, v209
  v_pk_fma_f32 v[206:207], v[170:171], v[178:179], v[194:195] op_sel:[1,0,0] neg_lo:[1,0,0] neg_hi:[1,0,0]
  v_pk_fma_f32 v[206:207], v[166:167], v[64:65], v[206:207] op_sel:[1,0,0]
  v_pk_fma_f32 v[208:209], v[170:171], v[180:181], v[196:197] op_sel:[1,0,0] neg_lo:[1,0,0] neg_hi:[1,0,0]
  v_pk_fma_f32 v[208:209], v[166:167], v[66:67], v[208:209] op_sel:[1,0,0]
  v_max_f32 v210, 0, v206
  v_max_f32 v211, 0, v207
  v_max_f32 v212, 0, v208
  v_max_f32 v213, 0, v209
  v_pk_mul_f32 v[206:207], v[206:207], v[210:211]
  v_pk_mul_f32 v[208:209], v[208:209], v[212:213]
  v_cvt_pk_bf16_f32 v220, v206, v207
  v_cvt_pk_bf16_f32 v221, v208, v209
  s_add_u32 s60, s65, 90112
  buffer_store_dwordx4 v[218:221], v10, s[40:43], s60 offen sc1
  v_pk_fma_f32 v[206:207], v[172:173], v[174:175], v[190:191] op_sel_hi:[0,1,1] neg_lo:[1,0,0] neg_hi:[1,0,0]
  v_pk_fma_f32 v[206:207], v[168:169], v[52:53], v[206:207] op_sel_hi:[0,1,1]
  v_pk_fma_f32 v[208:209], v[172:173], v[176:177], v[192:193] op_sel_hi:[0,1,1] neg_lo:[1,0,0] neg_hi:[1,0,0]
  v_pk_fma_f32 v[208:209], v[168:169], v[54:55], v[208:209] op_sel_hi:[0,1,1]
  v_max_f32 v210, 0, v206
  v_max_f32 v211, 0, v207
  v_max_f32 v212, 0, v208
  v_max_f32 v213, 0, v209
  v_pk_mul_f32 v[206:207], v[206:207], v[210:211]
  v_pk_mul_f32 v[208:209], v[208:209], v[212:213]
  v_cvt_pk_bf16_f32 v214, v206, v207
  v_cvt_pk_bf16_f32 v215, v208, v209
  v_pk_fma_f32 v[206:207], v[172:173], v[178:179], v[194:195] op_sel_hi:[0,1,1] neg_lo:[1,0,0] neg_hi:[1,0,0]
  v_pk_fma_f32 v[206:207], v[168:169], v[68:69], v[206:207] op_sel_hi:[0,1,1]
  v_pk_fma_f32 v[208:209], v[172:173], v[180:181], v[196:197] op_sel_hi:[0,1,1] neg_lo:[1,0,0] neg_hi:[1,0,0]
  v_pk_fma_f32 v[208:209], v[168:169], v[70:71], v[208:209] op_sel_hi:[0,1,1]
  v_max_f32 v210, 0, v206
  v_max_f32 v211, 0, v207
  v_max_f32 v212, 0, v208
  v_max_f32 v213, 0, v209
  v_pk_mul_f32 v[206:207], v[206:207], v[210:211]
  v_pk_mul_f32 v[208:209], v[208:209], v[212:213]
  v_cvt_pk_bf16_f32 v216, v206, v207
  v_cvt_pk_bf16_f32 v217, v208, v209
  s_add_u32 s60, s65, 180224
  buffer_store_dwordx4 v[214:217], v10, s[40:43], s60 offen sc1
  v_pk_fma_f32 v[206:207], v[172:173], v[174:175], v[190:191] op_sel:[1,0,0] neg_lo:[1,0,0] neg_hi:[1,0,0]
  v_pk_fma_f32 v[206:207], v[168:169], v[56:57], v[206:207] op_sel:[1,0,0]
  v_pk_fma_f32 v[208:209], v[172:173], v[176:177], v[192:193] op_sel:[1,0,0] neg_lo:[1,0,0] neg_hi:[1,0,0]
  v_pk_fma_f32 v[208:209], v[168:169], v[58:59], v[208:209] op_sel:[1,0,0]
  v_max_f32 v210, 0, v206
  v_max_f32 v211, 0, v207
  v_max_f32 v212, 0, v208
  v_max_f32 v213, 0, v209
  v_pk_mul_f32 v[206:207], v[206:207], v[210:211]
  v_pk_mul_f32 v[208:209], v[208:209], v[212:213]
  v_cvt_pk_bf16_f32 v218, v206, v207
  v_cvt_pk_bf16_f32 v219, v208, v209
  v_pk_fma_f32 v[206:207], v[172:173], v[178:179], v[194:195] op_sel:[1,0,0] neg_lo:[1,0,0] neg_hi:[1,0,0]
  v_pk_fma_f32 v[206:207], v[168:169], v[72:73], v[206:207] op_sel:[1,0,0]
  v_pk_fma_f32 v[208:209], v[172:173], v[180:181], v[196:197] op_sel:[1,0,0] neg_lo:[1,0,0] neg_hi:[1,0,0]
  v_pk_fma_f32 v[208:209], v[168:169], v[74:75], v[208:209] op_sel:[1,0,0]
  v_max_f32 v210, 0, v206
  v_max_f32 v211, 0, v207
  v_max_f32 v212, 0, v208
  v_max_f32 v213, 0, v209
  v_pk_mul_f32 v[206:207], v[206:207], v[210:211]
  v_pk_mul_f32 v[208:209], v[208:209], v[212:213]
  v_cvt_pk_bf16_f32 v220, v206, v207
  v_cvt_pk_bf16_f32 v221, v208, v209
  s_add_u32 s60, s65, 270336
  buffer_store_dwordx4 v[218:221], v10, s[40:43], s60 offen sc1
  v_pk_fma_f32 v[206:207], v[170:171], v[182:183], v[198:199] op_sel_hi:[0,1,1] neg_lo:[1,0,0] neg_hi:[1,0,0]
  v_pk_fma_f32 v[206:207], v[166:167], v[76:77], v[206:207] op_sel_hi:[0,1,1]
  v_pk_fma_f32 v[208:209], v[170:171], v[184:185], v[200:201] op_sel_hi:[0,1,1] neg_lo:[1,0,0] neg_hi:[1,0,0]
  v_pk_fma_f32 v[208:209], v[166:167], v[78:79], v[208:209] op_sel_hi:[0,1,1]
  v_max_f32 v210, 0, v206
  v_max_f32 v211, 0, v207
  v_max_f32 v212, 0, v208
  v_max_f32 v213, 0, v209
  v_pk_mul_f32 v[206:207], v[206:207], v[210:211]
  v_pk_mul_f32 v[208:209], v[208:209], v[212:213]
  v_cvt_pk_bf16_f32 v214, v206, v207
  v_cvt_pk_bf16_f32 v215, v208, v209
  v_pk_fma_f32 v[206:207], v[170:171], v[186:187], v[202:203] op_sel_hi:[0,1,1] neg_lo:[1,0,0] neg_hi:[1,0,0]
  v_pk_fma_f32 v[206:207], v[166:167], v[92:93], v[206:207] op_sel_hi:[0,1,1]
  v_pk_fma_f32 v[208:209], v[170:171], v[188:189], v[204:205] op_sel_hi:[0,1,1] neg_lo:[1,0,0] neg_hi:[1,0,0]
  v_pk_fma_f32 v[208:209], v[166:167], v[94:95], v[208:209] op_sel_hi:[0,1,1]
  v_max_f32 v210, 0, v206
  v_max_f32 v211, 0, v207
  v_max_f32 v212, 0, v208
  v_max_f32 v213, 0, v209
  v_pk_mul_f32 v[206:207], v[206:207], v[210:211]
  v_pk_mul_f32 v[208:209], v[208:209], v[212:213]
  v_cvt_pk_bf16_f32 v216, v206, v207
  v_cvt_pk_bf16_f32 v217, v208, v209
  s_add_u32 s60, s65, 1024
  buffer_store_dwordx4 v[214:217], v10, s[40:43], s60 offen sc1
  v_pk_fma_f32 v[206:207], v[170:171], v[182:183], v[198:199] op_sel:[1,0,0] neg_lo:[1,0,0] neg_hi:[1,0,0]
  v_pk_fma_f32 v[206:207], v[166:167], v[80:81], v[206:207] op_sel:[1,0,0]
  v_pk_fma_f32 v[208:209], v[170:171], v[184:185], v[200:201] op_sel:[1,0,0] neg_lo:[1,0,0] neg_hi:[1,0,0]
  v_pk_fma_f32 v[208:209], v[166:167], v[82:83], v[208:209] op_sel:[1,0,0]
  v_max_f32 v210, 0, v206
  v_max_f32 v211, 0, v207
  v_max_f32 v212, 0, v208
  v_max_f32 v213, 0, v209
  v_pk_mul_f32 v[206:207], v[206:207], v[210:211]
  v_pk_mul_f32 v[208:209], v[208:209], v[212:213]
  v_cvt_pk_bf16_f32 v218, v206, v207
  v_cvt_pk_bf16_f32 v219, v208, v209
  v_pk_fma_f32 v[206:207], v[170:171], v[186:187], v[202:203] op_sel:[1,0,0] neg_lo:[1,0,0] neg_hi:[1,0,0]
  v_pk_fma_f32 v[206:207], v[166:167], v[96:97], v[206:207] op_sel:[1,0,0]
  v_pk_fma_f32 v[208:209], v[170:171], v[188:189], v[204:205] op_sel:[1,0,0] neg_lo:[1,0,0] neg_hi:[1,0,0]
  v_pk_fma_f32 v[208:209], v[166:167], v[98:99], v[208:209] op_sel:[1,0,0]
  v_max_f32 v210, 0, v206
  v_max_f32 v211, 0, v207
  v_max_f32 v212, 0, v208
  v_max_f32 v213, 0, v209
  v_pk_mul_f32 v[206:207], v[206:207], v[210:211]
  v_pk_mul_f32 v[208:209], v[208:209], v[212:213]
  v_cvt_pk_bf16_f32 v220, v206, v207
  v_cvt_pk_bf16_f32 v221, v208, v209
  s_add_u32 s60, s65, 91136
  buffer_store_dwordx4 v[218:221], v10, s[40:43], s60 offen sc1
  v_pk_fma_f32 v[206:207], v[172:173], v[182:183], v[198:199] op_sel_hi:[0,1,1] neg_lo:[1,0,0] neg_hi:[1,0,0]
  v_pk_fma_f32 v[206:207], v[168:169], v[84:85], v[206:207] op_sel_hi:[0,1,1]
  v_pk_fma_f32 v[208:209], v[172:173], v[184:185], v[200:201] op_sel_hi:[0,1,1] neg_lo:[1,0,0] neg_hi:[1,0,0]
  v_pk_fma_f32 v[208:209], v[168:169], v[86:87], v[208:209] op_sel_hi:[0,1,1]
  v_max_f32 v210, 0, v206
  v_max_f32 v211, 0, v207
  v_max_f32 v212, 0, v208
  v_max_f32 v213, 0, v209
  v_pk_mul_f32 v[206:207], v[206:207], v[210:211]
  v_pk_mul_f32 v[208:209], v[208:209], v[212:213]
  v_cvt_pk_bf16_f32 v214, v206, v207
  v_cvt_pk_bf16_f32 v215, v208, v209
  v_pk_fma_f32 v[206:207], v[172:173], v[186:187], v[202:203] op_sel_hi:[0,1,1] neg_lo:[1,0,0] neg_hi:[1,0,0]
  v_pk_fma_f32 v[206:207], v[168:169], v[100:101], v[206:207] op_sel_hi:[0,1,1]
  v_pk_fma_f32 v[208:209], v[172:173], v[188:189], v[204:205] op_sel_hi:[0,1,1] neg_lo:[1,0,0] neg_hi:[1,0,0]
  v_pk_fma_f32 v[208:209], v[168:169], v[102:103], v[208:209] op_sel_hi:[0,1,1]
  v_max_f32 v210, 0, v206
  v_max_f32 v211, 0, v207
  v_max_f32 v212, 0, v208
  v_max_f32 v213, 0, v209
  v_pk_mul_f32 v[206:207], v[206:207], v[210:211]
  v_pk_mul_f32 v[208:209], v[208:209], v[212:213]
  v_cvt_pk_bf16_f32 v216, v206, v207
  v_cvt_pk_bf16_f32 v217, v208, v209
  s_add_u32 s60, s65, 181248
  buffer_store_dwordx4 v[214:217], v10, s[40:43], s60 offen sc1
  v_pk_fma_f32 v[206:207], v[172:173], v[182:183], v[198:199] op_sel:[1,0,0] neg_lo:[1,0,0] neg_hi:[1,0,0]
  v_pk_fma_f32 v[206:207], v[168:169], v[88:89], v[206:207] op_sel:[1,0,0]
  v_pk_fma_f32 v[208:209], v[172:173], v[184:185], v[200:201] op_sel:[1,0,0] neg_lo:[1,0,0] neg_hi:[1,0,0]
  v_pk_fma_f32 v[208:209], v[168:169], v[90:91], v[208:209] op_sel:[1,0,0]
  v_max_f32 v210, 0, v206
  v_max_f32 v211, 0, v207
  v_max_f32 v212, 0, v208
  v_max_f32 v213, 0, v209
  v_pk_mul_f32 v[206:207], v[206:207], v[210:211]
  v_pk_mul_f32 v[208:209], v[208:209], v[212:213]
  v_cvt_pk_bf16_f32 v218, v206, v207
  v_cvt_pk_bf16_f32 v219, v208, v209
  v_pk_fma_f32 v[206:207], v[172:173], v[186:187], v[202:203] op_sel:[1,0,0] neg_lo:[1,0,0] neg_hi:[1,0,0]
  v_pk_fma_f32 v[206:207], v[168:169], v[104:105], v[206:207] op_sel:[1,0,0]
  v_pk_fma_f32 v[208:209], v[172:173], v[188:189], v[204:205] op_sel:[1,0,0] neg_lo:[1,0,0] neg_hi:[1,0,0]
  v_pk_fma_f32 v[208:209], v[168:169], v[106:107], v[208:209] op_sel:[1,0,0]
  v_max_f32 v210, 0, v206
  v_max_f32 v211, 0, v207
  v_max_f32 v212, 0, v208
  v_max_f32 v213, 0, v209
  v_pk_mul_f32 v[206:207], v[206:207], v[210:211]
  v_pk_mul_f32 v[208:209], v[208:209], v[212:213]
  v_cvt_pk_bf16_f32 v220, v206, v207
  v_cvt_pk_bf16_f32 v221, v208, v209
  s_add_u32 s60, s65, 271360
  buffer_store_dwordx4 v[218:221], v10, s[40:43], s60 offen sc1

  v_lshrrev_b32 v1, 4, v0
  s_lshl_b32 s60, s66, 2
  v_add_u32 v1, s60, v1
  v_lshlrev_b32 v11, 6, v1
  v_add_u32 v11, 123136, v11

  ds_read_b128 v[108:111], v11 offset:0
  ds_read_b128 v[124:127], v11 offset:512
  ds_read_b128 v[112:115], v11 offset:16
  ds_read_b128 v[128:131], v11 offset:528
  ds_read_b128 v[116:119], v11 offset:32
  ds_read_b128 v[132:135], v11 offset:544
  ds_read_b128 v[120:123], v11 offset:48
  ds_read_b128 v[136:139], v11 offset:560

  v_and_b32 v11, 15, v0
  s_lshl_b32 s60, s67, 4
  v_add_u32 v11, s60, v11
  v_lshlrev_b32 v9, 5, v11
  v_add_u32 v9, 125568, v9
  v_lshlrev_b32 v11, 3, v11
  v_add_u32 v11, 125184, v11
  v_lshlrev_b32 v8, 7, v1
  v_and_b32 v7, 15, v0
  v_lshl_add_u32 v8, v7, 3, v8
  s_mul_i32 s60, s67, 1024
  v_add_u32 v7, s60, v8
  v_add_u32 v7, 128640, v7
  s_mul_i32 s60, s67, 1920
  v_add_u32 v8, s60, v8
  v_add_u32 v8, 132736, v8

  ds_read_b128 v[140:143], v9 offset:0
  ds_read_b128 v[144:147], v9 offset:16
  ds_read_b64 v[148:149], v11 offset:0
  ds_read_b64 v[150:151], v7 offset:0
  s_waitcnt lgkmcnt(0)
  v_pk_mul_f32 v[12:13], v[108:109], v[12:13]
  v_pk_mul_f32 v[28:29], v[108:109], v[28:29]
  v_pk_fma_f32 v[12:13], v[124:125], v[148:149], v[12:13] op_sel_hi:[1,0,1] neg_lo:[1,0,0] neg_hi:[1,0,0]
  v_pk_fma_f32 v[28:29], v[124:125], v[148:149], v[28:29] op_sel:[0,1,0] neg_lo:[1,0,0] neg_hi:[1,0,0]
  v_pk_mul_f32 v[14:15], v[110:111], v[14:15]
  v_pk_mul_f32 v[30:31], v[110:111], v[30:31]
  v_pk_fma_f32 v[14:15], v[126:127], v[148:149], v[14:15] op_sel_hi:[1,0,1] neg_lo:[1,0,0] neg_hi:[1,0,0]
  v_pk_fma_f32 v[30:31], v[126:127], v[148:149], v[30:31] op_sel:[0,1,0] neg_lo:[1,0,0] neg_hi:[1,0,0]
  v_pk_mul_f32 v[16:17], v[112:113], v[16:17]
  v_pk_mul_f32 v[32:33], v[112:113], v[32:33]
  v_pk_fma_f32 v[16:17], v[128:129], v[148:149], v[16:17] op_sel_hi:[1,0,1] neg_lo:[1,0,0] neg_hi:[1,0,0]
  v_pk_fma_f32 v[32:33], v[128:129], v[148:149], v[32:33] op_sel:[0,1,0] neg_lo:[1,0,0] neg_hi:[1,0,0]
  v_pk_mul_f32 v[18:19], v[114:115], v[18:19]
  v_pk_mul_f32 v[34:35], v[114:115], v[34:35]
  v_pk_fma_f32 v[18:19], v[130:131], v[148:149], v[18:19] op_sel_hi:[1,0,1] neg_lo:[1,0,0] neg_hi:[1,0,0]
  v_pk_fma_f32 v[34:35], v[130:131], v[148:149], v[34:35] op_sel:[0,1,0] neg_lo:[1,0,0] neg_hi:[1,0,0]
  v_pk_mul_f32 v[20:21], v[116:117], v[20:21]
  v_pk_mul_f32 v[36:37], v[116:117], v[36:37]
  v_pk_fma_f32 v[20:21], v[132:133], v[148:149], v[20:21] op_sel_hi:[1,0,1] neg_lo:[1,0,0] neg_hi:[1,0,0]
  v_pk_fma_f32 v[36:37], v[132:133], v[148:149], v[36:37] op_sel:[0,1,0] neg_lo:[1,0,0] neg_hi:[1,0,0]
  v_pk_mul_f32 v[22:23], v[118:119], v[22:23]
  v_pk_mul_f32 v[38:39], v[118:119], v[38:39]
  v_pk_fma_f32 v[22:23], v[134:135], v[148:149], v[22:23] op_sel_hi:[1,0,1] neg_lo:[1,0,0] neg_hi:[1,0,0]
  v_pk_fma_f32 v[38:39], v[134:135], v[148:149], v[38:39] op_sel:[0,1,0] neg_lo:[1,0,0] neg_hi:[1,0,0]
  v_pk_mul_f32 v[24:25], v[120:121], v[24:25]
  v_pk_mul_f32 v[40:41], v[120:121], v[40:41]
  v_pk_fma_f32 v[24:25], v[136:137], v[148:149], v[24:25] op_sel_hi:[1,0,1] neg_lo:[1,0,0] neg_hi:[1,0,0]
  v_pk_fma_f32 v[40:41], v[136:137], v[148:149], v[40:41] op_sel:[0,1,0] neg_lo:[1,0,0] neg_hi:[1,0,0]
  v_pk_mul_f32 v[26:27], v[122:123], v[26:27]
  v_pk_mul_f32 v[42:43], v[122:123], v[42:43]
  v_pk_fma_f32 v[26:27], v[138:139], v[148:149], v[26:27] op_sel_hi:[1,0,1] neg_lo:[1,0,0] neg_hi:[1,0,0]
  v_pk_fma_f32 v[42:43], v[138:139], v[148:149], v[42:43] op_sel:[0,1,0] neg_lo:[1,0,0] neg_hi:[1,0,0]
  v_pk_fma_f32 v[156:157], v[140:141], v[12:13], v[14:15] op_sel_hi:[0,1,1]
  v_pk_fma_f32 v[158:159], v[140:141], v[28:29], v[30:31] op_sel_hi:[0,1,1]
  v_pk_fma_f32 v[156:157], v[140:141], v[28:29], v[156:157] op_sel:[1,0,0] neg_lo:[1,0,0] neg_hi:[1,0,0]
  v_pk_fma_f32 v[158:159], v[140:141], v[12:13], v[158:159] op_sel:[1,0,0]
  v_pk_fma_f32 v[160:161], v[140:141], v[156:157], v[16:17] op_sel_hi:[0,1,1]
  v_pk_fma_f32 v[162:163], v[140:141], v[158:159], v[32:33] op_sel_hi:[0,1,1]
  v_pk_fma_f32 v[160:161], v[140:141], v[158:159], v[160:161] op_sel:[1,0,0] neg_lo:[1,0,0] neg_hi:[1,0,0]
  v_pk_fma_f32 v[162:163], v[140:141], v[156:157], v[162:163] op_sel:[1,0,0]
  v_pk_fma_f32 v[156:157], v[140:141], v[160:161], v[18:19] op_sel_hi:[0,1,1]
  v_pk_fma_f32 v[158:159], v[140:141], v[162:163], v[34:35] op_sel_hi:[0,1,1]
  v_pk_fma_f32 v[156:157], v[140:141], v[162:163], v[156:157] op_sel:[1,0,0] neg_lo:[1,0,0] neg_hi:[1,0,0]
  v_pk_fma_f32 v[158:159], v[140:141], v[160:161], v[158:159] op_sel:[1,0,0]
  v_pk_fma_f32 v[160:161], v[140:141], v[156:157], v[20:21] op_sel_hi:[0,1,1]
  v_pk_fma_f32 v[162:163], v[140:141], v[158:159], v[36:37] op_sel_hi:[0,1,1]
  v_pk_fma_f32 v[160:161], v[140:141], v[158:159], v[160:161] op_sel:[1,0,0] neg_lo:[1,0,0] neg_hi:[1,0,0]
  v_pk_fma_f32 v[162:163], v[140:141], v[156:157], v[162:163] op_sel:[1,0,0]
  v_pk_fma_f32 v[156:157], v[140:141], v[160:161], v[22:23] op_sel_hi:[0,1,1]
  v_pk_fma_f32 v[158:159], v[140:141], v[162:163], v[38:39] op_sel_hi:[0,1,1]
  v_pk_fma_f32 v[156:157], v[140:141], v[162:163], v[156:157] op_sel:[1,0,0] neg_lo:[1,0,0] neg_hi:[1,0,0]
  v_pk_fma_f32 v[158:159], v[140:141], v[160:161], v[158:159] op_sel:[1,0,0]
  v_pk_fma_f32 v[160:161], v[140:141], v[156:157], v[24:25] op_sel_hi:[0,1,1]
  v_pk_fma_f32 v[162:163], v[140:141], v[158:159], v[40:41] op_sel_hi:[0,1,1]
  v_pk_fma_f32 v[160:161], v[140:141], v[158:159], v[160:161] op_sel:[1,0,0] neg_lo:[1,0,0] neg_hi:[1,0,0]
  v_pk_fma_f32 v[162:163], v[140:141], v[156:157], v[162:163] op_sel:[1,0,0]
  v_pk_fma_f32 v[156:157], v[140:141], v[160:161], v[26:27] op_sel_hi:[0,1,1]
  v_pk_fma_f32 v[158:159], v[140:141], v[162:163], v[42:43] op_sel_hi:[0,1,1]
  v_pk_fma_f32 v[156:157], v[140:141], v[162:163], v[156:157] op_sel:[1,0,0] neg_lo:[1,0,0] neg_hi:[1,0,0]
  v_pk_fma_f32 v[158:159], v[140:141], v[160:161], v[158:159] op_sel:[1,0,0]
  v_mov_b32 v152, v156
  v_mov_b32 v153, v158
  v_fma_f32 v164, v142, v156, v157
  v_fma_f32 v165, v142, v158, v159
  v_fma_f32 v164, -v143, v158, v164
  v_fma_f32 v165, v143, v156, v165
  ds_write_b64 v8, v[164:165] offset:896

  v_mov_b32 v9, 122888
  s_lshl_b32 s60, s67, 2
  v_add_u32 v9, s60, v9
  s_cmp_eq_u32 s66, 0
  s_cbranch_scc0 K1_e1_1
  v_mov_b32 v7, 1
  s_waitcnt lgkmcnt(0)
  ds_write_b32 v9, v7
  s_branch K1_e2_1
K1_e1_1:
K1_ep_1:
  ds_read_b32 v7, v9 offset:0
  s_waitcnt lgkmcnt(0)
  v_readfirstlane_b32 s60, v7
  s_cmp_eq_u32 s60, 0
  s_cbranch_scc1 K1_ep_1
K1_e2_1:
  ds_read_b64 v[166:167], v8 offset:0
  ds_read_b64 v[168:169], v8 offset:128
  ds_read_b64 v[170:171], v8 offset:256
  ds_read_b64 v[172:173], v8 offset:384
  ds_read_b64 v[174:175], v8 offset:512
  ds_read_b64 v[176:177], v8 offset:640
  ds_read_b64 v[178:179], v8 offset:768
  s_waitcnt lgkmcnt(0)
  v_pk_fma_f32 v[156:157], v[144:145], v[166:167], v[168:169] op_sel_hi:[0,1,1]
  v_pk_fma_f32 v[156:157], v[144:145], v[166:167], v[156:157] op_sel:[1,1,0] op_sel_hi:[1,0,1] neg_lo:[0,1,0]
  v_pk_fma_f32 v[160:161], v[144:145], v[156:157], v[170:171] op_sel_hi:[0,1,1]
  v_pk_fma_f32 v[160:161], v[144:145], v[156:157], v[160:161] op_sel:[1,1,0] op_sel_hi:[1,0,1] neg_lo:[0,1,0]
  v_pk_fma_f32 v[156:157], v[144:145], v[160:161], v[172:173] op_sel_hi:[0,1,1]
  v_pk_fma_f32 v[156:157], v[144:145], v[160:161], v[156:157] op_sel:[1,1,0] op_sel_hi:[1,0,1] neg_lo:[0,1,0]
  v_pk_fma_f32 v[160:161], v[144:145], v[156:157], v[174:175] op_sel_hi:[0,1,1]
  v_pk_fma_f32 v[160:161], v[144:145], v[156:157], v[160:161] op_sel:[1,1,0] op_sel_hi:[1,0,1] neg_lo:[0,1,0]
  v_pk_fma_f32 v[156:157], v[144:145], v[160:161], v[176:177] op_sel_hi:[0,1,1]
  v_pk_fma_f32 v[156:157], v[144:145], v[160:161], v[156:157] op_sel:[1,1,0] op_sel_hi:[1,0,1] neg_lo:[0,1,0]
  v_pk_fma_f32 v[154:155], v[144:145], v[156:157], v[178:179] op_sel_hi:[0,1,1]
  v_pk_fma_f32 v[154:155], v[144:145], v[156:157], v[154:155] op_sel:[1,1,0] op_sel_hi:[1,0,1] neg_lo:[0,1,0]

  s_cmp_eq_u32 s66, 1
  s_cbranch_scc0 K1_nopub_1
  v_mov_b32 v9, 122912
  ds_read_b32 v7, v9
  v_and_b32 v1, 15, v0
  s_add_u32 s60, s32, s67
  s_lshl_b32 s60, s60, 4
  s_mul_i32 s61, s29, 640
  s_add_u32 s60, s60, s61
  v_add_u32 v1, s60, v1
  v_lshlrev_b32 v1, 4, v1
  v_add_u32 v1, 65536, v1
  s_waitcnt lgkmcnt(0)

  v_pk_fma_f32 v[160:161], v[144:145], v[154:155], v[164:165] op_sel_hi:[0,1,1]
  v_pk_fma_f32 v[160:161], v[144:145], v[154:155], v[160:161] op_sel:[1,1,0] op_sel_hi:[1,0,1] neg_lo:[0,1,0]
  v_mov_b32 v156, v160
  v_mov_b32 v157, v7
  v_mov_b32 v158, v161
  v_mov_b32 v159, v7
  s_mov_b32 exec_lo, 0
  s_mov_b32 exec_hi, 0xffff0000
  buffer_store_dwordx4 v[156:159], v1, s[44:47], 0 offen offset:0 sc1
  s_mov_b64 exec, -1
K1_nopub_1:
  s_waitcnt vmcnt(0)
  v_mov_b32 v9, 122912
  ds_read_b32 v7, v9
  s_lshl_b32 s60, s29, 1
  s_add_u32 s60, s60, s66
  s_lshl_b32 s60, s60, 7
  s_lshl_b32 s61, s30, 1
  s_add_u32 s61, s61, s69
  s_lshl_b32 s61, s61, 2
  s_add_u32 s78, s60, s61
  s_add_u32 s60, s78, 528384
  v_mov_b32 v1, s60
  s_waitcnt lgkmcnt(0)
  v_readfirstlane_b32 s79, v7
  s_mov_b64 exec, 1
  buffer_store_dword v7, v1, s[44:47], 0 offen sc1
  s_lshl_b32 s60, s28, 2
  s_add_u32 s60, s60, 122928
  v_mov_b32 v9, s60
  v_mov_b32 v7, 1
  ds_write_b32 v9, v7
  s_mov_b64 exec, -1
  v_mov_b32 v9, 122884
K1_hp_1:
  ds_read_b32 v7, v9 offset:0
  s_waitcnt lgkmcnt(0)
  v_readfirstlane_b32 s60, v7
  s_cmp_eq_u32 s60, 0
  s_cbranch_scc1 K1_hp_1
  ds_read_b64 v[156:157], v11 offset:13312
  s_waitcnt lgkmcnt(0)
  v_pk_fma_f32 v[158:159], v[150:151], v[156:157], v[154:155] op_sel_hi:[0,1,1]
  v_pk_fma_f32 v[158:159], v[150:151], v[156:157], v[158:159] op_sel:[1,1,0] op_sel_hi:[1,0,1] neg_lo:[0,1,0]
  v_pk_fma_f32 v[160:161], v[142:143], v[158:159], v[152:153] op_sel_hi:[0,1,1]
  v_pk_fma_f32 v[160:161], v[142:143], v[158:159], v[160:161] op_sel:[1,1,0] op_sel_hi:[1,0,1] neg_lo:[0,1,0]
  v_mov_b32 v156, v158
  v_mov_b32 v157, v160
  v_mov_b32 v162, v159
  v_mov_b32 v163, v161
  v_pk_fma_f32 v[12:13], v[140:141], v[156:157], v[12:13] op_sel_hi:[0,1,1]
  v_pk_fma_f32 v[28:29], v[140:141], v[162:163], v[28:29] op_sel_hi:[0,1,1]
  v_pk_fma_f32 v[12:13], v[140:141], v[162:163], v[12:13] op_sel:[1,0,0] neg_lo:[1,0,0] neg_hi:[1,0,0]
  v_pk_fma_f32 v[28:29], v[140:141], v[156:157], v[28:29] op_sel:[1,0,0]
  v_pk_fma_f32 v[14:15], v[140:141], v[12:13], v[14:15] op_sel_hi:[0,1,1]
  v_pk_fma_f32 v[30:31], v[140:141], v[28:29], v[30:31] op_sel_hi:[0,1,1]
  v_pk_fma_f32 v[14:15], v[140:141], v[28:29], v[14:15] op_sel:[1,0,0] neg_lo:[1,0,0] neg_hi:[1,0,0]
  v_pk_fma_f32 v[30:31], v[140:141], v[12:13], v[30:31] op_sel:[1,0,0]
  v_pk_fma_f32 v[16:17], v[140:141], v[14:15], v[16:17] op_sel_hi:[0,1,1]
  v_pk_fma_f32 v[32:33], v[140:141], v[30:31], v[32:33] op_sel_hi:[0,1,1]
  v_pk_fma_f32 v[16:17], v[140:141], v[30:31], v[16:17] op_sel:[1,0,0] neg_lo:[1,0,0] neg_hi:[1,0,0]
  v_pk_fma_f32 v[32:33], v[140:141], v[14:15], v[32:33] op_sel:[1,0,0]
  v_pk_fma_f32 v[18:19], v[140:141], v[16:17], v[18:19] op_sel_hi:[0,1,1]
  v_pk_fma_f32 v[34:35], v[140:141], v[32:33], v[34:35] op_sel_hi:[0,1,1]
  v_pk_fma_f32 v[18:19], v[140:141], v[32:33], v[18:19] op_sel:[1,0,0] neg_lo:[1,0,0] neg_hi:[1,0,0]
  v_pk_fma_f32 v[34:35], v[140:141], v[16:17], v[34:35] op_sel:[1,0,0]
  v_pk_fma_f32 v[20:21], v[140:141], v[18:19], v[20:21] op_sel_hi:[0,1,1]
  v_pk_fma_f32 v[36:37], v[140:141], v[34:35], v[36:37] op_sel_hi:[0,1,1]
  v_pk_fma_f32 v[20:21], v[140:141], v[34:35], v[20:21] op_sel:[1,0,0] neg_lo:[1,0,0] neg_hi:[1,0,0]
  v_pk_fma_f32 v[36:37], v[140:141], v[18:19], v[36:37] op_sel:[1,0,0]
  v_pk_fma_f32 v[22:23], v[140:141], v[20:21], v[22:23] op_sel_hi:[0,1,1]
  v_pk_fma_f32 v[38:39], v[140:141], v[36:37], v[38:39] op_sel_hi:[0,1,1]
  v_pk_fma_f32 v[22:23], v[140:141], v[36:37], v[22:23] op_sel:[1,0,0] neg_lo:[1,0,0] neg_hi:[1,0,0]
  v_pk_fma_f32 v[38:39], v[140:141], v[20:21], v[38:39] op_sel:[1,0,0]
  v_pk_fma_f32 v[24:25], v[140:141], v[22:23], v[24:25] op_sel_hi:[0,1,1]
  v_pk_fma_f32 v[40:41], v[140:141], v[38:39], v[40:41] op_sel_hi:[0,1,1]
  v_pk_fma_f32 v[24:25], v[140:141], v[38:39], v[24:25] op_sel:[1,0,0] neg_lo:[1,0,0] neg_hi:[1,0,0]
  v_pk_fma_f32 v[40:41], v[140:141], v[22:23], v[40:41] op_sel:[1,0,0]
  v_pk_fma_f32 v[26:27], v[140:141], v[24:25], v[26:27] op_sel_hi:[0,1,1]
  v_pk_fma_f32 v[42:43], v[140:141], v[40:41], v[42:43] op_sel_hi:[0,1,1]
  v_pk_fma_f32 v[26:27], v[140:141], v[40:41], v[26:27] op_sel:[1,0,0] neg_lo:[1,0,0] neg_hi:[1,0,0]
  v_pk_fma_f32 v[42:43], v[140:141], v[24:25], v[42:43] op_sel:[1,0,0]

  v_and_b32 v1, 15, v0
  v_lshlrev_b32 v1, 5, v1
  v_lshrrev_b32 v7, 4, v0
  v_lshl_add_u32 v1, v7, 3, v1
  s_lshl_b32 s60, s28, 12
  s_add_u32 s60, s60, 139264
  v_add_u32 v1, s60, v1
  v_lshlrev_b32 v7, 3, v0
  v_add_u32 v7, s60, v7

  v_pk_mul_f32 v[166:167], v[146:147], v[12:13] op_sel_hi:[0,1]
  v_pk_mul_f32 v[170:171], v[146:147], v[28:29] op_sel_hi:[0,1] neg_lo:[1,0] neg_hi:[1,0]
  v_pk_mul_f32 v[168:169], v[146:147], v[14:15] op_sel_hi:[0,1]
  v_pk_mul_f32 v[172:173], v[146:147], v[30:31] op_sel_hi:[0,1] neg_lo:[1,0] neg_hi:[1,0]
  v_pk_fma_f32 v[166:167], v[146:147], v[28:29], v[166:167] op_sel:[1,0,0] neg_lo:[1,0,0] neg_hi:[1,0,0]
  v_pk_fma_f32 v[170:171], v[146:147], v[12:13], v[170:171] op_sel:[1,0,0] neg_lo:[1,0,0] neg_hi:[1,0,0]
  v_pk_fma_f32 v[168:169], v[146:147], v[30:31], v[168:169] op_sel:[1,0,0] neg_lo:[1,0,0] neg_hi:[1,0,0]
  v_pk_fma_f32 v[172:173], v[146:147], v[14:15], v[172:173] op_sel:[1,0,0] neg_lo:[1,0,0] neg_hi:[1,0,0]
  v_cvt_pk_bf16_f32 v182, v166, v167
  v_cvt_pk_bf16_f32 v183, v168, v169
  v_cvt_pk_bf16_f32 v184, v170, v171
  v_cvt_pk_bf16_f32 v185, v172, v173
  ds_write_b64 v1, v[182:183] offset:0
  ds_write_b64 v1, v[184:185] offset:512
  v_pk_mul_f32 v[174:175], v[146:147], v[16:17] op_sel_hi:[0,1]
  v_pk_mul_f32 v[178:179], v[146:147], v[32:33] op_sel_hi:[0,1] neg_lo:[1,0] neg_hi:[1,0]
  v_pk_mul_f32 v[176:177], v[146:147], v[18:19] op_sel_hi:[0,1]
  v_pk_mul_f32 v[180:181], v[146:147], v[34:35] op_sel_hi:[0,1] neg_lo:[1,0] neg_hi:[1,0]
  v_pk_fma_f32 v[174:175], v[146:147], v[32:33], v[174:175] op_sel:[1,0,0] neg_lo:[1,0,0] neg_hi:[1,0,0]
  v_pk_fma_f32 v[178:179], v[146:147], v[16:17], v[178:179] op_sel:[1,0,0] neg_lo:[1,0,0] neg_hi:[1,0,0]
  v_pk_fma_f32 v[176:177], v[146:147], v[34:35], v[176:177] op_sel:[1,0,0] neg_lo:[1,0,0] neg_hi:[1,0,0]
  v_pk_fma_f32 v[180:181], v[146:147], v[18:19], v[180:181] op_sel:[1,0,0] neg_lo:[1,0,0] neg_hi:[1,0,0]
  v_cvt_pk_bf16_f32 v186, v174, v175
  v_cvt_pk_bf16_f32 v187, v176, v177
  v_cvt_pk_bf16_f32 v188, v178, v179
  v_cvt_pk_bf16_f32 v189, v180, v181
  ds_write_b64 v1, v[186:187] offset:1024
  ds_write_b64 v1, v[188:189] offset:1536
  v_pk_mul_f32 v[166:167], v[146:147], v[20:21] op_sel_hi:[0,1]
  v_pk_mul_f32 v[170:171], v[146:147], v[36:37] op_sel_hi:[0,1] neg_lo:[1,0] neg_hi:[1,0]
  v_pk_mul_f32 v[168:169], v[146:147], v[22:23] op_sel_hi:[0,1]
  v_pk_mul_f32 v[172:173], v[146:147], v[38:39] op_sel_hi:[0,1] neg_lo:[1,0] neg_hi:[1,0]
  v_pk_fma_f32 v[166:167], v[146:147], v[36:37], v[166:167] op_sel:[1,0,0] neg_lo:[1,0,0] neg_hi:[1,0,0]
  v_pk_fma_f32 v[170:171], v[146:147], v[20:21], v[170:171] op_sel:[1,0,0] neg_lo:[1,0,0] neg_hi:[1,0,0]
  v_pk_fma_f32 v[168:169], v[146:147], v[38:39], v[168:169] op_sel:[1,0,0] neg_lo:[1,0,0] neg_hi:[1,0,0]
  v_pk_fma_f32 v[172:173], v[146:147], v[22:23], v[172:173] op_sel:[1,0,0] neg_lo:[1,0,0] neg_hi:[1,0,0]
  v_cvt_pk_bf16_f32 v182, v166, v167
  v_cvt_pk_bf16_f32 v183, v168, v169
  v_cvt_pk_bf16_f32 v184, v170, v171
  v_cvt_pk_bf16_f32 v185, v172, v173
  ds_write_b64 v1, v[182:183] offset:2048
  ds_write_b64 v1, v[184:185] offset:2560
  v_pk_mul_f32 v[174:175], v[146:147], v[24:25] op_sel_hi:[0,1]
  v_pk_mul_f32 v[178:179], v[146:147], v[40:41] op_sel_hi:[0,1] neg_lo:[1,0] neg_hi:[1,0]
  v_pk_mul_f32 v[176:177], v[146:147], v[26:27] op_sel_hi:[0,1]
  v_pk_mul_f32 v[180:181], v[146:147], v[42:43] op_sel_hi:[0,1] neg_lo:[1,0] neg_hi:[1,0]
  v_pk_fma_f32 v[174:175], v[146:147], v[40:41], v[174:175] op_sel:[1,0,0] neg_lo:[1,0,0] neg_hi:[1,0,0]
  v_pk_fma_f32 v[178:179], v[146:147], v[24:25], v[178:179] op_sel:[1,0,0] neg_lo:[1,0,0] neg_hi:[1,0,0]
  v_pk_fma_f32 v[176:177], v[146:147], v[42:43], v[176:177] op_sel:[1,0,0] neg_lo:[1,0,0] neg_hi:[1,0,0]
  v_pk_fma_f32 v[180:181], v[146:147], v[26:27], v[180:181] op_sel:[1,0,0] neg_lo:[1,0,0] neg_hi:[1,0,0]
  v_cvt_pk_bf16_f32 v186, v174, v175
  v_cvt_pk_bf16_f32 v187, v176, v177
  v_cvt_pk_bf16_f32 v188, v178, v179
  v_cvt_pk_bf16_f32 v189, v180, v181
  ds_write_b64 v1, v[186:187] offset:3072
  ds_write_b64 v1, v[188:189] offset:3584
  ds_read_b64_tr_b16 v[190:191], v7 offset:0
  ds_read_b64_tr_b16 v[192:193], v7 offset:512
  ds_read_b64_tr_b16 v[194:195], v7 offset:1024
  ds_read_b64_tr_b16 v[196:197], v7 offset:1536
  ds_read_b64_tr_b16 v[198:199], v7 offset:2048
  ds_read_b64_tr_b16 v[200:201], v7 offset:2560
  ds_read_b64_tr_b16 v[202:203], v7 offset:3072
  ds_read_b64_tr_b16 v[204:205], v7 offset:3584
  s_waitcnt lgkmcnt(6)
  s_add_u32 s60, s68, 0
  buffer_store_dwordx4 v[190:193], v10, s[40:43], s60 offen sc1
  s_waitcnt lgkmcnt(4)
  s_add_u32 s60, s68, 90112
  buffer_store_dwordx4 v[194:197], v10, s[40:43], s60 offen sc1
  s_waitcnt lgkmcnt(2)
  s_add_u32 s60, s68, 180224
  buffer_store_dwordx4 v[198:201], v10, s[40:43], s60 offen sc1
  s_waitcnt lgkmcnt(0)
  s_add_u32 s60, s68, 270336
  buffer_store_dwordx4 v[202:205], v10, s[40:43], s60 offen sc1
  s_lshl_b32 s60, s28, 2
  s_add_u32 s60, s60, 122944
  v_mov_b32 v9, s60
  v_mov_b32 v7, 1
  ds_write_b32 v9, v7
  s_branch K2_compute
K1_Q:
  v_mov_b32 v12, 0
  v_mov_b32 v13, 0
  v_mov_b32 v14, 0
  v_mov_b32 v15, 0
  v_mov_b32 v16, 0
  v_mov_b32 v17, 0
  v_mov_b32 v18, 0
  v_mov_b32 v19, 0
  v_mov_b32 v20, 0
  v_mov_b32 v21, 0
  v_mov_b32 v22, 0
  v_mov_b32 v23, 0
  v_mov_b32 v24, 0
  v_mov_b32 v25, 0
  v_mov_b32 v26, 0
  v_mov_b32 v27, 0
  v_mov_b32 v28, 0
  v_mov_b32 v29, 0
  v_mov_b32 v30, 0
  v_mov_b32 v31, 0
  v_mov_b32 v32, 0
  v_mov_b32 v33, 0
  v_mov_b32 v34, 0
  v_mov_b32 v35, 0
  v_mov_b32 v36, 0
  v_mov_b32 v37, 0
  v_mov_b32 v38, 0
  v_mov_b32 v39, 0
  v_mov_b32 v40, 0
  v_mov_b32 v41, 0
  v_mov_b32 v42, 0
  v_mov_b32 v43, 0
  v_mov_b32 v44, 0
  v_mov_b32 v45, 0
  v_mov_b32 v46, 0
  v_mov_b32 v47, 0
  v_mov_b32 v48, 0
  v_mov_b32 v49, 0
  v_mov_b32 v50, 0
  v_mov_b32 v51, 0
  v_mov_b32 v52, 0
  v_mov_b32 v53, 0
  v_mov_b32 v54, 0
  v_mov_b32 v55, 0
  v_mov_b32 v56, 0
  v_mov_b32 v57, 0
  v_mov_b32 v58, 0
  v_mov_b32 v59, 0
  v_mov_b32 v60, 0
  v_mov_b32 v61, 0
  v_mov_b32 v62, 0
  v_mov_b32 v63, 0
  v_mov_b32 v64, 0
  v_mov_b32 v65, 0
  v_mov_b32 v66, 0
  v_mov_b32 v67, 0
  v_mov_b32 v68, 0
  v_mov_b32 v69, 0
  v_mov_b32 v70, 0
  v_mov_b32 v71, 0
  v_mov_b32 v72, 0
  v_mov_b32 v73, 0
  v_mov_b32 v74, 0
  v_mov_b32 v75, 0
  s_barrier
  s_barrier
  ds_read_b128 v[76:79], v2
  ds_read_b128 v[92:95], v4 offset:0
  ds_read_b128 v[96:99], v4 offset:2048
  ds_read_b128 v[100:103], v4 offset:4096
  ds_read_b128 v[104:107], v4 offset:6144
  ds_read_b128 v[80:83], v2 offset:2048
  ds_read_b128 v[84:87], v2 offset:4096
  ds_read_b128 v[88:91], v2 offset:6144
  s_waitcnt lgkmcnt(0)
  v_mfma_f32_16x16x32_bf16 v[12:15], v[76:79], v[92:95], v[12:15]
  ds_read_b128 v[108:111], v3
  v_mfma_f32_16x16x32_bf16 v[28:31], v[76:79], v[96:99], v[28:31]
  ds_read_b128 v[124:127], v5 offset:0
  v_mfma_f32_16x16x32_bf16 v[44:47], v[76:79], v[100:103], v[44:47]
  ds_read_b128 v[128:131], v5 offset:2048
  v_mfma_f32_16x16x32_bf16 v[60:63], v[76:79], v[104:107], v[60:63]
  ds_read_b128 v[132:135], v5 offset:4096
  v_mfma_f32_16x16x32_bf16 v[16:19], v[80:83], v[92:95], v[16:19]
  ds_read_b128 v[136:139], v5 offset:6144
  v_mfma_f32_16x16x32_bf16 v[32:35], v[80:83], v[96:99], v[32:35]
  ds_read_b128 v[112:115], v3 offset:2048
  v_mfma_f32_16x16x32_bf16 v[48:51], v[80:83], v[100:103], v[48:51]
  ds_read_b128 v[116:119], v3 offset:4096
  v_mfma_f32_16x16x32_bf16 v[64:67], v[80:83], v[104:107], v[64:67]
  ds_read_b128 v[120:123], v3 offset:6144
  v_mfma_f32_16x16x32_bf16 v[20:23], v[84:87], v[92:95], v[20:23]
  v_add_u32 v2, 40960, v2
  v_mfma_f32_16x16x32_bf16 v[36:39], v[84:87], v[96:99], v[36:39]
  v_add_u32 v3, 40960, v3
  v_mfma_f32_16x16x32_bf16 v[52:55], v[84:87], v[100:103], v[52:55]
  v_add_u32 v4, 40960, v4
  v_mfma_f32_16x16x32_bf16 v[68:71], v[84:87], v[104:107], v[68:71]
  v_add_u32 v5, 40960, v5
  v_mfma_f32_16x16x32_bf16 v[24:27], v[88:91], v[92:95], v[24:27]
  v_mfma_f32_16x16x32_bf16 v[40:43], v[88:91], v[96:99], v[40:43]
  v_mfma_f32_16x16x32_bf16 v[56:59], v[88:91], v[100:103], v[56:59]
  v_mfma_f32_16x16x32_bf16 v[72:75], v[88:91], v[104:107], v[72:75]
  s_waitcnt lgkmcnt(0)
  s_barrier
  v_mfma_f32_16x16x32_bf16 v[12:15], v[108:111], v[124:127], v[12:15]
  ds_read_b128 v[76:79], v2
  v_mfma_f32_16x16x32_bf16 v[28:31], v[108:111], v[128:131], v[28:31]
  ds_read_b128 v[92:95], v4 offset:0
  v_mfma_f32_16x16x32_bf16 v[44:47], v[108:111], v[132:135], v[44:47]
  ds_read_b128 v[96:99], v4 offset:2048
  v_mfma_f32_16x16x32_bf16 v[60:63], v[108:111], v[136:139], v[60:63]
  ds_read_b128 v[100:103], v4 offset:4096
  v_mfma_f32_16x16x32_bf16 v[16:19], v[112:115], v[124:127], v[16:19]
  ds_read_b128 v[104:107], v4 offset:6144
  v_mfma_f32_16x16x32_bf16 v[32:35], v[112:115], v[128:131], v[32:35]
  ds_read_b128 v[80:83], v2 offset:2048
  v_mfma_f32_16x16x32_bf16 v[48:51], v[112:115], v[132:135], v[48:51]
  ds_read_b128 v[84:87], v2 offset:4096
  v_mfma_f32_16x16x32_bf16 v[64:67], v[112:115], v[136:139], v[64:67]
  ds_read_b128 v[88:91], v2 offset:6144
  v_mfma_f32_16x16x32_bf16 v[20:23], v[116:119], v[124:127], v[20:23]
  v_mfma_f32_16x16x32_bf16 v[36:39], v[116:119], v[128:131], v[36:39]
  v_mfma_f32_16x16x32_bf16 v[52:55], v[116:119], v[132:135], v[52:55]
  v_mfma_f32_16x16x32_bf16 v[68:71], v[116:119], v[136:139], v[68:71]
  v_mfma_f32_16x16x32_bf16 v[24:27], v[120:123], v[124:127], v[24:27]
  v_mfma_f32_16x16x32_bf16 v[40:43], v[120:123], v[128:131], v[40:43]
  v_mfma_f32_16x16x32_bf16 v[56:59], v[120:123], v[132:135], v[56:59]
  v_mfma_f32_16x16x32_bf16 v[72:75], v[120:123], v[136:139], v[72:75]
  s_waitcnt lgkmcnt(0)
  v_mfma_f32_16x16x32_bf16 v[12:15], v[76:79], v[92:95], v[12:15]
  ds_read_b128 v[108:111], v3
  v_mfma_f32_16x16x32_bf16 v[28:31], v[76:79], v[96:99], v[28:31]
  ds_read_b128 v[124:127], v5 offset:0
  v_mfma_f32_16x16x32_bf16 v[44:47], v[76:79], v[100:103], v[44:47]
  ds_read_b128 v[128:131], v5 offset:2048
  v_mfma_f32_16x16x32_bf16 v[60:63], v[76:79], v[104:107], v[60:63]
  ds_read_b128 v[132:135], v5 offset:4096
  v_mfma_f32_16x16x32_bf16 v[16:19], v[80:83], v[92:95], v[16:19]
  ds_read_b128 v[136:139], v5 offset:6144
  v_mfma_f32_16x16x32_bf16 v[32:35], v[80:83], v[96:99], v[32:35]
  ds_read_b128 v[112:115], v3 offset:2048
  v_mfma_f32_16x16x32_bf16 v[48:51], v[80:83], v[100:103], v[48:51]
  ds_read_b128 v[116:119], v3 offset:4096
  v_mfma_f32_16x16x32_bf16 v[64:67], v[80:83], v[104:107], v[64:67]
  ds_read_b128 v[120:123], v3 offset:6144
  v_mfma_f32_16x16x32_bf16 v[20:23], v[84:87], v[92:95], v[20:23]
  v_add_u32 v2, 40960, v2
  v_mfma_f32_16x16x32_bf16 v[36:39], v[84:87], v[96:99], v[36:39]
  v_add_u32 v3, 40960, v3
  v_mfma_f32_16x16x32_bf16 v[52:55], v[84:87], v[100:103], v[52:55]
  v_add_u32 v4, 40960, v4
  v_mfma_f32_16x16x32_bf16 v[68:71], v[84:87], v[104:107], v[68:71]
  v_add_u32 v5, 40960, v5
  v_mfma_f32_16x16x32_bf16 v[24:27], v[88:91], v[92:95], v[24:27]
  v_mfma_f32_16x16x32_bf16 v[40:43], v[88:91], v[96:99], v[40:43]
  v_mfma_f32_16x16x32_bf16 v[56:59], v[88:91], v[100:103], v[56:59]
  v_mfma_f32_16x16x32_bf16 v[72:75], v[88:91], v[104:107], v[72:75]
  s_waitcnt lgkmcnt(0)
  s_barrier
  v_mfma_f32_16x16x32_bf16 v[12:15], v[108:111], v[124:127], v[12:15]
  ds_read_b128 v[76:79], v2
  v_mfma_f32_16x16x32_bf16 v[28:31], v[108:111], v[128:131], v[28:31]
  ds_read_b128 v[92:95], v4 offset:0
  v_mfma_f32_16x16x32_bf16 v[44:47], v[108:111], v[132:135], v[44:47]
  ds_read_b128 v[96:99], v4 offset:2048
  v_mfma_f32_16x16x32_bf16 v[60:63], v[108:111], v[136:139], v[60:63]
  ds_read_b128 v[100:103], v4 offset:4096
  v_mfma_f32_16x16x32_bf16 v[16:19], v[112:115], v[124:127], v[16:19]
  ds_read_b128 v[104:107], v4 offset:6144
  v_mfma_f32_16x16x32_bf16 v[32:35], v[112:115], v[128:131], v[32:35]
  ds_read_b128 v[80:83], v2 offset:2048
  v_mfma_f32_16x16x32_bf16 v[48:51], v[112:115], v[132:135], v[48:51]
  ds_read_b128 v[84:87], v2 offset:4096
  v_mfma_f32_16x16x32_bf16 v[64:67], v[112:115], v[136:139], v[64:67]
  ds_read_b128 v[88:91], v2 offset:6144
  v_mfma_f32_16x16x32_bf16 v[20:23], v[116:119], v[124:127], v[20:23]
  v_mfma_f32_16x16x32_bf16 v[36:39], v[116:119], v[128:131], v[36:39]
  v_mfma_f32_16x16x32_bf16 v[52:55], v[116:119], v[132:135], v[52:55]
  v_mfma_f32_16x16x32_bf16 v[68:71], v[116:119], v[136:139], v[68:71]
  v_mfma_f32_16x16x32_bf16 v[24:27], v[120:123], v[124:127], v[24:27]
  v_mfma_f32_16x16x32_bf16 v[40:43], v[120:123], v[128:131], v[40:43]
  v_mfma_f32_16x16x32_bf16 v[56:59], v[120:123], v[132:135], v[56:59]
  v_mfma_f32_16x16x32_bf16 v[72:75], v[120:123], v[136:139], v[72:75]
  s_waitcnt lgkmcnt(0)
  v_mfma_f32_16x16x32_bf16 v[12:15], v[76:79], v[92:95], v[12:15]
  ds_read_b128 v[108:111], v3
  v_mfma_f32_16x16x32_bf16 v[28:31], v[76:79], v[96:99], v[28:31]
  ds_read_b128 v[124:127], v5 offset:0
  v_mfma_f32_16x16x32_bf16 v[44:47], v[76:79], v[100:103], v[44:47]
  ds_read_b128 v[128:131], v5 offset:2048
  v_mfma_f32_16x16x32_bf16 v[60:63], v[76:79], v[104:107], v[60:63]
  ds_read_b128 v[132:135], v5 offset:4096
  v_mfma_f32_16x16x32_bf16 v[16:19], v[80:83], v[92:95], v[16:19]
  ds_read_b128 v[136:139], v5 offset:6144
  v_mfma_f32_16x16x32_bf16 v[32:35], v[80:83], v[96:99], v[32:35]
  ds_read_b128 v[112:115], v3 offset:2048
  v_mfma_f32_16x16x32_bf16 v[48:51], v[80:83], v[100:103], v[48:51]
  ds_read_b128 v[116:119], v3 offset:4096
  v_mfma_f32_16x16x32_bf16 v[64:67], v[80:83], v[104:107], v[64:67]
  ds_read_b128 v[120:123], v3 offset:6144
  v_mfma_f32_16x16x32_bf16 v[20:23], v[84:87], v[92:95], v[20:23]
  v_subrev_u32 v2, 81920, v2
  v_mfma_f32_16x16x32_bf16 v[36:39], v[84:87], v[96:99], v[36:39]
  v_subrev_u32 v3, 81920, v3
  v_mfma_f32_16x16x32_bf16 v[52:55], v[84:87], v[100:103], v[52:55]
  v_subrev_u32 v4, 81920, v4
  v_mfma_f32_16x16x32_bf16 v[68:71], v[84:87], v[104:107], v[68:71]
  v_subrev_u32 v5, 81920, v5
  v_mfma_f32_16x16x32_bf16 v[24:27], v[88:91], v[92:95], v[24:27]
  v_mfma_f32_16x16x32_bf16 v[40:43], v[88:91], v[96:99], v[40:43]
  v_mfma_f32_16x16x32_bf16 v[56:59], v[88:91], v[100:103], v[56:59]
  v_mfma_f32_16x16x32_bf16 v[72:75], v[88:91], v[104:107], v[72:75]
  s_waitcnt lgkmcnt(0)
  s_barrier
  v_mfma_f32_16x16x32_bf16 v[12:15], v[108:111], v[124:127], v[12:15]
  ds_read_b128 v[76:79], v2
  v_mfma_f32_16x16x32_bf16 v[28:31], v[108:111], v[128:131], v[28:31]
  ds_read_b128 v[92:95], v4 offset:0
  v_mfma_f32_16x16x32_bf16 v[44:47], v[108:111], v[132:135], v[44:47]
  ds_read_b128 v[96:99], v4 offset:2048
  v_mfma_f32_16x16x32_bf16 v[60:63], v[108:111], v[136:139], v[60:63]
  ds_read_b128 v[100:103], v4 offset:4096
  v_mfma_f32_16x16x32_bf16 v[16:19], v[112:115], v[124:127], v[16:19]
  ds_read_b128 v[104:107], v4 offset:6144
  v_mfma_f32_16x16x32_bf16 v[32:35], v[112:115], v[128:131], v[32:35]
  ds_read_b128 v[80:83], v2 offset:2048
  v_mfma_f32_16x16x32_bf16 v[48:51], v[112:115], v[132:135], v[48:51]
  ds_read_b128 v[84:87], v2 offset:4096
  v_mfma_f32_16x16x32_bf16 v[64:67], v[112:115], v[136:139], v[64:67]
  ds_read_b128 v[88:91], v2 offset:6144
  v_mfma_f32_16x16x32_bf16 v[20:23], v[116:119], v[124:127], v[20:23]
  v_mfma_f32_16x16x32_bf16 v[36:39], v[116:119], v[128:131], v[36:39]
  v_mfma_f32_16x16x32_bf16 v[52:55], v[116:119], v[132:135], v[52:55]
  v_mfma_f32_16x16x32_bf16 v[68:71], v[116:119], v[136:139], v[68:71]
  v_mfma_f32_16x16x32_bf16 v[24:27], v[120:123], v[124:127], v[24:27]
  v_mfma_f32_16x16x32_bf16 v[40:43], v[120:123], v[128:131], v[40:43]
  v_mfma_f32_16x16x32_bf16 v[56:59], v[120:123], v[132:135], v[56:59]
  v_mfma_f32_16x16x32_bf16 v[72:75], v[120:123], v[136:139], v[72:75]
  s_waitcnt lgkmcnt(0)
  v_mfma_f32_16x16x32_bf16 v[12:15], v[76:79], v[92:95], v[12:15]
  ds_read_b128 v[108:111], v3
  v_mfma_f32_16x16x32_bf16 v[28:31], v[76:79], v[96:99], v[28:31]
  ds_read_b128 v[124:127], v5 offset:0
  v_mfma_f32_16x16x32_bf16 v[44:47], v[76:79], v[100:103], v[44:47]
  ds_read_b128 v[128:131], v5 offset:2048
  v_mfma_f32_16x16x32_bf16 v[60:63], v[76:79], v[104:107], v[60:63]
  ds_read_b128 v[132:135], v5 offset:4096
  v_mfma_f32_16x16x32_bf16 v[16:19], v[80:83], v[92:95], v[16:19]
  ds_read_b128 v[136:139], v5 offset:6144
  v_mfma_f32_16x16x32_bf16 v[32:35], v[80:83], v[96:99], v[32:35]
  ds_read_b128 v[112:115], v3 offset:2048
  v_mfma_f32_16x16x32_bf16 v[48:51], v[80:83], v[100:103], v[48:51]
  ds_read_b128 v[116:119], v3 offset:4096
  v_mfma_f32_16x16x32_bf16 v[64:67], v[80:83], v[104:107], v[64:67]
  ds_read_b128 v[120:123], v3 offset:6144
  v_mfma_f32_16x16x32_bf16 v[20:23], v[84:87], v[92:95], v[20:23]
  v_add_u32 v2, 40960, v2
  v_mfma_f32_16x16x32_bf16 v[36:39], v[84:87], v[96:99], v[36:39]
  v_add_u32 v3, 40960, v3
  v_mfma_f32_16x16x32_bf16 v[52:55], v[84:87], v[100:103], v[52:55]
  v_add_u32 v4, 40960, v4
  v_mfma_f32_16x16x32_bf16 v[68:71], v[84:87], v[104:107], v[68:71]
  v_add_u32 v5, 40960, v5
  v_mfma_f32_16x16x32_bf16 v[24:27], v[88:91], v[92:95], v[24:27]
  v_mfma_f32_16x16x32_bf16 v[40:43], v[88:91], v[96:99], v[40:43]
  v_mfma_f32_16x16x32_bf16 v[56:59], v[88:91], v[100:103], v[56:59]
  v_mfma_f32_16x16x32_bf16 v[72:75], v[88:91], v[104:107], v[72:75]
  s_waitcnt lgkmcnt(0)
  s_barrier
  v_mfma_f32_16x16x32_bf16 v[12:15], v[108:111], v[124:127], v[12:15]
  ds_read_b128 v[76:79], v2
  v_mfma_f32_16x16x32_bf16 v[28:31], v[108:111], v[128:131], v[28:31]
  ds_read_b128 v[92:95], v4 offset:0
  v_mfma_f32_16x16x32_bf16 v[44:47], v[108:111], v[132:135], v[44:47]
  ds_read_b128 v[96:99], v4 offset:2048
  v_mfma_f32_16x16x32_bf16 v[60:63], v[108:111], v[136:139], v[60:63]
  ds_read_b128 v[100:103], v4 offset:4096
  v_mfma_f32_16x16x32_bf16 v[16:19], v[112:115], v[124:127], v[16:19]
  ds_read_b128 v[104:107], v4 offset:6144
  v_mfma_f32_16x16x32_bf16 v[32:35], v[112:115], v[128:131], v[32:35]
  ds_read_b128 v[80:83], v2 offset:2048
  v_mfma_f32_16x16x32_bf16 v[48:51], v[112:115], v[132:135], v[48:51]
  ds_read_b128 v[84:87], v2 offset:4096
  v_mfma_f32_16x16x32_bf16 v[64:67], v[112:115], v[136:139], v[64:67]
  ds_read_b128 v[88:91], v2 offset:6144
  v_mfma_f32_16x16x32_bf16 v[20:23], v[116:119], v[124:127], v[20:23]
  v_mfma_f32_16x16x32_bf16 v[36:39], v[116:119], v[128:131], v[36:39]
  v_mfma_f32_16x16x32_bf16 v[52:55], v[116:119], v[132:135], v[52:55]
  v_mfma_f32_16x16x32_bf16 v[68:71], v[116:119], v[136:139], v[68:71]
  v_mfma_f32_16x16x32_bf16 v[24:27], v[120:123], v[124:127], v[24:27]
  v_mfma_f32_16x16x32_bf16 v[40:43], v[120:123], v[128:131], v[40:43]
  v_mfma_f32_16x16x32_bf16 v[56:59], v[120:123], v[132:135], v[56:59]
  v_mfma_f32_16x16x32_bf16 v[72:75], v[120:123], v[136:139], v[72:75]
  s_waitcnt lgkmcnt(0)
  v_mfma_f32_16x16x32_bf16 v[12:15], v[76:79], v[92:95], v[12:15]
  ds_read_b128 v[108:111], v3
  v_mfma_f32_16x16x32_bf16 v[28:31], v[76:79], v[96:99], v[28:31]
  ds_read_b128 v[124:127], v5 offset:0
  v_mfma_f32_16x16x32_bf16 v[44:47], v[76:79], v[100:103], v[44:47]
  ds_read_b128 v[128:131], v5 offset:2048
  v_mfma_f32_16x16x32_bf16 v[60:63], v[76:79], v[104:107], v[60:63]
  ds_read_b128 v[132:135], v5 offset:4096
  v_mfma_f32_16x16x32_bf16 v[16:19], v[80:83], v[92:95], v[16:19]
  ds_read_b128 v[136:139], v5 offset:6144
  v_mfma_f32_16x16x32_bf16 v[32:35], v[80:83], v[96:99], v[32:35]
  ds_read_b128 v[112:115], v3 offset:2048
  v_mfma_f32_16x16x32_bf16 v[48:51], v[80:83], v[100:103], v[48:51]
  ds_read_b128 v[116:119], v3 offset:4096
  v_mfma_f32_16x16x32_bf16 v[64:67], v[80:83], v[104:107], v[64:67]
  ds_read_b128 v[120:123], v3 offset:6144
  v_mfma_f32_16x16x32_bf16 v[20:23], v[84:87], v[92:95], v[20:23]
  v_add_u32 v2, 40960, v2
  v_mfma_f32_16x16x32_bf16 v[36:39], v[84:87], v[96:99], v[36:39]
  v_add_u32 v3, 40960, v3
  v_mfma_f32_16x16x32_bf16 v[52:55], v[84:87], v[100:103], v[52:55]
  v_add_u32 v4, 40960, v4
  v_mfma_f32_16x16x32_bf16 v[68:71], v[84:87], v[104:107], v[68:71]
  v_add_u32 v5, 40960, v5
  v_mfma_f32_16x16x32_bf16 v[24:27], v[88:91], v[92:95], v[24:27]
  v_mfma_f32_16x16x32_bf16 v[40:43], v[88:91], v[96:99], v[40:43]
  v_mfma_f32_16x16x32_bf16 v[56:59], v[88:91], v[100:103], v[56:59]
  v_mfma_f32_16x16x32_bf16 v[72:75], v[88:91], v[104:107], v[72:75]
  s_waitcnt lgkmcnt(0)
  s_barrier
  v_mfma_f32_16x16x32_bf16 v[12:15], v[108:111], v[124:127], v[12:15]
  ds_read_b128 v[76:79], v2
  v_mfma_f32_16x16x32_bf16 v[28:31], v[108:111], v[128:131], v[28:31]
  ds_read_b128 v[92:95], v4 offset:0
  v_mfma_f32_16x16x32_bf16 v[44:47], v[108:111], v[132:135], v[44:47]
  ds_read_b128 v[96:99], v4 offset:2048
  v_mfma_f32_16x16x32_bf16 v[60:63], v[108:111], v[136:139], v[60:63]
  ds_read_b128 v[100:103], v4 offset:4096
  v_mfma_f32_16x16x32_bf16 v[16:19], v[112:115], v[124:127], v[16:19]
  ds_read_b128 v[104:107], v4 offset:6144
  v_mfma_f32_16x16x32_bf16 v[32:35], v[112:115], v[128:131], v[32:35]
  ds_read_b128 v[80:83], v2 offset:2048
  v_mfma_f32_16x16x32_bf16 v[48:51], v[112:115], v[132:135], v[48:51]
  ds_read_b128 v[84:87], v2 offset:4096
  v_mfma_f32_16x16x32_bf16 v[64:67], v[112:115], v[136:139], v[64:67]
  ds_read_b128 v[88:91], v2 offset:6144
  v_mfma_f32_16x16x32_bf16 v[20:23], v[116:119], v[124:127], v[20:23]
  v_mfma_f32_16x16x32_bf16 v[36:39], v[116:119], v[128:131], v[36:39]
  v_mfma_f32_16x16x32_bf16 v[52:55], v[116:119], v[132:135], v[52:55]
  v_mfma_f32_16x16x32_bf16 v[68:71], v[116:119], v[136:139], v[68:71]
  v_mfma_f32_16x16x32_bf16 v[24:27], v[120:123], v[124:127], v[24:27]
  v_mfma_f32_16x16x32_bf16 v[40:43], v[120:123], v[128:131], v[40:43]
  v_mfma_f32_16x16x32_bf16 v[56:59], v[120:123], v[132:135], v[56:59]
  v_mfma_f32_16x16x32_bf16 v[72:75], v[120:123], v[136:139], v[72:75]
  s_waitcnt lgkmcnt(0)
  v_mfma_f32_16x16x32_bf16 v[12:15], v[76:79], v[92:95], v[12:15]
  ds_read_b128 v[108:111], v3
  v_mfma_f32_16x16x32_bf16 v[28:31], v[76:79], v[96:99], v[28:31]
  ds_read_b128 v[124:127], v5 offset:0
  v_mfma_f32_16x16x32_bf16 v[44:47], v[76:79], v[100:103], v[44:47]
  ds_read_b128 v[128:131], v5 offset:2048
  v_mfma_f32_16x16x32_bf16 v[60:63], v[76:79], v[104:107], v[60:63]
  ds_read_b128 v[132:135], v5 offset:4096
  v_mfma_f32_16x16x32_bf16 v[16:19], v[80:83], v[92:95], v[16:19]
  ds_read_b128 v[136:139], v5 offset:6144
  v_mfma_f32_16x16x32_bf16 v[32:35], v[80:83], v[96:99], v[32:35]
  ds_read_b128 v[112:115], v3 offset:2048
  v_mfma_f32_16x16x32_bf16 v[48:51], v[80:83], v[100:103], v[48:51]
  ds_read_b128 v[116:119], v3 offset:4096
  v_mfma_f32_16x16x32_bf16 v[64:67], v[80:83], v[104:107], v[64:67]
  ds_read_b128 v[120:123], v3 offset:6144
  v_mfma_f32_16x16x32_bf16 v[20:23], v[84:87], v[92:95], v[20:23]
  v_subrev_u32 v2, 81920, v2
  v_mfma_f32_16x16x32_bf16 v[36:39], v[84:87], v[96:99], v[36:39]
  v_subrev_u32 v3, 81920, v3
  v_mfma_f32_16x16x32_bf16 v[52:55], v[84:87], v[100:103], v[52:55]
  v_subrev_u32 v4, 81920, v4
  v_mfma_f32_16x16x32_bf16 v[68:71], v[84:87], v[104:107], v[68:71]
  v_subrev_u32 v5, 81920, v5
  v_mfma_f32_16x16x32_bf16 v[24:27], v[88:91], v[92:95], v[24:27]
  v_mfma_f32_16x16x32_bf16 v[40:43], v[88:91], v[96:99], v[40:43]
  v_mfma_f32_16x16x32_bf16 v[56:59], v[88:91], v[100:103], v[56:59]
  v_mfma_f32_16x16x32_bf16 v[72:75], v[88:91], v[104:107], v[72:75]
  s_waitcnt lgkmcnt(0)
  s_barrier
  v_mfma_f32_16x16x32_bf16 v[12:15], v[108:111], v[124:127], v[12:15]
  ds_read_b128 v[76:79], v2
  v_mfma_f32_16x16x32_bf16 v[28:31], v[108:111], v[128:131], v[28:31]
  ds_read_b128 v[92:95], v4 offset:0
  v_mfma_f32_16x16x32_bf16 v[44:47], v[108:111], v[132:135], v[44:47]
  ds_read_b128 v[96:99], v4 offset:2048
  v_mfma_f32_16x16x32_bf16 v[60:63], v[108:111], v[136:139], v[60:63]
  ds_read_b128 v[100:103], v4 offset:4096
  v_mfma_f32_16x16x32_bf16 v[16:19], v[112:115], v[124:127], v[16:19]
  ds_read_b128 v[104:107], v4 offset:6144
  v_mfma_f32_16x16x32_bf16 v[32:35], v[112:115], v[128:131], v[32:35]
  ds_read_b128 v[80:83], v2 offset:2048
  v_mfma_f32_16x16x32_bf16 v[48:51], v[112:115], v[132:135], v[48:51]
  ds_read_b128 v[84:87], v2 offset:4096
  v_mfma_f32_16x16x32_bf16 v[64:67], v[112:115], v[136:139], v[64:67]
  ds_read_b128 v[88:91], v2 offset:6144
  v_mfma_f32_16x16x32_bf16 v[20:23], v[116:119], v[124:127], v[20:23]
  v_mfma_f32_16x16x32_bf16 v[36:39], v[116:119], v[128:131], v[36:39]
  v_mfma_f32_16x16x32_bf16 v[52:55], v[116:119], v[132:135], v[52:55]
  v_mfma_f32_16x16x32_bf16 v[68:71], v[116:119], v[136:139], v[68:71]
  v_mfma_f32_16x16x32_bf16 v[24:27], v[120:123], v[124:127], v[24:27]
  v_mfma_f32_16x16x32_bf16 v[40:43], v[120:123], v[128:131], v[40:43]
  v_mfma_f32_16x16x32_bf16 v[56:59], v[120:123], v[132:135], v[56:59]
  v_mfma_f32_16x16x32_bf16 v[72:75], v[120:123], v[136:139], v[72:75]
  s_waitcnt lgkmcnt(0)
  v_mfma_f32_16x16x32_bf16 v[12:15], v[76:79], v[92:95], v[12:15]
  ds_read_b128 v[108:111], v3
  v_mfma_f32_16x16x32_bf16 v[28:31], v[76:79], v[96:99], v[28:31]
  ds_read_b128 v[124:127], v5 offset:0
  v_mfma_f32_16x16x32_bf16 v[44:47], v[76:79], v[100:103], v[44:47]
  ds_read_b128 v[128:131], v5 offset:2048
  v_mfma_f32_16x16x32_bf16 v[60:63], v[76:79], v[104:107], v[60:63]
  ds_read_b128 v[132:135], v5 offset:4096
  v_mfma_f32_16x16x32_bf16 v[16:19], v[80:83], v[92:95], v[16:19]
  ds_read_b128 v[136:139], v5 offset:6144
  v_mfma_f32_16x16x32_bf16 v[32:35], v[80:83], v[96:99], v[32:35]
  ds_read_b128 v[112:115], v3 offset:2048
  v_mfma_f32_16x16x32_bf16 v[48:51], v[80:83], v[100:103], v[48:51]
  ds_read_b128 v[116:119], v3 offset:4096
  v_mfma_f32_16x16x32_bf16 v[64:67], v[80:83], v[104:107], v[64:67]
  ds_read_b128 v[120:123], v3 offset:6144
  v_mfma_f32_16x16x32_bf16 v[20:23], v[84:87], v[92:95], v[20:23]
  v_add_u32 v2, 40960, v2
  v_mfma_f32_16x16x32_bf16 v[36:39], v[84:87], v[96:99], v[36:39]
  v_add_u32 v3, 40960, v3
  v_mfma_f32_16x16x32_bf16 v[52:55], v[84:87], v[100:103], v[52:55]
  v_add_u32 v4, 40960, v4
  v_mfma_f32_16x16x32_bf16 v[68:71], v[84:87], v[104:107], v[68:71]
  v_add_u32 v5, 40960, v5
  v_mfma_f32_16x16x32_bf16 v[24:27], v[88:91], v[92:95], v[24:27]
  v_mfma_f32_16x16x32_bf16 v[40:43], v[88:91], v[96:99], v[40:43]
  v_mfma_f32_16x16x32_bf16 v[56:59], v[88:91], v[100:103], v[56:59]
  v_mfma_f32_16x16x32_bf16 v[72:75], v[88:91], v[104:107], v[72:75]
  s_waitcnt lgkmcnt(0)
  s_barrier
  v_mfma_f32_16x16x32_bf16 v[12:15], v[108:111], v[124:127], v[12:15]
  ds_read_b128 v[76:79], v2
  v_mfma_f32_16x16x32_bf16 v[28:31], v[108:111], v[128:131], v[28:31]
  ds_read_b128 v[92:95], v4 offset:0
  v_mfma_f32_16x16x32_bf16 v[44:47], v[108:111], v[132:135], v[44:47]
  ds_read_b128 v[96:99], v4 offset:2048
  v_mfma_f32_16x16x32_bf16 v[60:63], v[108:111], v[136:139], v[60:63]
  ds_read_b128 v[100:103], v4 offset:4096
  v_mfma_f32_16x16x32_bf16 v[16:19], v[112:115], v[124:127], v[16:19]
  ds_read_b128 v[104:107], v4 offset:6144
  v_mfma_f32_16x16x32_bf16 v[32:35], v[112:115], v[128:131], v[32:35]
  ds_read_b128 v[80:83], v2 offset:2048
  v_mfma_f32_16x16x32_bf16 v[48:51], v[112:115], v[132:135], v[48:51]
  ds_read_b128 v[84:87], v2 offset:4096
  v_mfma_f32_16x16x32_bf16 v[64:67], v[112:115], v[136:139], v[64:67]
  ds_read_b128 v[88:91], v2 offset:6144
  v_mfma_f32_16x16x32_bf16 v[20:23], v[116:119], v[124:127], v[20:23]
  v_mfma_f32_16x16x32_bf16 v[36:39], v[116:119], v[128:131], v[36:39]
  v_mfma_f32_16x16x32_bf16 v[52:55], v[116:119], v[132:135], v[52:55]
  v_mfma_f32_16x16x32_bf16 v[68:71], v[116:119], v[136:139], v[68:71]
  v_mfma_f32_16x16x32_bf16 v[24:27], v[120:123], v[124:127], v[24:27]
  v_mfma_f32_16x16x32_bf16 v[40:43], v[120:123], v[128:131], v[40:43]
  v_mfma_f32_16x16x32_bf16 v[56:59], v[120:123], v[132:135], v[56:59]
  v_mfma_f32_16x16x32_bf16 v[72:75], v[120:123], v[136:139], v[72:75]
  s_waitcnt lgkmcnt(0)
  v_mfma_f32_16x16x32_bf16 v[12:15], v[76:79], v[92:95], v[12:15]
  ds_read_b128 v[108:111], v3
  v_mfma_f32_16x16x32_bf16 v[28:31], v[76:79], v[96:99], v[28:31]
  ds_read_b128 v[124:127], v5 offset:0
  v_mfma_f32_16x16x32_bf16 v[44:47], v[76:79], v[100:103], v[44:47]
  ds_read_b128 v[128:131], v5 offset:2048
  v_mfma_f32_16x16x32_bf16 v[60:63], v[76:79], v[104:107], v[60:63]
  ds_read_b128 v[132:135], v5 offset:4096
  v_mfma_f32_16x16x32_bf16 v[16:19], v[80:83], v[92:95], v[16:19]
  ds_read_b128 v[136:139], v5 offset:6144
  v_mfma_f32_16x16x32_bf16 v[32:35], v[80:83], v[96:99], v[32:35]
  ds_read_b128 v[112:115], v3 offset:2048
  v_mfma_f32_16x16x32_bf16 v[48:51], v[80:83], v[100:103], v[48:51]
  ds_read_b128 v[116:119], v3 offset:4096
  v_mfma_f32_16x16x32_bf16 v[64:67], v[80:83], v[104:107], v[64:67]
  ds_read_b128 v[120:123], v3 offset:6144
  v_mfma_f32_16x16x32_bf16 v[20:23], v[84:87], v[92:95], v[20:23]
  v_add_u32 v2, 40960, v2
  v_mfma_f32_16x16x32_bf16 v[36:39], v[84:87], v[96:99], v[36:39]
  v_add_u32 v3, 40960, v3
  v_mfma_f32_16x16x32_bf16 v[52:55], v[84:87], v[100:103], v[52:55]
  v_add_u32 v4, 40960, v4
  v_mfma_f32_16x16x32_bf16 v[68:71], v[84:87], v[104:107], v[68:71]
  v_add_u32 v5, 40960, v5
  v_mfma_f32_16x16x32_bf16 v[24:27], v[88:91], v[92:95], v[24:27]
  v_mfma_f32_16x16x32_bf16 v[40:43], v[88:91], v[96:99], v[40:43]
  v_mfma_f32_16x16x32_bf16 v[56:59], v[88:91], v[100:103], v[56:59]
  v_mfma_f32_16x16x32_bf16 v[72:75], v[88:91], v[104:107], v[72:75]
  s_waitcnt lgkmcnt(0)
  s_barrier
  v_mfma_f32_16x16x32_bf16 v[12:15], v[108:111], v[124:127], v[12:15]
  ds_read_b128 v[76:79], v2
  v_mfma_f32_16x16x32_bf16 v[28:31], v[108:111], v[128:131], v[28:31]
  ds_read_b128 v[92:95], v4 offset:0
  v_mfma_f32_16x16x32_bf16 v[44:47], v[108:111], v[132:135], v[44:47]
  ds_read_b128 v[96:99], v4 offset:2048
  v_mfma_f32_16x16x32_bf16 v[60:63], v[108:111], v[136:139], v[60:63]
  ds_read_b128 v[100:103], v4 offset:4096
  v_mfma_f32_16x16x32_bf16 v[16:19], v[112:115], v[124:127], v[16:19]
  ds_read_b128 v[104:107], v4 offset:6144
  v_mfma_f32_16x16x32_bf16 v[32:35], v[112:115], v[128:131], v[32:35]
  ds_read_b128 v[80:83], v2 offset:2048
  v_mfma_f32_16x16x32_bf16 v[48:51], v[112:115], v[132:135], v[48:51]
  ds_read_b128 v[84:87], v2 offset:4096
  v_mfma_f32_16x16x32_bf16 v[64:67], v[112:115], v[136:139], v[64:67]
  ds_read_b128 v[88:91], v2 offset:6144
  v_mfma_f32_16x16x32_bf16 v[20:23], v[116:119], v[124:127], v[20:23]
  v_mfma_f32_16x16x32_bf16 v[36:39], v[116:119], v[128:131], v[36:39]
  v_mfma_f32_16x16x32_bf16 v[52:55], v[116:119], v[132:135], v[52:55]
  v_mfma_f32_16x16x32_bf16 v[68:71], v[116:119], v[136:139], v[68:71]
  v_mfma_f32_16x16x32_bf16 v[24:27], v[120:123], v[124:127], v[24:27]
  v_mfma_f32_16x16x32_bf16 v[40:43], v[120:123], v[128:131], v[40:43]
  v_mfma_f32_16x16x32_bf16 v[56:59], v[120:123], v[132:135], v[56:59]
  v_mfma_f32_16x16x32_bf16 v[72:75], v[120:123], v[136:139], v[72:75]
  s_waitcnt lgkmcnt(0)
  v_mfma_f32_16x16x32_bf16 v[12:15], v[76:79], v[92:95], v[12:15]
  ds_read_b128 v[108:111], v3
  v_mfma_f32_16x16x32_bf16 v[28:31], v[76:79], v[96:99], v[28:31]
  ds_read_b128 v[124:127], v5 offset:0
  v_mfma_f32_16x16x32_bf16 v[44:47], v[76:79], v[100:103], v[44:47]
  ds_read_b128 v[128:131], v5 offset:2048
  v_mfma_f32_16x16x32_bf16 v[60:63], v[76:79], v[104:107], v[60:63]
  ds_read_b128 v[132:135], v5 offset:4096
  v_mfma_f32_16x16x32_bf16 v[16:19], v[80:83], v[92:95], v[16:19]
  ds_read_b128 v[136:139], v5 offset:6144
  v_mfma_f32_16x16x32_bf16 v[32:35], v[80:83], v[96:99], v[32:35]
  ds_read_b128 v[112:115], v3 offset:2048
  v_mfma_f32_16x16x32_bf16 v[48:51], v[80:83], v[100:103], v[48:51]
  ds_read_b128 v[116:119], v3 offset:4096
  v_mfma_f32_16x16x32_bf16 v[64:67], v[80:83], v[104:107], v[64:67]
  ds_read_b128 v[120:123], v3 offset:6144
  v_mfma_f32_16x16x32_bf16 v[20:23], v[84:87], v[92:95], v[20:23]
  v_subrev_u32 v2, 81920, v2
  v_mfma_f32_16x16x32_bf16 v[36:39], v[84:87], v[96:99], v[36:39]
  v_subrev_u32 v3, 81920, v3
  v_mfma_f32_16x16x32_bf16 v[52:55], v[84:87], v[100:103], v[52:55]
  v_subrev_u32 v4, 81920, v4
  v_mfma_f32_16x16x32_bf16 v[68:71], v[84:87], v[104:107], v[68:71]
  v_subrev_u32 v5, 81920, v5
  v_mfma_f32_16x16x32_bf16 v[24:27], v[88:91], v[92:95], v[24:27]
  v_mfma_f32_16x16x32_bf16 v[40:43], v[88:91], v[96:99], v[40:43]
  v_mfma_f32_16x16x32_bf16 v[56:59], v[88:91], v[100:103], v[56:59]
  v_mfma_f32_16x16x32_bf16 v[72:75], v[88:91], v[104:107], v[72:75]
  s_waitcnt lgkmcnt(0)
  s_barrier
  v_mfma_f32_16x16x32_bf16 v[12:15], v[108:111], v[124:127], v[12:15]
  ds_read_b128 v[76:79], v2
  v_mfma_f32_16x16x32_bf16 v[28:31], v[108:111], v[128:131], v[28:31]
  ds_read_b128 v[92:95], v4 offset:0
  v_mfma_f32_16x16x32_bf16 v[44:47], v[108:111], v[132:135], v[44:47]
  ds_read_b128 v[96:99], v4 offset:2048
  v_mfma_f32_16x16x32_bf16 v[60:63], v[108:111], v[136:139], v[60:63]
  ds_read_b128 v[100:103], v4 offset:4096
  v_mfma_f32_16x16x32_bf16 v[16:19], v[112:115], v[124:127], v[16:19]
  ds_read_b128 v[104:107], v4 offset:6144
  v_mfma_f32_16x16x32_bf16 v[32:35], v[112:115], v[128:131], v[32:35]
  ds_read_b128 v[80:83], v2 offset:2048
  v_mfma_f32_16x16x32_bf16 v[48:51], v[112:115], v[132:135], v[48:51]
  ds_read_b128 v[84:87], v2 offset:4096
  v_mfma_f32_16x16x32_bf16 v[64:67], v[112:115], v[136:139], v[64:67]
  ds_read_b128 v[88:91], v2 offset:6144
  v_mfma_f32_16x16x32_bf16 v[20:23], v[116:119], v[124:127], v[20:23]
  v_mfma_f32_16x16x32_bf16 v[36:39], v[116:119], v[128:131], v[36:39]
  v_mfma_f32_16x16x32_bf16 v[52:55], v[116:119], v[132:135], v[52:55]
  v_mfma_f32_16x16x32_bf16 v[68:71], v[116:119], v[136:139], v[68:71]
  v_mfma_f32_16x16x32_bf16 v[24:27], v[120:123], v[124:127], v[24:27]
  v_mfma_f32_16x16x32_bf16 v[40:43], v[120:123], v[128:131], v[40:43]
  v_mfma_f32_16x16x32_bf16 v[56:59], v[120:123], v[132:135], v[56:59]
  v_mfma_f32_16x16x32_bf16 v[72:75], v[120:123], v[136:139], v[72:75]
  s_waitcnt lgkmcnt(0)
  v_mfma_f32_16x16x32_bf16 v[12:15], v[76:79], v[92:95], v[12:15]
  ds_read_b128 v[108:111], v3
  v_mfma_f32_16x16x32_bf16 v[28:31], v[76:79], v[96:99], v[28:31]
  ds_read_b128 v[124:127], v5 offset:0
  v_mfma_f32_16x16x32_bf16 v[44:47], v[76:79], v[100:103], v[44:47]
  ds_read_b128 v[128:131], v5 offset:2048
  v_mfma_f32_16x16x32_bf16 v[60:63], v[76:79], v[104:107], v[60:63]
  ds_read_b128 v[132:135], v5 offset:4096
  v_mfma_f32_16x16x32_bf16 v[16:19], v[80:83], v[92:95], v[16:19]
  ds_read_b128 v[136:139], v5 offset:6144
  v_mfma_f32_16x16x32_bf16 v[32:35], v[80:83], v[96:99], v[32:35]
  ds_read_b128 v[112:115], v3 offset:2048
  v_mfma_f32_16x16x32_bf16 v[48:51], v[80:83], v[100:103], v[48:51]
  ds_read_b128 v[116:119], v3 offset:4096
  v_mfma_f32_16x16x32_bf16 v[64:67], v[80:83], v[104:107], v[64:67]
  ds_read_b128 v[120:123], v3 offset:6144
  v_mfma_f32_16x16x32_bf16 v[20:23], v[84:87], v[92:95], v[20:23]
  v_mfma_f32_16x16x32_bf16 v[36:39], v[84:87], v[96:99], v[36:39]
  v_mfma_f32_16x16x32_bf16 v[52:55], v[84:87], v[100:103], v[52:55]
  v_mfma_f32_16x16x32_bf16 v[68:71], v[84:87], v[104:107], v[68:71]
  v_mfma_f32_16x16x32_bf16 v[24:27], v[88:91], v[92:95], v[24:27]
  v_mfma_f32_16x16x32_bf16 v[40:43], v[88:91], v[96:99], v[40:43]
  v_mfma_f32_16x16x32_bf16 v[56:59], v[88:91], v[100:103], v[56:59]
  v_mfma_f32_16x16x32_bf16 v[72:75], v[88:91], v[104:107], v[72:75]
  s_waitcnt lgkmcnt(0)
  s_barrier
  v_mfma_f32_16x16x32_bf16 v[12:15], v[108:111], v[124:127], v[12:15]
  v_mfma_f32_16x16x32_bf16 v[28:31], v[108:111], v[128:131], v[28:31]
  v_mfma_f32_16x16x32_bf16 v[44:47], v[108:111], v[132:135], v[44:47]
  v_mfma_f32_16x16x32_bf16 v[60:63], v[108:111], v[136:139], v[60:63]
  v_mfma_f32_16x16x32_bf16 v[16:19], v[112:115], v[124:127], v[16:19]
  v_mfma_f32_16x16x32_bf16 v[32:35], v[112:115], v[128:131], v[32:35]
  v_mfma_f32_16x16x32_bf16 v[48:51], v[112:115], v[132:135], v[48:51]
  v_mfma_f32_16x16x32_bf16 v[64:67], v[112:115], v[136:139], v[64:67]
  v_mfma_f32_16x16x32_bf16 v[20:23], v[116:119], v[124:127], v[20:23]
  v_mfma_f32_16x16x32_bf16 v[36:39], v[116:119], v[128:131], v[36:39]
  v_mfma_f32_16x16x32_bf16 v[52:55], v[116:119], v[132:135], v[52:55]
  v_mfma_f32_16x16x32_bf16 v[68:71], v[116:119], v[136:139], v[68:71]
  v_mfma_f32_16x16x32_bf16 v[24:27], v[120:123], v[124:127], v[24:27]
  v_mfma_f32_16x16x32_bf16 v[40:43], v[120:123], v[128:131], v[40:43]
  v_mfma_f32_16x16x32_bf16 v[56:59], v[120:123], v[132:135], v[56:59]
  v_mfma_f32_16x16x32_bf16 v[72:75], v[120:123], v[136:139], v[72:75]
  v_mov_b32 v9, 122880
K1_tp_0:
  ds_read_b32 v7, v9 offset:0
  s_waitcnt lgkmcnt(0)
  v_readfirstlane_b32 s60, v7
  s_cmp_eq_u32 s60, 0
  s_cbranch_scc1 K1_tp_0
  s_nop 7

  v_lshrrev_b32 v1, 4, v0
  s_lshl_b32 s60, s66, 2
  v_add_u32 v1, s60, v1
  v_lshlrev_b32 v11, 6, v1
  v_add_u32 v11, 123136, v11

  ds_read_b128 v[76:79], v11 offset:0
  ds_read_b128 v[92:95], v11 offset:512
  ds_read_b128 v[80:83], v11 offset:16
  ds_read_b128 v[96:99], v11 offset:528
  ds_read_b128 v[84:87], v11 offset:32
  ds_read_b128 v[100:103], v11 offset:544
  ds_read_b128 v[88:91], v11 offset:48
  ds_read_b128 v[104:107], v11 offset:560

  v_and_b32 v11, 15, v0
  s_lshl_b32 s60, s67, 4
  v_add_u32 v11, s60, v11
  v_lshlrev_b32 v9, 5, v11
  v_add_u32 v9, 125568, v9
  v_lshlrev_b32 v11, 3, v11
  v_add_u32 v11, 125184, v11
  v_lshlrev_b32 v8, 7, v1
  v_and_b32 v7, 15, v0
  v_lshl_add_u32 v8, v7, 3, v8
  s_mul_i32 s60, s67, 1024
  v_add_u32 v7, s60, v8
  v_add_u32 v7, 128640, v7
  s_mul_i32 s60, s67, 1920
  v_add_u32 v8, s60, v8
  v_add_u32 v8, 132736, v8

  ds_read_b128 v[108:111], v9 offset:0
  ds_read_b128 v[112:115], v9 offset:16
  ds_read_b64 v[116:117], v11 offset:0
  ds_read_b64 v[118:119], v7 offset:0
  ds_read_b128 v[134:137], v9 offset:512
  ds_read_b128 v[138:141], v9 offset:528
  ds_read_b64 v[142:143], v11 offset:128
  ds_read_b64 v[144:145], v7 offset:1024
  s_waitcnt lgkmcnt(0)
  v_pk_mul_f32 v[12:13], v[76:77], v[12:13]
  v_pk_mul_f32 v[28:29], v[76:77], v[28:29]
  v_pk_mul_f32 v[44:45], v[76:77], v[44:45]
  v_pk_mul_f32 v[60:61], v[76:77], v[60:61]
  v_pk_fma_f32 v[12:13], v[92:93], v[116:117], v[12:13] op_sel_hi:[1,0,1] neg_lo:[1,0,0] neg_hi:[1,0,0]
  v_pk_fma_f32 v[28:29], v[92:93], v[116:117], v[28:29] op_sel:[0,1,0] neg_lo:[1,0,0] neg_hi:[1,0,0]
  v_pk_fma_f32 v[44:45], v[92:93], v[142:143], v[44:45] op_sel_hi:[1,0,1] neg_lo:[1,0,0] neg_hi:[1,0,0]
  v_pk_fma_f32 v[60:61], v[92:93], v[142:143], v[60:61] op_sel:[0,1,0] neg_lo:[1,0,0] neg_hi:[1,0,0]
  v_pk_mul_f32 v[14:15], v[78:79], v[14:15]
  v_pk_mul_f32 v[30:31], v[78:79], v[30:31]
  v_pk_mul_f32 v[46:47], v[78:79], v[46:47]
  v_pk_mul_f32 v[62:63], v[78:79], v[62:63]
  v_pk_fma_f32 v[14:15], v[94:95], v[116:117], v[14:15] op_sel_hi:[1,0,1] neg_lo:[1,0,0] neg_hi:[1,0,0]
  v_pk_fma_f32 v[30:31], v[94:95], v[116:117], v[30:31] op_sel:[0,1,0] neg_lo:[1,0,0] neg_hi:[1,0,0]
  v_pk_fma_f32 v[46:47], v[94:95], v[142:143], v[46:47] op_sel_hi:[1,0,1] neg_lo:[1,0,0] neg_hi:[1,0,0]
  v_pk_fma_f32 v[62:63], v[94:95], v[142:143], v[62:63] op_sel:[0,1,0] neg_lo:[1,0,0] neg_hi:[1,0,0]
  v_pk_mul_f32 v[16:17], v[80:81], v[16:17]
  v_pk_mul_f32 v[32:33], v[80:81], v[32:33]
  v_pk_mul_f32 v[48:49], v[80:81], v[48:49]
  v_pk_mul_f32 v[64:65], v[80:81], v[64:65]
  v_pk_fma_f32 v[16:17], v[96:97], v[116:117], v[16:17] op_sel_hi:[1,0,1] neg_lo:[1,0,0] neg_hi:[1,0,0]
  v_pk_fma_f32 v[32:33], v[96:97], v[116:117], v[32:33] op_sel:[0,1,0] neg_lo:[1,0,0] neg_hi:[1,0,0]
  v_pk_fma_f32 v[48:49], v[96:97], v[142:143], v[48:49] op_sel_hi:[1,0,1] neg_lo:[1,0,0] neg_hi:[1,0,0]
  v_pk_fma_f32 v[64:65], v[96:97], v[142:143], v[64:65] op_sel:[0,1,0] neg_lo:[1,0,0] neg_hi:[1,0,0]
  v_pk_mul_f32 v[18:19], v[82:83], v[18:19]
  v_pk_mul_f32 v[34:35], v[82:83], v[34:35]
  v_pk_mul_f32 v[50:51], v[82:83], v[50:51]
  v_pk_mul_f32 v[66:67], v[82:83], v[66:67]
  v_pk_fma_f32 v[18:19], v[98:99], v[116:117], v[18:19] op_sel_hi:[1,0,1] neg_lo:[1,0,0] neg_hi:[1,0,0]
  v_pk_fma_f32 v[34:35], v[98:99], v[116:117], v[34:35] op_sel:[0,1,0] neg_lo:[1,0,0] neg_hi:[1,0,0]
  v_pk_fma_f32 v[50:51], v[98:99], v[142:143], v[50:51] op_sel_hi:[1,0,1] neg_lo:[1,0,0] neg_hi:[1,0,0]
  v_pk_fma_f32 v[66:67], v[98:99], v[142:143], v[66:67] op_sel:[0,1,0] neg_lo:[1,0,0] neg_hi:[1,0,0]
  v_pk_mul_f32 v[20:21], v[84:85], v[20:21]
  v_pk_mul_f32 v[36:37], v[84:85], v[36:37]
  v_pk_mul_f32 v[52:53], v[84:85], v[52:53]
  v_pk_mul_f32 v[68:69], v[84:85], v[68:69]
  v_pk_fma_f32 v[20:21], v[100:101], v[116:117], v[20:21] op_sel_hi:[1,0,1] neg_lo:[1,0,0] neg_hi:[1,0,0]
  v_pk_fma_f32 v[36:37], v[100:101], v[116:117], v[36:37] op_sel:[0,1,0] neg_lo:[1,0,0] neg_hi:[1,0,0]
  v_pk_fma_f32 v[52:53], v[100:101], v[142:143], v[52:53] op_sel_hi:[1,0,1] neg_lo:[1,0,0] neg_hi:[1,0,0]
  v_pk_fma_f32 v[68:69], v[100:101], v[142:143], v[68:69] op_sel:[0,1,0] neg_lo:[1,0,0] neg_hi:[1,0,0]
  v_pk_mul_f32 v[22:23], v[86:87], v[22:23]
  v_pk_mul_f32 v[38:39], v[86:87], v[38:39]
  v_pk_mul_f32 v[54:55], v[86:87], v[54:55]
  v_pk_mul_f32 v[70:71], v[86:87], v[70:71]
  v_pk_fma_f32 v[22:23], v[102:103], v[116:117], v[22:23] op_sel_hi:[1,0,1] neg_lo:[1,0,0] neg_hi:[1,0,0]
  v_pk_fma_f32 v[38:39], v[102:103], v[116:117], v[38:39] op_sel:[0,1,0] neg_lo:[1,0,0] neg_hi:[1,0,0]
  v_pk_fma_f32 v[54:55], v[102:103], v[142:143], v[54:55] op_sel_hi:[1,0,1] neg_lo:[1,0,0] neg_hi:[1,0,0]
  v_pk_fma_f32 v[70:71], v[102:103], v[142:143], v[70:71] op_sel:[0,1,0] neg_lo:[1,0,0] neg_hi:[1,0,0]
  v_pk_mul_f32 v[24:25], v[88:89], v[24:25]
  v_pk_mul_f32 v[40:41], v[88:89], v[40:41]
  v_pk_mul_f32 v[56:57], v[88:89], v[56:57]
  v_pk_mul_f32 v[72:73], v[88:89], v[72:73]
  v_pk_fma_f32 v[24:25], v[104:105], v[116:117], v[24:25] op_sel_hi:[1,0,1] neg_lo:[1,0,0] neg_hi:[1,0,0]
  v_pk_fma_f32 v[40:41], v[104:105], v[116:117], v[40:41] op_sel:[0,1,0] neg_lo:[1,0,0] neg_hi:[1,0,0]
  v_pk_fma_f32 v[56:57], v[104:105], v[142:143], v[56:57] op_sel_hi:[1,0,1] neg_lo:[1,0,0] neg_hi:[1,0,0]
  v_pk_fma_f32 v[72:73], v[104:105], v[142:143], v[72:73] op_sel:[0,1,0] neg_lo:[1,0,0] neg_hi:[1,0,0]
  v_pk_mul_f32 v[26:27], v[90:91], v[26:27]
  v_pk_mul_f32 v[42:43], v[90:91], v[42:43]
  v_pk_mul_f32 v[58:59], v[90:91], v[58:59]
  v_pk_mul_f32 v[74:75], v[90:91], v[74:75]
  v_pk_fma_f32 v[26:27], v[106:107], v[116:117], v[26:27] op_sel_hi:[1,0,1] neg_lo:[1,0,0] neg_hi:[1,0,0]
  v_pk_fma_f32 v[42:43], v[106:107], v[116:117], v[42:43] op_sel:[0,1,0] neg_lo:[1,0,0] neg_hi:[1,0,0]
  v_pk_fma_f32 v[58:59], v[106:107], v[142:143], v[58:59] op_sel_hi:[1,0,1] neg_lo:[1,0,0] neg_hi:[1,0,0]
  v_pk_fma_f32 v[74:75], v[106:107], v[142:143], v[74:75] op_sel:[0,1,0] neg_lo:[1,0,0] neg_hi:[1,0,0]
  v_pk_fma_f32 v[124:125], v[108:109], v[12:13], v[14:15] op_sel_hi:[0,1,1]
  v_pk_fma_f32 v[126:127], v[108:109], v[28:29], v[30:31] op_sel_hi:[0,1,1]
  v_pk_fma_f32 v[150:151], v[134:135], v[44:45], v[46:47] op_sel_hi:[0,1,1]
  v_pk_fma_f32 v[152:153], v[134:135], v[60:61], v[62:63] op_sel_hi:[0,1,1]
  v_pk_fma_f32 v[124:125], v[108:109], v[28:29], v[124:125] op_sel:[1,0,0] neg_lo:[1,0,0] neg_hi:[1,0,0]
  v_pk_fma_f32 v[126:127], v[108:109], v[12:13], v[126:127] op_sel:[1,0,0]
  v_pk_fma_f32 v[150:151], v[134:135], v[60:61], v[150:151] op_sel:[1,0,0] neg_lo:[1,0,0] neg_hi:[1,0,0]
  v_pk_fma_f32 v[152:153], v[134:135], v[44:45], v[152:153] op_sel:[1,0,0]
  v_pk_fma_f32 v[128:129], v[108:109], v[124:125], v[16:17] op_sel_hi:[0,1,1]
  v_pk_fma_f32 v[130:131], v[108:109], v[126:127], v[32:33] op_sel_hi:[0,1,1]
  v_pk_fma_f32 v[154:155], v[134:135], v[150:151], v[48:49] op_sel_hi:[0,1,1]
  v_pk_fma_f32 v[156:157], v[134:135], v[152:153], v[64:65] op_sel_hi:[0,1,1]
  v_pk_fma_f32 v[128:129], v[108:109], v[126:127], v[128:129] op_sel:[1,0,0] neg_lo:[1,0,0] neg_hi:[1,0,0]
  v_pk_fma_f32 v[130:131], v[108:109], v[124:125], v[130:131] op_sel:[1,0,0]
  v_pk_fma_f32 v[154:155], v[134:135], v[152:153], v[154:155] op_sel:[1,0,0] neg_lo:[1,0,0] neg_hi:[1,0,0]
  v_pk_fma_f32 v[156:157], v[134:135], v[150:151], v[156:157] op_sel:[1,0,0]
  v_pk_fma_f32 v[124:125], v[108:109], v[128:129], v[18:19] op_sel_hi:[0,1,1]
  v_pk_fma_f32 v[126:127], v[108:109], v[130:131], v[34:35] op_sel_hi:[0,1,1]
  v_pk_fma_f32 v[150:151], v[134:135], v[154:155], v[50:51] op_sel_hi:[0,1,1]
  v_pk_fma_f32 v[152:153], v[134:135], v[156:157], v[66:67] op_sel_hi:[0,1,1]
  v_pk_fma_f32 v[124:125], v[108:109], v[130:131], v[124:125] op_sel:[1,0,0] neg_lo:[1,0,0] neg_hi:[1,0,0]
  v_pk_fma_f32 v[126:127], v[108:109], v[128:129], v[126:127] op_sel:[1,0,0]
  v_pk_fma_f32 v[150:151], v[134:135], v[156:157], v[150:151] op_sel:[1,0,0] neg_lo:[1,0,0] neg_hi:[1,0,0]
  v_pk_fma_f32 v[152:153], v[134:135], v[154:155], v[152:153] op_sel:[1,0,0]
  v_pk_fma_f32 v[128:129], v[108:109], v[124:125], v[20:21] op_sel_hi:[0,1,1]
  v_pk_fma_f32 v[130:131], v[108:109], v[126:127], v[36:37] op_sel_hi:[0,1,1]
  v_pk_fma_f32 v[154:155], v[134:135], v[150:151], v[52:53] op_sel_hi:[0,1,1]
  v_pk_fma_f32 v[156:157], v[134:135], v[152:153], v[68:69] op_sel_hi:[0,1,1]
  v_pk_fma_f32 v[128:129], v[108:109], v[126:127], v[128:129] op_sel:[1,0,0] neg_lo:[1,0,0] neg_hi:[1,0,0]
  v_pk_fma_f32 v[130:131], v[108:109], v[124:125], v[130:131] op_sel:[1,0,0]
  v_pk_fma_f32 v[154:155], v[134:135], v[152:153], v[154:155] op_sel:[1,0,0] neg_lo:[1,0,0] neg_hi:[1,0,0]
  v_pk_fma_f32 v[156:157], v[134:135], v[150:151], v[156:157] op_sel:[1,0,0]
  v_pk_fma_f32 v[124:125], v[108:109], v[128:129], v[22:23] op_sel_hi:[0,1,1]
  v_pk_fma_f32 v[126:127], v[108:109], v[130:131], v[38:39] op_sel_hi:[0,1,1]
  v_pk_fma_f32 v[150:151], v[134:135], v[154:155], v[54:55] op_sel_hi:[0,1,1]
  v_pk_fma_f32 v[152:153], v[134:135], v[156:157], v[70:71] op_sel_hi:[0,1,1]
  v_pk_fma_f32 v[124:125], v[108:109], v[130:131], v[124:125] op_sel:[1,0,0] neg_lo:[1,0,0] neg_hi:[1,0,0]
  v_pk_fma_f32 v[126:127], v[108:109], v[128:129], v[126:127] op_sel:[1,0,0]
  v_pk_fma_f32 v[150:151], v[134:135], v[156:157], v[150:151] op_sel:[1,0,0] neg_lo:[1,0,0] neg_hi:[1,0,0]
  v_pk_fma_f32 v[152:153], v[134:135], v[154:155], v[152:153] op_sel:[1,0,0]
  v_pk_fma_f32 v[128:129], v[108:109], v[124:125], v[24:25] op_sel_hi:[0,1,1]
  v_pk_fma_f32 v[130:131], v[108:109], v[126:127], v[40:41] op_sel_hi:[0,1,1]
  v_pk_fma_f32 v[154:155], v[134:135], v[150:151], v[56:57] op_sel_hi:[0,1,1]
  v_pk_fma_f32 v[156:157], v[134:135], v[152:153], v[72:73] op_sel_hi:[0,1,1]
  v_pk_fma_f32 v[128:129], v[108:109], v[126:127], v[128:129] op_sel:[1,0,0] neg_lo:[1,0,0] neg_hi:[1,0,0]
  v_pk_fma_f32 v[130:131], v[108:109], v[124:125], v[130:131] op_sel:[1,0,0]
  v_pk_fma_f32 v[154:155], v[134:135], v[152:153], v[154:155] op_sel:[1,0,0] neg_lo:[1,0,0] neg_hi:[1,0,0]
  v_pk_fma_f32 v[156:157], v[134:135], v[150:151], v[156:157] op_sel:[1,0,0]
  v_pk_fma_f32 v[124:125], v[108:109], v[128:129], v[26:27] op_sel_hi:[0,1,1]
  v_pk_fma_f32 v[126:127], v[108:109], v[130:131], v[42:43] op_sel_hi:[0,1,1]
  v_pk_fma_f32 v[150:151], v[134:135], v[154:155], v[58:59] op_sel_hi:[0,1,1]
  v_pk_fma_f32 v[152:153], v[134:135], v[156:157], v[74:75] op_sel_hi:[0,1,1]
  v_pk_fma_f32 v[124:125], v[108:109], v[130:131], v[124:125] op_sel:[1,0,0] neg_lo:[1,0,0] neg_hi:[1,0,0]
  v_pk_fma_f32 v[126:127], v[108:109], v[128:129], v[126:127] op_sel:[1,0,0]
  v_pk_fma_f32 v[150:151], v[134:135], v[156:157], v[150:151] op_sel:[1,0,0] neg_lo:[1,0,0] neg_hi:[1,0,0]
  v_pk_fma_f32 v[152:153], v[134:135], v[154:155], v[152:153] op_sel:[1,0,0]
  v_mov_b32 v120, v124
  v_mov_b32 v121, v126
  v_fma_f32 v132, v110, v124, v125
  v_fma_f32 v133, v110, v126, v127
  v_fma_f32 v132, -v111, v126, v132
  v_fma_f32 v133, v111, v124, v133
  ds_write_b64 v8, v[132:133] offset:896
  v_mov_b32 v146, v150
  v_mov_b32 v147, v152
  v_fma_f32 v158, v136, v150, v151
  v_fma_f32 v159, v136, v152, v153
  v_fma_f32 v158, -v137, v152, v158
  v_fma_f32 v159, v137, v150, v159
  ds_write_b64 v8, v[158:159] offset:2816

  v_mov_b32 v9, 122888
  s_lshl_b32 s60, s67, 2
  v_add_u32 v9, s60, v9
  s_cmp_eq_u32 s66, 0
  s_cbranch_scc0 K1_e1_0
  v_mov_b32 v7, 1
  s_waitcnt lgkmcnt(0)
  ds_write_b32 v9, v7
  s_branch K1_e2_0
K1_e1_0:
K1_ep_0:
  ds_read_b32 v7, v9 offset:0
  s_waitcnt lgkmcnt(0)
  v_readfirstlane_b32 s60, v7
  s_cmp_eq_u32 s60, 0
  s_cbranch_scc1 K1_ep_0
K1_e2_0:
  ds_read_b64 v[160:161], v8 offset:0
  ds_read_b64 v[162:163], v8 offset:128
  ds_read_b64 v[164:165], v8 offset:256
  ds_read_b64 v[166:167], v8 offset:384
  ds_read_b64 v[168:169], v8 offset:512
  ds_read_b64 v[170:171], v8 offset:640
  ds_read_b64 v[172:173], v8 offset:768
  ds_read_b64 v[174:175], v8 offset:1920
  ds_read_b64 v[176:177], v8 offset:2048
  ds_read_b64 v[178:179], v8 offset:2176
  ds_read_b64 v[180:181], v8 offset:2304
  ds_read_b64 v[182:183], v8 offset:2432
  ds_read_b64 v[184:185], v8 offset:2560
  ds_read_b64 v[186:187], v8 offset:2688
  s_waitcnt lgkmcnt(0)
  v_pk_fma_f32 v[124:125], v[112:113], v[160:161], v[162:163] op_sel_hi:[0,1,1]
  v_pk_fma_f32 v[150:151], v[138:139], v[174:175], v[176:177] op_sel_hi:[0,1,1]
  v_pk_fma_f32 v[124:125], v[112:113], v[160:161], v[124:125] op_sel:[1,1,0] op_sel_hi:[1,0,1] neg_lo:[0,1,0]
  v_pk_fma_f32 v[150:151], v[138:139], v[174:175], v[150:151] op_sel:[1,1,0] op_sel_hi:[1,0,1] neg_lo:[0,1,0]
  v_pk_fma_f32 v[128:129], v[112:113], v[124:125], v[164:165] op_sel_hi:[0,1,1]
  v_pk_fma_f32 v[154:155], v[138:139], v[150:151], v[178:179] op_sel_hi:[0,1,1]
  v_pk_fma_f32 v[128:129], v[112:113], v[124:125], v[128:129] op_sel:[1,1,0] op_sel_hi:[1,0,1] neg_lo:[0,1,0]
  v_pk_fma_f32 v[154:155], v[138:139], v[150:151], v[154:155] op_sel:[1,1,0] op_sel_hi:[1,0,1] neg_lo:[0,1,0]
  v_pk_fma_f32 v[124:125], v[112:113], v[128:129], v[166:167] op_sel_hi:[0,1,1]
  v_pk_fma_f32 v[150:151], v[138:139], v[154:155], v[180:181] op_sel_hi:[0,1,1]
  v_pk_fma_f32 v[124:125], v[112:113], v[128:129], v[124:125] op_sel:[1,1,0] op_sel_hi:[1,0,1] neg_lo:[0,1,0]
  v_pk_fma_f32 v[150:151], v[138:139], v[154:155], v[150:151] op_sel:[1,1,0] op_sel_hi:[1,0,1] neg_lo:[0,1,0]
  v_pk_fma_f32 v[128:129], v[112:113], v[124:125], v[168:169] op_sel_hi:[0,1,1]
  v_pk_fma_f32 v[154:155], v[138:139], v[150:151], v[182:183] op_sel_hi:[0,1,1]
  v_pk_fma_f32 v[128:129], v[112:113], v[124:125], v[128:129] op_sel:[1,1,0] op_sel_hi:[1,0,1] neg_lo:[0,1,0]
  v_pk_fma_f32 v[154:155], v[138:139], v[150:151], v[154:155] op_sel:[1,1,0] op_sel_hi:[1,0,1] neg_lo:[0,1,0]
  v_pk_fma_f32 v[124:125], v[112:113], v[128:129], v[170:171] op_sel_hi:[0,1,1]
  v_pk_fma_f32 v[150:151], v[138:139], v[154:155], v[184:185] op_sel_hi:[0,1,1]
  v_pk_fma_f32 v[124:125], v[112:113], v[128:129], v[124:125] op_sel:[1,1,0] op_sel_hi:[1,0,1] neg_lo:[0,1,0]
  v_pk_fma_f32 v[150:151], v[138:139], v[154:155], v[150:151] op_sel:[1,1,0] op_sel_hi:[1,0,1] neg_lo:[0,1,0]
  v_pk_fma_f32 v[122:123], v[112:113], v[124:125], v[172:173] op_sel_hi:[0,1,1]
  v_pk_fma_f32 v[148:149], v[138:139], v[150:151], v[186:187] op_sel_hi:[0,1,1]
  v_pk_fma_f32 v[122:123], v[112:113], v[124:125], v[122:123] op_sel:[1,1,0] op_sel_hi:[1,0,1] neg_lo:[0,1,0]
  v_pk_fma_f32 v[148:149], v[138:139], v[150:151], v[148:149] op_sel:[1,1,0] op_sel_hi:[1,0,1] neg_lo:[0,1,0]

  s_cmp_eq_u32 s66, 1
  s_cbranch_scc0 K1_nopub_0
  v_mov_b32 v9, 122912
  ds_read_b32 v7, v9
  v_and_b32 v1, 15, v0
  s_add_u32 s60, s32, s67
  s_lshl_b32 s60, s60, 4
  s_mul_i32 s61, s29, 640
  s_add_u32 s60, s60, s61
  v_add_u32 v1, s60, v1
  v_lshlrev_b32 v1, 4, v1
  v_add_u32 v1, 65536, v1
  s_waitcnt lgkmcnt(0)

  v_pk_fma_f32 v[128:129], v[112:113], v[122:123], v[132:133] op_sel_hi:[0,1,1]
  v_pk_fma_f32 v[128:129], v[112:113], v[122:123], v[128:129] op_sel:[1,1,0] op_sel_hi:[1,0,1] neg_lo:[0,1,0]
  v_mov_b32 v124, v128
  v_mov_b32 v125, v7
  v_mov_b32 v126, v129
  v_mov_b32 v127, v7
  v_pk_fma_f32 v[154:155], v[138:139], v[148:149], v[158:159] op_sel_hi:[0,1,1]
  v_pk_fma_f32 v[154:155], v[138:139], v[148:149], v[154:155] op_sel:[1,1,0] op_sel_hi:[1,0,1] neg_lo:[0,1,0]
  v_mov_b32 v150, v154
  v_mov_b32 v151, v7
  v_mov_b32 v152, v155
  v_mov_b32 v153, v7
  s_mov_b32 exec_lo, 0
  s_mov_b32 exec_hi, 0xffff0000
  buffer_store_dwordx4 v[124:127], v1, s[44:47], 0 offen offset:0 sc1
  buffer_store_dwordx4 v[150:153], v1, s[44:47], 0 offen offset:256 sc1
  s_mov_b64 exec, -1
K1_nopub_0:
  v_mov_b32 v9, 122912
  ds_read_b32 v7, v9
  s_lshl_b32 s60, s29, 1
  s_add_u32 s60, s60, s66
  s_lshl_b32 s60, s60, 7
  s_lshl_b32 s61, s30, 1
  s_add_u32 s61, s61, s69
  s_lshl_b32 s61, s61, 2
  s_add_u32 s78, s60, s61
  s_add_u32 s60, s78, 528384
  v_mov_b32 v1, s60
  s_waitcnt lgkmcnt(0)
  v_readfirstlane_b32 s79, v7
  s_mov_b64 exec, 1
  buffer_store_dword v7, v1, s[44:47], 0 offen sc1
  s_lshl_b32 s60, s28, 2
  s_add_u32 s60, s60, 122928
  v_mov_b32 v9, s60
  v_mov_b32 v7, 1
  ds_write_b32 v9, v7
  s_mov_b64 exec, -1
  v_mov_b32 v9, 122884
K1_hp_0:
  ds_read_b32 v7, v9 offset:0
  s_waitcnt lgkmcnt(0)
  v_readfirstlane_b32 s60, v7
  s_cmp_eq_u32 s60, 0
  s_cbranch_scc1 K1_hp_0
  ds_read_b64 v[124:125], v11 offset:13312
  ds_read_b64 v[150:151], v11 offset:13440
  s_waitcnt lgkmcnt(0)
  v_pk_fma_f32 v[126:127], v[118:119], v[124:125], v[122:123] op_sel_hi:[0,1,1]
  v_pk_fma_f32 v[126:127], v[118:119], v[124:125], v[126:127] op_sel:[1,1,0] op_sel_hi:[1,0,1] neg_lo:[0,1,0]
  v_pk_fma_f32 v[128:129], v[110:111], v[126:127], v[120:121] op_sel_hi:[0,1,1]
  v_pk_fma_f32 v[128:129], v[110:111], v[126:127], v[128:129] op_sel:[1,1,0] op_sel_hi:[1,0,1] neg_lo:[0,1,0]
  v_mov_b32 v124, v126
  v_mov_b32 v125, v128
  v_mov_b32 v130, v127
  v_mov_b32 v131, v129
  v_pk_fma_f32 v[152:153], v[144:145], v[150:151], v[148:149] op_sel_hi:[0,1,1]
  v_pk_fma_f32 v[152:153], v[144:145], v[150:151], v[152:153] op_sel:[1,1,0] op_sel_hi:[1,0,1] neg_lo:[0,1,0]
  v_pk_fma_f32 v[154:155], v[136:137], v[152:153], v[146:147] op_sel_hi:[0,1,1]
  v_pk_fma_f32 v[154:155], v[136:137], v[152:153], v[154:155] op_sel:[1,1,0] op_sel_hi:[1,0,1] neg_lo:[0,1,0]
  v_mov_b32 v150, v152
  v_mov_b32 v151, v154
  v_mov_b32 v156, v153
  v_mov_b32 v157, v155
  v_pk_fma_f32 v[12:13], v[108:109], v[124:125], v[12:13] op_sel_hi:[0,1,1]
  v_pk_fma_f32 v[28:29], v[108:109], v[130:131], v[28:29] op_sel_hi:[0,1,1]
  v_pk_fma_f32 v[44:45], v[134:135], v[150:151], v[44:45] op_sel_hi:[0,1,1]
  v_pk_fma_f32 v[60:61], v[134:135], v[156:157], v[60:61] op_sel_hi:[0,1,1]
  v_pk_fma_f32 v[12:13], v[108:109], v[130:131], v[12:13] op_sel:[1,0,0] neg_lo:[1,0,0] neg_hi:[1,0,0]
  v_pk_fma_f32 v[28:29], v[108:109], v[124:125], v[28:29] op_sel:[1,0,0]
  v_pk_fma_f32 v[44:45], v[134:135], v[156:157], v[44:45] op_sel:[1,0,0] neg_lo:[1,0,0] neg_hi:[1,0,0]
  v_pk_fma_f32 v[60:61], v[134:135], v[150:151], v[60:61] op_sel:[1,0,0]
  v_pk_fma_f32 v[14:15], v[108:109], v[12:13], v[14:15] op_sel_hi:[0,1,1]
  v_pk_fma_f32 v[30:31], v[108:109], v[28:29], v[30:31] op_sel_hi:[0,1,1]
  v_pk_fma_f32 v[46:47], v[134:135], v[44:45], v[46:47] op_sel_hi:[0,1,1]
  v_pk_fma_f32 v[62:63], v[134:135], v[60:61], v[62:63] op_sel_hi:[0,1,1]
  v_pk_fma_f32 v[14:15], v[108:109], v[28:29], v[14:15] op_sel:[1,0,0] neg_lo:[1,0,0] neg_hi:[1,0,0]
  v_pk_fma_f32 v[30:31], v[108:109], v[12:13], v[30:31] op_sel:[1,0,0]
  v_pk_fma_f32 v[46:47], v[134:135], v[60:61], v[46:47] op_sel:[1,0,0] neg_lo:[1,0,0] neg_hi:[1,0,0]
  v_pk_fma_f32 v[62:63], v[134:135], v[44:45], v[62:63] op_sel:[1,0,0]
  v_pk_fma_f32 v[16:17], v[108:109], v[14:15], v[16:17] op_sel_hi:[0,1,1]
  v_pk_fma_f32 v[32:33], v[108:109], v[30:31], v[32:33] op_sel_hi:[0,1,1]
  v_pk_fma_f32 v[48:49], v[134:135], v[46:47], v[48:49] op_sel_hi:[0,1,1]
  v_pk_fma_f32 v[64:65], v[134:135], v[62:63], v[64:65] op_sel_hi:[0,1,1]
  v_pk_fma_f32 v[16:17], v[108:109], v[30:31], v[16:17] op_sel:[1,0,0] neg_lo:[1,0,0] neg_hi:[1,0,0]
  v_pk_fma_f32 v[32:33], v[108:109], v[14:15], v[32:33] op_sel:[1,0,0]
  v_pk_fma_f32 v[48:49], v[134:135], v[62:63], v[48:49] op_sel:[1,0,0] neg_lo:[1,0,0] neg_hi:[1,0,0]
  v_pk_fma_f32 v[64:65], v[134:135], v[46:47], v[64:65] op_sel:[1,0,0]
  v_pk_fma_f32 v[18:19], v[108:109], v[16:17], v[18:19] op_sel_hi:[0,1,1]
  v_pk_fma_f32 v[34:35], v[108:109], v[32:33], v[34:35] op_sel_hi:[0,1,1]
  v_pk_fma_f32 v[50:51], v[134:135], v[48:49], v[50:51] op_sel_hi:[0,1,1]
  v_pk_fma_f32 v[66:67], v[134:135], v[64:65], v[66:67] op_sel_hi:[0,1,1]
  v_pk_fma_f32 v[18:19], v[108:109], v[32:33], v[18:19] op_sel:[1,0,0] neg_lo:[1,0,0] neg_hi:[1,0,0]
  v_pk_fma_f32 v[34:35], v[108:109], v[16:17], v[34:35] op_sel:[1,0,0]
  v_pk_fma_f32 v[50:51], v[134:135], v[64:65], v[50:51] op_sel:[1,0,0] neg_lo:[1,0,0] neg_hi:[1,0,0]
  v_pk_fma_f32 v[66:67], v[134:135], v[48:49], v[66:67] op_sel:[1,0,0]
  v_pk_fma_f32 v[20:21], v[108:109], v[18:19], v[20:21] op_sel_hi:[0,1,1]
  v_pk_fma_f32 v[36:37], v[108:109], v[34:35], v[36:37] op_sel_hi:[0,1,1]
  v_pk_fma_f32 v[52:53], v[134:135], v[50:51], v[52:53] op_sel_hi:[0,1,1]
  v_pk_fma_f32 v[68:69], v[134:135], v[66:67], v[68:69] op_sel_hi:[0,1,1]
  v_pk_fma_f32 v[20:21], v[108:109], v[34:35], v[20:21] op_sel:[1,0,0] neg_lo:[1,0,0] neg_hi:[1,0,0]
  v_pk_fma_f32 v[36:37], v[108:109], v[18:19], v[36:37] op_sel:[1,0,0]
  v_pk_fma_f32 v[52:53], v[134:135], v[66:67], v[52:53] op_sel:[1,0,0] neg_lo:[1,0,0] neg_hi:[1,0,0]
  v_pk_fma_f32 v[68:69], v[134:135], v[50:51], v[68:69] op_sel:[1,0,0]
  v_pk_fma_f32 v[22:23], v[108:109], v[20:21], v[22:23] op_sel_hi:[0,1,1]
  v_pk_fma_f32 v[38:39], v[108:109], v[36:37], v[38:39] op_sel_hi:[0,1,1]
  v_pk_fma_f32 v[54:55], v[134:135], v[52:53], v[54:55] op_sel_hi:[0,1,1]
  v_pk_fma_f32 v[70:71], v[134:135], v[68:69], v[70:71] op_sel_hi:[0,1,1]
  v_pk_fma_f32 v[22:23], v[108:109], v[36:37], v[22:23] op_sel:[1,0,0] neg_lo:[1,0,0] neg_hi:[1,0,0]
  v_pk_fma_f32 v[38:39], v[108:109], v[20:21], v[38:39] op_sel:[1,0,0]
  v_pk_fma_f32 v[54:55], v[134:135], v[68:69], v[54:55] op_sel:[1,0,0] neg_lo:[1,0,0] neg_hi:[1,0,0]
  v_pk_fma_f32 v[70:71], v[134:135], v[52:53], v[70:71] op_sel:[1,0,0]
  v_pk_fma_f32 v[24:25], v[108:109], v[22:23], v[24:25] op_sel_hi:[0,1,1]
  v_pk_fma_f32 v[40:41], v[108:109], v[38:39], v[40:41] op_sel_hi:[0,1,1]
  v_pk_fma_f32 v[56:57], v[134:135], v[54:55], v[56:57] op_sel_hi:[0,1,1]
  v_pk_fma_f32 v[72:73], v[134:135], v[70:71], v[72:73] op_sel_hi:[0,1,1]
  v_pk_fma_f32 v[24:25], v[108:109], v[38:39], v[24:25] op_sel:[1,0,0] neg_lo:[1,0,0] neg_hi:[1,0,0]
  v_pk_fma_f32 v[40:41], v[108:109], v[22:23], v[40:41] op_sel:[1,0,0]
  v_pk_fma_f32 v[56:57], v[134:135], v[70:71], v[56:57] op_sel:[1,0,0] neg_lo:[1,0,0] neg_hi:[1,0,0]
  v_pk_fma_f32 v[72:73], v[134:135], v[54:55], v[72:73] op_sel:[1,0,0]
  v_pk_fma_f32 v[26:27], v[108:109], v[24:25], v[26:27] op_sel_hi:[0,1,1]
  v_pk_fma_f32 v[42:43], v[108:109], v[40:41], v[42:43] op_sel_hi:[0,1,1]
  v_pk_fma_f32 v[58:59], v[134:135], v[56:57], v[58:59] op_sel_hi:[0,1,1]
  v_pk_fma_f32 v[74:75], v[134:135], v[72:73], v[74:75] op_sel_hi:[0,1,1]
  v_pk_fma_f32 v[26:27], v[108:109], v[40:41], v[26:27] op_sel:[1,0,0] neg_lo:[1,0,0] neg_hi:[1,0,0]
  v_pk_fma_f32 v[42:43], v[108:109], v[24:25], v[42:43] op_sel:[1,0,0]
  v_pk_fma_f32 v[58:59], v[134:135], v[72:73], v[58:59] op_sel:[1,0,0] neg_lo:[1,0,0] neg_hi:[1,0,0]
  v_pk_fma_f32 v[74:75], v[134:135], v[56:57], v[74:75] op_sel:[1,0,0]

  v_and_b32 v1, 15, v0
  v_lshlrev_b32 v1, 5, v1
  v_lshrrev_b32 v7, 4, v0
  v_lshl_add_u32 v1, v7, 3, v1
  s_lshl_b32 s60, s28, 12
  s_add_u32 s60, s60, 139264
  v_add_u32 v1, s60, v1
  v_lshlrev_b32 v7, 3, v0
  v_add_u32 v7, s60, v7

  v_pk_mul_f32 v[160:161], v[114:115], v[12:13] op_sel_hi:[0,1]
  v_pk_mul_f32 v[164:165], v[114:115], v[28:29] op_sel_hi:[0,1] neg_lo:[1,0] neg_hi:[1,0]
  v_pk_mul_f32 v[162:163], v[114:115], v[14:15] op_sel_hi:[0,1]
  v_pk_mul_f32 v[166:167], v[114:115], v[30:31] op_sel_hi:[0,1] neg_lo:[1,0] neg_hi:[1,0]
  v_pk_fma_f32 v[160:161], v[114:115], v[28:29], v[160:161] op_sel:[1,0,0] neg_lo:[1,0,0] neg_hi:[1,0,0]
  v_pk_fma_f32 v[164:165], v[114:115], v[12:13], v[164:165] op_sel:[1,0,0] neg_lo:[1,0,0] neg_hi:[1,0,0]
  v_pk_fma_f32 v[162:163], v[114:115], v[30:31], v[162:163] op_sel:[1,0,0] neg_lo:[1,0,0] neg_hi:[1,0,0]
  v_pk_fma_f32 v[166:167], v[114:115], v[14:15], v[166:167] op_sel:[1,0,0] neg_lo:[1,0,0] neg_hi:[1,0,0]
  v_cvt_pk_bf16_f32 v176, v160, v161
  v_cvt_pk_bf16_f32 v177, v162, v163
  v_cvt_pk_bf16_f32 v178, v164, v165
  v_cvt_pk_bf16_f32 v179, v166, v167
  ds_write_b64 v1, v[176:177] offset:0
  ds_write_b64 v1, v[178:179] offset:512
  v_pk_mul_f32 v[168:169], v[114:115], v[16:17] op_sel_hi:[0,1]
  v_pk_mul_f32 v[172:173], v[114:115], v[32:33] op_sel_hi:[0,1] neg_lo:[1,0] neg_hi:[1,0]
  v_pk_mul_f32 v[170:171], v[114:115], v[18:19] op_sel_hi:[0,1]
  v_pk_mul_f32 v[174:175], v[114:115], v[34:35] op_sel_hi:[0,1] neg_lo:[1,0] neg_hi:[1,0]
  v_pk_fma_f32 v[168:169], v[114:115], v[32:33], v[168:169] op_sel:[1,0,0] neg_lo:[1,0,0] neg_hi:[1,0,0]
  v_pk_fma_f32 v[172:173], v[114:115], v[16:17], v[172:173] op_sel:[1,0,0] neg_lo:[1,0,0] neg_hi:[1,0,0]
  v_pk_fma_f32 v[170:171], v[114:115], v[34:35], v[170:171] op_sel:[1,0,0] neg_lo:[1,0,0] neg_hi:[1,0,0]
  v_pk_fma_f32 v[174:175], v[114:115], v[18:19], v[174:175] op_sel:[1,0,0] neg_lo:[1,0,0] neg_hi:[1,0,0]
  v_cvt_pk_bf16_f32 v180, v168, v169
  v_cvt_pk_bf16_f32 v181, v170, v171
  v_cvt_pk_bf16_f32 v182, v172, v173
  v_cvt_pk_bf16_f32 v183, v174, v175
  ds_write_b64 v1, v[180:181] offset:1024
  ds_write_b64 v1, v[182:183] offset:1536
  v_pk_mul_f32 v[160:161], v[114:115], v[20:21] op_sel_hi:[0,1]
  v_pk_mul_f32 v[164:165], v[114:115], v[36:37] op_sel_hi:[0,1] neg_lo:[1,0] neg_hi:[1,0]
  v_pk_mul_f32 v[162:163], v[114:115], v[22:23] op_sel_hi:[0,1]
  v_pk_mul_f32 v[166:167], v[114:115], v[38:39] op_sel_hi:[0,1] neg_lo:[1,0] neg_hi:[1,0]
  v_pk_fma_f32 v[160:161], v[114:115], v[36:37], v[160:161] op_sel:[1,0,0] neg_lo:[1,0,0] neg_hi:[1,0,0]
  v_pk_fma_f32 v[164:165], v[114:115], v[20:21], v[164:165] op_sel:[1,0,0] neg_lo:[1,0,0] neg_hi:[1,0,0]
  v_pk_fma_f32 v[162:163], v[114:115], v[38:39], v[162:163] op_sel:[1,0,0] neg_lo:[1,0,0] neg_hi:[1,0,0]
  v_pk_fma_f32 v[166:167], v[114:115], v[22:23], v[166:167] op_sel:[1,0,0] neg_lo:[1,0,0] neg_hi:[1,0,0]
  v_cvt_pk_bf16_f32 v176, v160, v161
  v_cvt_pk_bf16_f32 v177, v162, v163
  v_cvt_pk_bf16_f32 v178, v164, v165
  v_cvt_pk_bf16_f32 v179, v166, v167
  ds_write_b64 v1, v[176:177] offset:2048
  ds_write_b64 v1, v[178:179] offset:2560
  v_pk_mul_f32 v[168:169], v[114:115], v[24:25] op_sel_hi:[0,1]
  v_pk_mul_f32 v[172:173], v[114:115], v[40:41] op_sel_hi:[0,1] neg_lo:[1,0] neg_hi:[1,0]
  v_pk_mul_f32 v[170:171], v[114:115], v[26:27] op_sel_hi:[0,1]
  v_pk_mul_f32 v[174:175], v[114:115], v[42:43] op_sel_hi:[0,1] neg_lo:[1,0] neg_hi:[1,0]
  v_pk_fma_f32 v[168:169], v[114:115], v[40:41], v[168:169] op_sel:[1,0,0] neg_lo:[1,0,0] neg_hi:[1,0,0]
  v_pk_fma_f32 v[172:173], v[114:115], v[24:25], v[172:173] op_sel:[1,0,0] neg_lo:[1,0,0] neg_hi:[1,0,0]
  v_pk_fma_f32 v[170:171], v[114:115], v[42:43], v[170:171] op_sel:[1,0,0] neg_lo:[1,0,0] neg_hi:[1,0,0]
  v_pk_fma_f32 v[174:175], v[114:115], v[26:27], v[174:175] op_sel:[1,0,0] neg_lo:[1,0,0] neg_hi:[1,0,0]
  v_cvt_pk_bf16_f32 v180, v168, v169
  v_cvt_pk_bf16_f32 v181, v170, v171
  v_cvt_pk_bf16_f32 v182, v172, v173
  v_cvt_pk_bf16_f32 v183, v174, v175
  ds_write_b64 v1, v[180:181] offset:3072
  ds_write_b64 v1, v[182:183] offset:3584
  ds_read_b64_tr_b16 v[184:185], v7 offset:0
  ds_read_b64_tr_b16 v[186:187], v7 offset:512
  ds_read_b64_tr_b16 v[188:189], v7 offset:1024
  ds_read_b64_tr_b16 v[190:191], v7 offset:1536
  ds_read_b64_tr_b16 v[192:193], v7 offset:2048
  ds_read_b64_tr_b16 v[194:195], v7 offset:2560
  ds_read_b64_tr_b16 v[196:197], v7 offset:3072
  ds_read_b64_tr_b16 v[198:199], v7 offset:3584
  s_waitcnt lgkmcnt(6)
  s_add_u32 s60, s68, 0
  buffer_store_dwordx4 v[184:187], v10, s[40:43], s60 offen sc1
  s_waitcnt lgkmcnt(4)
  s_add_u32 s60, s68, 90112
  buffer_store_dwordx4 v[188:191], v10, s[40:43], s60 offen sc1
  s_waitcnt lgkmcnt(2)
  s_add_u32 s60, s68, 180224
  buffer_store_dwordx4 v[192:195], v10, s[40:43], s60 offen sc1
  s_waitcnt lgkmcnt(0)
  s_add_u32 s60, s68, 270336
  buffer_store_dwordx4 v[196:199], v10, s[40:43], s60 offen sc1
  v_pk_mul_f32 v[160:161], v[140:141], v[44:45] op_sel_hi:[0,1]
  v_pk_mul_f32 v[164:165], v[140:141], v[60:61] op_sel_hi:[0,1] neg_lo:[1,0] neg_hi:[1,0]
  v_pk_mul_f32 v[162:163], v[140:141], v[46:47] op_sel_hi:[0,1]
  v_pk_mul_f32 v[166:167], v[140:141], v[62:63] op_sel_hi:[0,1] neg_lo:[1,0] neg_hi:[1,0]
  v_pk_fma_f32 v[160:161], v[140:141], v[60:61], v[160:161] op_sel:[1,0,0] neg_lo:[1,0,0] neg_hi:[1,0,0]
  v_pk_fma_f32 v[164:165], v[140:141], v[44:45], v[164:165] op_sel:[1,0,0] neg_lo:[1,0,0] neg_hi:[1,0,0]
  v_pk_fma_f32 v[162:163], v[140:141], v[62:63], v[162:163] op_sel:[1,0,0] neg_lo:[1,0,0] neg_hi:[1,0,0]
  v_pk_fma_f32 v[166:167], v[140:141], v[46:47], v[166:167] op_sel:[1,0,0] neg_lo:[1,0,0] neg_hi:[1,0,0]
  v_cvt_pk_bf16_f32 v176, v160, v161
  v_cvt_pk_bf16_f32 v177, v162, v163
  v_cvt_pk_bf16_f32 v178, v164, v165
  v_cvt_pk_bf16_f32 v179, v166, v167
  ds_write_b64 v1, v[176:177] offset:0
  ds_write_b64 v1, v[178:179] offset:512
  v_pk_mul_f32 v[168:169], v[140:141], v[48:49] op_sel_hi:[0,1]
  v_pk_mul_f32 v[172:173], v[140:141], v[64:65] op_sel_hi:[0,1] neg_lo:[1,0] neg_hi:[1,0]
  v_pk_mul_f32 v[170:171], v[140:141], v[50:51] op_sel_hi:[0,1]
  v_pk_mul_f32 v[174:175], v[140:141], v[66:67] op_sel_hi:[0,1] neg_lo:[1,0] neg_hi:[1,0]
  v_pk_fma_f32 v[168:169], v[140:141], v[64:65], v[168:169] op_sel:[1,0,0] neg_lo:[1,0,0] neg_hi:[1,0,0]
  v_pk_fma_f32 v[172:173], v[140:141], v[48:49], v[172:173] op_sel:[1,0,0] neg_lo:[1,0,0] neg_hi:[1,0,0]
  v_pk_fma_f32 v[170:171], v[140:141], v[66:67], v[170:171] op_sel:[1,0,0] neg_lo:[1,0,0] neg_hi:[1,0,0]
  v_pk_fma_f32 v[174:175], v[140:141], v[50:51], v[174:175] op_sel:[1,0,0] neg_lo:[1,0,0] neg_hi:[1,0,0]
  v_cvt_pk_bf16_f32 v180, v168, v169
  v_cvt_pk_bf16_f32 v181, v170, v171
  v_cvt_pk_bf16_f32 v182, v172, v173
  v_cvt_pk_bf16_f32 v183, v174, v175
  ds_write_b64 v1, v[180:181] offset:1024
  ds_write_b64 v1, v[182:183] offset:1536
  v_pk_mul_f32 v[160:161], v[140:141], v[52:53] op_sel_hi:[0,1]
  v_pk_mul_f32 v[164:165], v[140:141], v[68:69] op_sel_hi:[0,1] neg_lo:[1,0] neg_hi:[1,0]
  v_pk_mul_f32 v[162:163], v[140:141], v[54:55] op_sel_hi:[0,1]
  v_pk_mul_f32 v[166:167], v[140:141], v[70:71] op_sel_hi:[0,1] neg_lo:[1,0] neg_hi:[1,0]
  v_pk_fma_f32 v[160:161], v[140:141], v[68:69], v[160:161] op_sel:[1,0,0] neg_lo:[1,0,0] neg_hi:[1,0,0]
  v_pk_fma_f32 v[164:165], v[140:141], v[52:53], v[164:165] op_sel:[1,0,0] neg_lo:[1,0,0] neg_hi:[1,0,0]
  v_pk_fma_f32 v[162:163], v[140:141], v[70:71], v[162:163] op_sel:[1,0,0] neg_lo:[1,0,0] neg_hi:[1,0,0]
  v_pk_fma_f32 v[166:167], v[140:141], v[54:55], v[166:167] op_sel:[1,0,0] neg_lo:[1,0,0] neg_hi:[1,0,0]
  v_cvt_pk_bf16_f32 v176, v160, v161
  v_cvt_pk_bf16_f32 v177, v162, v163
  v_cvt_pk_bf16_f32 v178, v164, v165
  v_cvt_pk_bf16_f32 v179, v166, v167
  ds_write_b64 v1, v[176:177] offset:2048
  ds_write_b64 v1, v[178:179] offset:2560
  v_pk_mul_f32 v[168:169], v[140:141], v[56:57] op_sel_hi:[0,1]
  v_pk_mul_f32 v[172:173], v[140:141], v[72:73] op_sel_hi:[0,1] neg_lo:[1,0] neg_hi:[1,0]
  v_pk_mul_f32 v[170:171], v[140:141], v[58:59] op_sel_hi:[0,1]
  v_pk_mul_f32 v[174:175], v[140:141], v[74:75] op_sel_hi:[0,1] neg_lo:[1,0] neg_hi:[1,0]
  v_pk_fma_f32 v[168:169], v[140:141], v[72:73], v[168:169] op_sel:[1,0,0] neg_lo:[1,0,0] neg_hi:[1,0,0]
  v_pk_fma_f32 v[172:173], v[140:141], v[56:57], v[172:173] op_sel:[1,0,0] neg_lo:[1,0,0] neg_hi:[1,0,0]
  v_pk_fma_f32 v[170:171], v[140:141], v[74:75], v[170:171] op_sel:[1,0,0] neg_lo:[1,0,0] neg_hi:[1,0,0]
  v_pk_fma_f32 v[174:175], v[140:141], v[58:59], v[174:175] op_sel:[1,0,0] neg_lo:[1,0,0] neg_hi:[1,0,0]
  v_cvt_pk_bf16_f32 v180, v168, v169
  v_cvt_pk_bf16_f32 v181, v170, v171
  v_cvt_pk_bf16_f32 v182, v172, v173
  v_cvt_pk_bf16_f32 v183, v174, v175
  ds_write_b64 v1, v[180:181] offset:3072
  ds_write_b64 v1, v[182:183] offset:3584
  ds_read_b64_tr_b16 v[184:185], v7 offset:0
  ds_read_b64_tr_b16 v[186:187], v7 offset:512
  ds_read_b64_tr_b16 v[188:189], v7 offset:1024
  ds_read_b64_tr_b16 v[190:191], v7 offset:1536
  ds_read_b64_tr_b16 v[192:193], v7 offset:2048
  ds_read_b64_tr_b16 v[194:195], v7 offset:2560
  ds_read_b64_tr_b16 v[196:197], v7 offset:3072
  ds_read_b64_tr_b16 v[198:199], v7 offset:3584
  s_waitcnt lgkmcnt(6)
  s_add_u32 s60, s68, 1024
  buffer_store_dwordx4 v[184:187], v10, s[40:43], s60 offen sc1
  s_waitcnt lgkmcnt(4)
  s_add_u32 s60, s68, 91136
  buffer_store_dwordx4 v[188:191], v10, s[40:43], s60 offen sc1
  s_waitcnt lgkmcnt(2)
  s_add_u32 s60, s68, 181248
  buffer_store_dwordx4 v[192:195], v10, s[40:43], s60 offen sc1
  s_waitcnt lgkmcnt(0)
  s_add_u32 s60, s68, 271360
  buffer_store_dwordx4 v[196:199], v10, s[40:43], s60 offen sc1
  s_lshl_b32 s60, s28, 2
  s_add_u32 s60, s60, 122944
  v_mov_b32 v9, s60
  v_mov_b32 v7, 1
  ds_write_b32 v9, v7
K2_compute:
  s_load_dwordx2 s[4:5], s[0:1], 0
  s_load_dwordx2 s[6:7], s[0:1], 64
  s_load_dwordx2 s[8:9], s[0:1], 104
  s_load_dwordx2 s[12:13], s[0:1], 112
  s_load_dwordx2 s[10:11], s[0:1], 128
  s_and_b32 s60, s2, 7
  s_lshr_b32 s61, s2, 3
  s_and_b32 s62, s60, 1
  s_lshl_b32 s62, s62, 2
  s_and_b32 s63, s61, 3
  s_add_u32 s64, s62, s63

  s_lshr_b32 s62, s61, 3
  s_lshl_b32 s62, s62, 2
  s_lshr_b32 s63, s60, 1
  s_add_u32 s62, s62, s63
  s_lshl_b32 s62, s62, 1
  s_bfe_u32 s63, s61, 0x10002
  s_add_u32 s65, s62, s63
  s_and_b32 s61, s28, 3
  s_waitcnt lgkmcnt(0)
  s_mov_b32 s16, s4
  s_and_b32 s17, s5, 0xffff
  s_mov_b32 s18, 2621440
  s_mov_b32 s19, 0x20000
  s_mov_b32 s20, s6
  s_and_b32 s21, s7, 0xffff
  s_mov_b32 s22, 1280
  s_mov_b32 s23, 0x20000
  s_mov_b32 s56, s12
  s_and_b32 s57, s13, 0xffff
  s_mov_b32 s58, 5242880
  s_mov_b32 s59, 0x20000
  s_add_u32 s32, s10, 1048576
  s_addc_u32 s33, s11, 0
  s_and_b32 s33, s33, 0xffff
  s_mov_b32 s34, 11534336
  s_mov_b32 s35, 0x20000
  s_add_u32 s52, s10, 12582912
  s_addc_u32 s53, s11, 0
  s_and_b32 s53, s53, 0xffff
  s_mov_b32 s54, 3604480
  s_mov_b32 s55, 0x20000
  s_mov_b32 s36, s10
  s_and_b32 s37, s11, 0xffff
  s_mov_b32 s38, 1048576
  s_mov_b32 s39, 0x20000
  v_lshlrev_b32 v3, 4, v0
  s_add_u32 s62, s61, 48
  s_mul_i32 s63, s64, 450560
  s_mul_i32 s60, s62, 5120
  s_add_u32 s63, s63, s60
  v_add_u32 v1, s63, v3
  s_mul_i32 s63, s65, 360448
  s_lshl_b32 s60, s62, 10
  s_add_u32 s63, s63, s60
  v_add_u32 v2, s63, v3
  s_add_u32 s66, s61, 0
  s_and_b32 s66, s66, 3
  s_mul_i32 s66, s66, 90112
  s_add_u32 s67, s61, 1
  s_and_b32 s67, s67, 3
  s_mul_i32 s67, s67, 90112
  s_add_u32 s68, s61, 2
  s_and_b32 s68, s68, 3
  s_mul_i32 s68, s68, 90112
  s_add_u32 s69, s61, 3
  s_and_b32 s69, s69, 3
  s_mul_i32 s69, s69, 90112
  v_mov_b32 v254, 122920
K2s_w:
  ds_read_b32 v255, v254 offset:0
  s_waitcnt lgkmcnt(0)
  v_readfirstlane_b32 s60, v255
  s_cmp_eq_u32 s60, 0
  s_cbranch_scc1 K2s_w
  s_mov_b32 s70, 0
  s_mov_b32 s71, 4096
  buffer_load_dwordx4 v[88:91], v1, s[52:55], s70 offen offset:0
  buffer_load_dwordx4 v[92:95], v1, s[52:55], s70 offen offset:1024
  buffer_load_dwordx4 v[96:99], v1, s[52:55], s70 offen offset:2048
  buffer_load_dwordx4 v[100:103], v1, s[52:55], s70 offen offset:3072
  buffer_load_dwordx4 v[104:107], v1, s[52:55], s71 offen
  s_mov_b32 s70, 20480
  s_mov_b32 s71, 24576
  buffer_load_dwordx4 v[124:127], v1, s[52:55], s70 offen offset:0
  buffer_load_dwordx4 v[128:131], v1, s[52:55], s70 offen offset:1024
  buffer_load_dwordx4 v[132:135], v1, s[52:55], s70 offen offset:2048
  buffer_load_dwordx4 v[136:139], v1, s[52:55], s70 offen offset:3072
  buffer_load_dwordx4 v[140:143], v1, s[52:55], s71 offen
  s_mov_b32 s70, 40960
  s_mov_b32 s71, 45056
  buffer_load_dwordx4 v[160:163], v1, s[52:55], s70 offen offset:0
  buffer_load_dwordx4 v[164:167], v1, s[52:55], s70 offen offset:1024
  buffer_load_dwordx4 v[168:171], v1, s[52:55], s70 offen offset:2048
  buffer_load_dwordx4 v[172:175], v1, s[52:55], s70 offen offset:3072
  buffer_load_dwordx4 v[176:179], v1, s[52:55], s71 offen
  s_mov_b32 s70, 61440
  s_mov_b32 s71, 65536
  buffer_load_dwordx4 v[196:199], v1, s[52:55], s70 offen offset:0
  buffer_load_dwordx4 v[200:203], v1, s[52:55], s70 offen offset:1024
  buffer_load_dwordx4 v[204:207], v1, s[52:55], s70 offen offset:2048
  buffer_load_dwordx4 v[208:211], v1, s[52:55], s70 offen offset:3072
  buffer_load_dwordx4 v[212:215], v1, s[52:55], s71 offen
  s_waitcnt vmcnt(20)
  s_add_u32 s60, s78, 532480
  v_mov_b32 v254, s60
  v_mov_b32 v255, s79
  s_mov_b64 exec, 1
  buffer_store_dword v255, v254, s[36:39], 0 offen sc1
  s_mov_b64 exec, -1
  v_mov_b32 v28, 0
  v_mov_b32 v29, 0
  v_mov_b32 v30, 0
  v_mov_b32 v31, 0
  v_mov_b32 v32, 0
  v_mov_b32 v33, 0
  v_mov_b32 v34, 0
  v_mov_b32 v35, 0
  v_mov_b32 v36, 0
  v_mov_b32 v37, 0
  v_mov_b32 v38, 0
  v_mov_b32 v39, 0
  v_mov_b32 v40, 0
  v_mov_b32 v41, 0
  v_mov_b32 v42, 0
  v_mov_b32 v43, 0
  v_mov_b32 v44, 0
  v_mov_b32 v45, 0
  v_mov_b32 v46, 0
  v_mov_b32 v47, 0
  v_mov_b32 v48, 0
  v_mov_b32 v49, 0
  v_mov_b32 v50, 0
  v_mov_b32 v51, 0
  v_mov_b32 v52, 0
  v_mov_b32 v53, 0
  v_mov_b32 v54, 0
  v_mov_b32 v55, 0
  v_mov_b32 v56, 0
  v_mov_b32 v57, 0
  v_mov_b32 v58, 0
  v_mov_b32 v59, 0
  v_mov_b32 v60, 0
  v_mov_b32 v61, 0
  v_mov_b32 v62, 0
  v_mov_b32 v63, 0
  v_mov_b32 v64, 0
  v_mov_b32 v65, 0
  v_mov_b32 v66, 0
  v_mov_b32 v67, 0
  v_mov_b32 v68, 0
  v_mov_b32 v69, 0
  v_mov_b32 v70, 0
  v_mov_b32 v71, 0
  v_mov_b32 v72, 0
  v_mov_b32 v73, 0
  v_mov_b32 v74, 0
  v_mov_b32 v75, 0
  v_mov_b32 v76, 0
  v_mov_b32 v77, 0
  v_mov_b32 v78, 0
  v_mov_b32 v79, 0
  v_mov_b32 v80, 0
  v_mov_b32 v81, 0
  v_mov_b32 v82, 0
  v_mov_b32 v83, 0
  v_mov_b32 v84, 0
  v_mov_b32 v85, 0
  v_mov_b32 v86, 0
  v_mov_b32 v87, 0
  v_and_b32 v5, 15, v0
  v_lshrrev_b32 v6, 4, v0
  v_lshrrev_b32 v7, 2, v5
  v_lshlrev_b32 v7, 4, v7
  v_and_b32 v254, 1, v5
  v_lshl_add_u32 v7, v254, 3, v7
  v_bfe_u32 v254, v5, 1, 1
  v_add_u32 v7, v7, v254
  s_lshl_b32 s62, s65, 6
  s_lshl_b32 s63, s61, 1
  s_add_u32 s62, s62, s63
  v_add_u32 v7, s62, v7
  s_mul_i32 s63, s64, 80
  v_lshl_add_u32 v5, v6, 2, s63
  v_lshlrev_b32 v4, 4, v7
  v_add_u32 v4, 4096, v4
  v_mul_u32_u24 v7, 640, v7
  v_add_u32 v7, v7, v5
  v_lshlrev_b32 v6, 1, v7
  v_lshlrev_b32 v7, 2, v7
  v_lshlrev_b32 v5, 1, v5
  v_mov_b32 v254, 122916
K2s_hf:
  ds_read_b32 v255, v254 offset:0
  s_waitcnt lgkmcnt(0)
  v_readfirstlane_b32 s60, v255
  s_cmp_eq_u32 s60, 0
  s_cbranch_scc1 K2s_hf
  buffer_load_dword v252, v4, s[36:39], 0 offen sc1
  buffer_load_dword v253, v4, s[36:39], 0 offen offset:8 sc1
  buffer_load_dwordx2 v[232:233], v6, s[16:19], 0 offen offset:0
  buffer_load_dwordx2 v[242:243], v5, s[20:23], 0 offen offset:0
  buffer_load_dwordx2 v[234:235], v6, s[16:19], 0 offen offset:32
  buffer_load_dwordx2 v[244:245], v5, s[20:23], 0 offen offset:32
  buffer_load_dwordx2 v[236:237], v6, s[16:19], 0 offen offset:64
  buffer_load_dwordx2 v[246:247], v5, s[20:23], 0 offen offset:64
  buffer_load_dwordx2 v[238:239], v6, s[16:19], 0 offen offset:96
  buffer_load_dwordx2 v[248:249], v5, s[20:23], 0 offen offset:96
  buffer_load_dwordx2 v[240:241], v6, s[16:19], 0 offen offset:128
  buffer_load_dwordx2 v[250:251], v5, s[20:23], 0 offen offset:128
  s_cmp_eq_u32 s61, 0
  s_cbranch_scc0 K2s_nopoll
  v_and_b32 v8, 31, v0
  v_lshlrev_b32 v8, 2, v8
  s_lshl_b32 s62, s65, 7
  s_add_u32 s62, s62, 532480
  v_add_u32 v8, s62, v8
  s_mov_b32 s73, 65536
K2s_poll:
  buffer_load_dword v9, v8, s[36:39], 0 offen sc1
  s_waitcnt vmcnt(0)
  v_cmp_ne_u32 vcc, s79, v9
  s_cmp_eq_u64 vcc, 0
  s_cbranch_scc1 K2s_pok
  s_sub_u32 s73, s73, 1
  s_cmp_lg_u32 s73, 0
  s_cbranch_scc1 K2s_poll
K2s_pok:
  v_mov_b32 v254, 122924
  v_mov_b32 v255, 1
  ds_write_b32 v254, v255
  s_branch K2s_go
K2s_nopoll:
  v_mov_b32 v254, 122924
K2s_hs:
  ds_read_b32 v255, v254 offset:0
  s_waitcnt lgkmcnt(0)
  v_readfirstlane_b32 s60, v255
  s_cmp_eq_u32 s60, 0
  s_cbranch_scc1 K2s_hs
K2s_go:
  buffer_load_dwordx4 v[108:111], v2, s[32:35], s66 offen
  s_add_u32 s66, s66, 4096
  buffer_load_dwordx4 v[112:115], v2, s[32:35], s67 offen
  s_add_u32 s67, s67, 4096
  buffer_load_dwordx4 v[116:119], v2, s[32:35], s68 offen
  s_add_u32 s68, s68, 4096
  buffer_load_dwordx4 v[120:123], v2, s[32:35], s69 offen
  s_add_u32 s69, s69, 4096
  buffer_load_dwordx4 v[144:147], v2, s[32:35], s66 offen
  s_add_u32 s66, s66, 4096
  buffer_load_dwordx4 v[148:151], v2, s[32:35], s67 offen
  s_add_u32 s67, s67, 4096
  buffer_load_dwordx4 v[152:155], v2, s[32:35], s68 offen
  s_add_u32 s68, s68, 4096
  buffer_load_dwordx4 v[156:159], v2, s[32:35], s69 offen
  s_add_u32 s69, s69, 4096
  buffer_load_dwordx4 v[180:183], v2, s[32:35], s66 offen
  s_add_u32 s66, s66, 4096
  buffer_load_dwordx4 v[184:187], v2, s[32:35], s67 offen
  s_add_u32 s67, s67, 4096
  buffer_load_dwordx4 v[188:191], v2, s[32:35], s68 offen
  s_add_u32 s68, s68, 4096
  buffer_load_dwordx4 v[192:195], v2, s[32:35], s69 offen
  s_add_u32 s69, s69, 4096
  buffer_load_dwordx4 v[216:219], v2, s[32:35], s66 offen
  s_add_u32 s66, s66, 4096
  buffer_load_dwordx4 v[220:223], v2, s[32:35], s67 offen
  s_add_u32 s67, s67, 4096
  buffer_load_dwordx4 v[224:227], v2, s[32:35], s68 offen
  s_add_u32 s68, s68, 4096
  buffer_load_dwordx4 v[228:231], v2, s[32:35], s69 offen
  s_add_u32 s69, s69, 4096
  s_waitcnt vmcnt(16)
  v_lshlrev_b32 v4, 16, v232
  v_and_b32 v5, 0xffff0000, v232
  v_lshlrev_b32 v6, 16, v242
  v_and_b32 v7, 0xffff0000, v242
  v_pk_add_f32 v[4:5], v[4:5], v[252:253] op_sel_hi:[1,0] neg_lo:[0,1] neg_hi:[0,1]
  v_cvt_pk_bf16_f32 v254, v4, v5
  v_lshlrev_b32 v4, 16, v254
  v_and_b32 v5, 0xffff0000, v254
  v_pk_mul_f32 v[4:5], v[4:5], v[252:253] op_sel:[0,1]
  v_cvt_pk_bf16_f32 v254, v4, v5
  v_lshlrev_b32 v4, 16, v254
  v_and_b32 v5, 0xffff0000, v254
  v_pk_mul_f32 v[4:5], v[4:5], v[6:7]
  v_cvt_pk_bf16_f32 v254, v4, v5
  v_lshlrev_b32 v8, 16, v254
  v_and_b32 v9, 0xffff0000, v254
  v_lshlrev_b32 v4, 16, v233
  v_and_b32 v5, 0xffff0000, v233
  v_lshlrev_b32 v6, 16, v243
  v_and_b32 v7, 0xffff0000, v243
  v_pk_add_f32 v[4:5], v[4:5], v[252:253] op_sel_hi:[1,0] neg_lo:[0,1] neg_hi:[0,1]
  v_cvt_pk_bf16_f32 v254, v4, v5
  v_lshlrev_b32 v4, 16, v254
  v_and_b32 v5, 0xffff0000, v254
  v_pk_mul_f32 v[4:5], v[4:5], v[252:253] op_sel:[0,1]
  v_cvt_pk_bf16_f32 v254, v4, v5
  v_lshlrev_b32 v4, 16, v254
  v_and_b32 v5, 0xffff0000, v254
  v_pk_mul_f32 v[4:5], v[4:5], v[6:7]
  v_cvt_pk_bf16_f32 v254, v4, v5
  v_lshlrev_b32 v10, 16, v254
  v_and_b32 v11, 0xffff0000, v254
  v_lshlrev_b32 v4, 16, v234
  v_and_b32 v5, 0xffff0000, v234
  v_lshlrev_b32 v6, 16, v244
  v_and_b32 v7, 0xffff0000, v244
  v_pk_add_f32 v[4:5], v[4:5], v[252:253] op_sel_hi:[1,0] neg_lo:[0,1] neg_hi:[0,1]
  v_cvt_pk_bf16_f32 v254, v4, v5
  v_lshlrev_b32 v4, 16, v254
  v_and_b32 v5, 0xffff0000, v254
  v_pk_mul_f32 v[4:5], v[4:5], v[252:253] op_sel:[0,1]
  v_cvt_pk_bf16_f32 v254, v4, v5
  v_lshlrev_b32 v4, 16, v254
  v_and_b32 v5, 0xffff0000, v254
  v_pk_mul_f32 v[4:5], v[4:5], v[6:7]
  v_cvt_pk_bf16_f32 v254, v4, v5
  v_lshlrev_b32 v12, 16, v254
  v_and_b32 v13, 0xffff0000, v254
  v_lshlrev_b32 v4, 16, v235
  v_and_b32 v5, 0xffff0000, v235
  v_lshlrev_b32 v6, 16, v245
  v_and_b32 v7, 0xffff0000, v245
  v_pk_add_f32 v[4:5], v[4:5], v[252:253] op_sel_hi:[1,0] neg_lo:[0,1] neg_hi:[0,1]
  v_cvt_pk_bf16_f32 v254, v4, v5
  v_lshlrev_b32 v4, 16, v254
  v_and_b32 v5, 0xffff0000, v254
  v_pk_mul_f32 v[4:5], v[4:5], v[252:253] op_sel:[0,1]
  v_cvt_pk_bf16_f32 v254, v4, v5
  v_lshlrev_b32 v4, 16, v254
  v_and_b32 v5, 0xffff0000, v254
  v_pk_mul_f32 v[4:5], v[4:5], v[6:7]
  v_cvt_pk_bf16_f32 v254, v4, v5
  v_lshlrev_b32 v14, 16, v254
  v_and_b32 v15, 0xffff0000, v254
  v_lshlrev_b32 v4, 16, v236
  v_and_b32 v5, 0xffff0000, v236
  v_lshlrev_b32 v6, 16, v246
  v_and_b32 v7, 0xffff0000, v246
  v_pk_add_f32 v[4:5], v[4:5], v[252:253] op_sel_hi:[1,0] neg_lo:[0,1] neg_hi:[0,1]
  v_cvt_pk_bf16_f32 v254, v4, v5
  v_lshlrev_b32 v4, 16, v254
  v_and_b32 v5, 0xffff0000, v254
  v_pk_mul_f32 v[4:5], v[4:5], v[252:253] op_sel:[0,1]
  v_cvt_pk_bf16_f32 v254, v4, v5
  v_lshlrev_b32 v4, 16, v254
  v_and_b32 v5, 0xffff0000, v254
  v_pk_mul_f32 v[4:5], v[4:5], v[6:7]
  v_cvt_pk_bf16_f32 v254, v4, v5
  v_lshlrev_b32 v16, 16, v254
  v_and_b32 v17, 0xffff0000, v254
  v_lshlrev_b32 v4, 16, v237
  v_and_b32 v5, 0xffff0000, v237
  v_lshlrev_b32 v6, 16, v247
  v_and_b32 v7, 0xffff0000, v247
  v_pk_add_f32 v[4:5], v[4:5], v[252:253] op_sel_hi:[1,0] neg_lo:[0,1] neg_hi:[0,1]
  v_cvt_pk_bf16_f32 v254, v4, v5
  v_lshlrev_b32 v4, 16, v254
  v_and_b32 v5, 0xffff0000, v254
  v_pk_mul_f32 v[4:5], v[4:5], v[252:253] op_sel:[0,1]
  v_cvt_pk_bf16_f32 v254, v4, v5
  v_lshlrev_b32 v4, 16, v254
  v_and_b32 v5, 0xffff0000, v254
  v_pk_mul_f32 v[4:5], v[4:5], v[6:7]
  v_cvt_pk_bf16_f32 v254, v4, v5
  v_lshlrev_b32 v18, 16, v254
  v_and_b32 v19, 0xffff0000, v254
  v_lshlrev_b32 v4, 16, v238
  v_and_b32 v5, 0xffff0000, v238
  v_lshlrev_b32 v6, 16, v248
  v_and_b32 v7, 0xffff0000, v248
  v_pk_add_f32 v[4:5], v[4:5], v[252:253] op_sel_hi:[1,0] neg_lo:[0,1] neg_hi:[0,1]
  v_cvt_pk_bf16_f32 v254, v4, v5
  v_lshlrev_b32 v4, 16, v254
  v_and_b32 v5, 0xffff0000, v254
  v_pk_mul_f32 v[4:5], v[4:5], v[252:253] op_sel:[0,1]
  v_cvt_pk_bf16_f32 v254, v4, v5
  v_lshlrev_b32 v4, 16, v254
  v_and_b32 v5, 0xffff0000, v254
  v_pk_mul_f32 v[4:5], v[4:5], v[6:7]
  v_cvt_pk_bf16_f32 v254, v4, v5
  v_lshlrev_b32 v20, 16, v254
  v_and_b32 v21, 0xffff0000, v254
  v_lshlrev_b32 v4, 16, v239
  v_and_b32 v5, 0xffff0000, v239
  v_lshlrev_b32 v6, 16, v249
  v_and_b32 v7, 0xffff0000, v249
  v_pk_add_f32 v[4:5], v[4:5], v[252:253] op_sel_hi:[1,0] neg_lo:[0,1] neg_hi:[0,1]
  v_cvt_pk_bf16_f32 v254, v4, v5
  v_lshlrev_b32 v4, 16, v254
  v_and_b32 v5, 0xffff0000, v254
  v_pk_mul_f32 v[4:5], v[4:5], v[252:253] op_sel:[0,1]
  v_cvt_pk_bf16_f32 v254, v4, v5
  v_lshlrev_b32 v4, 16, v254
  v_and_b32 v5, 0xffff0000, v254
  v_pk_mul_f32 v[4:5], v[4:5], v[6:7]
  v_cvt_pk_bf16_f32 v254, v4, v5
  v_lshlrev_b32 v22, 16, v254
  v_and_b32 v23, 0xffff0000, v254
  v_lshlrev_b32 v4, 16, v240
  v_and_b32 v5, 0xffff0000, v240
  v_lshlrev_b32 v6, 16, v250
  v_and_b32 v7, 0xffff0000, v250
  v_pk_add_f32 v[4:5], v[4:5], v[252:253] op_sel_hi:[1,0] neg_lo:[0,1] neg_hi:[0,1]
  v_cvt_pk_bf16_f32 v254, v4, v5
  v_lshlrev_b32 v4, 16, v254
  v_and_b32 v5, 0xffff0000, v254
  v_pk_mul_f32 v[4:5], v[4:5], v[252:253] op_sel:[0,1]
  v_cvt_pk_bf16_f32 v254, v4, v5
  v_lshlrev_b32 v4, 16, v254
  v_and_b32 v5, 0xffff0000, v254
  v_pk_mul_f32 v[4:5], v[4:5], v[6:7]
  v_cvt_pk_bf16_f32 v254, v4, v5
  v_lshlrev_b32 v24, 16, v254
  v_and_b32 v25, 0xffff0000, v254
  v_lshlrev_b32 v4, 16, v241
  v_and_b32 v5, 0xffff0000, v241
  v_lshlrev_b32 v6, 16, v251
  v_and_b32 v7, 0xffff0000, v251
  v_pk_add_f32 v[4:5], v[4:5], v[252:253] op_sel_hi:[1,0] neg_lo:[0,1] neg_hi:[0,1]
  v_cvt_pk_bf16_f32 v254, v4, v5
  v_lshlrev_b32 v4, 16, v254
  v_and_b32 v5, 0xffff0000, v254
  v_pk_mul_f32 v[4:5], v[4:5], v[252:253] op_sel:[0,1]
  v_cvt_pk_bf16_f32 v254, v4, v5
  v_lshlrev_b32 v4, 16, v254
  v_and_b32 v5, 0xffff0000, v254
  v_pk_mul_f32 v[4:5], v[4:5], v[6:7]
  v_cvt_pk_bf16_f32 v254, v4, v5
  v_lshlrev_b32 v26, 16, v254
  v_and_b32 v27, 0xffff0000, v254
  s_waitcnt vmcnt(12)
  v_mfma_f32_16x16x32_bf16 v[8:11], v[88:91], v[108:111], v[8:11]
  v_mfma_f32_16x16x32_bf16 v[12:15], v[92:95], v[108:111], v[12:15]
  v_mfma_f32_16x16x32_bf16 v[16:19], v[96:99], v[108:111], v[16:19]
  v_mfma_f32_16x16x32_bf16 v[20:23], v[100:103], v[108:111], v[20:23]
  v_mfma_f32_16x16x32_bf16 v[24:27], v[104:107], v[108:111], v[24:27]
  buffer_load_dwordx4 v[108:111], v2, s[32:35], s66 offen
  s_add_u32 s66, s66, 4096
  v_mfma_f32_16x16x32_bf16 v[28:31], v[88:91], v[112:115], v[28:31]
  v_mfma_f32_16x16x32_bf16 v[32:35], v[92:95], v[112:115], v[32:35]
  v_mfma_f32_16x16x32_bf16 v[36:39], v[96:99], v[112:115], v[36:39]
  v_mfma_f32_16x16x32_bf16 v[40:43], v[100:103], v[112:115], v[40:43]
  v_mfma_f32_16x16x32_bf16 v[44:47], v[104:107], v[112:115], v[44:47]
  buffer_load_dwordx4 v[112:115], v2, s[32:35], s67 offen
  s_add_u32 s67, s67, 4096
  v_mfma_f32_16x16x32_bf16 v[48:51], v[88:91], v[116:119], v[48:51]
  v_mfma_f32_16x16x32_bf16 v[52:55], v[92:95], v[116:119], v[52:55]
  v_mfma_f32_16x16x32_bf16 v[56:59], v[96:99], v[116:119], v[56:59]
  v_mfma_f32_16x16x32_bf16 v[60:63], v[100:103], v[116:119], v[60:63]
  v_mfma_f32_16x16x32_bf16 v[64:67], v[104:107], v[116:119], v[64:67]
  buffer_load_dwordx4 v[116:119], v2, s[32:35], s68 offen
  s_add_u32 s68, s68, 4096
  v_mfma_f32_16x16x32_bf16 v[68:71], v[88:91], v[120:123], v[68:71]
  s_mov_b32 s70, 81920
  s_mov_b32 s71, 86016
  buffer_load_dwordx4 v[88:91], v1, s[52:55], s70 offen offset:0
  v_mfma_f32_16x16x32_bf16 v[72:75], v[92:95], v[120:123], v[72:75]
  buffer_load_dwordx4 v[92:95], v1, s[52:55], s70 offen offset:1024
  v_mfma_f32_16x16x32_bf16 v[76:79], v[96:99], v[120:123], v[76:79]
  buffer_load_dwordx4 v[96:99], v1, s[52:55], s70 offen offset:2048
  v_mfma_f32_16x16x32_bf16 v[80:83], v[100:103], v[120:123], v[80:83]
  buffer_load_dwordx4 v[100:103], v1, s[52:55], s70 offen offset:3072
  v_mfma_f32_16x16x32_bf16 v[84:87], v[104:107], v[120:123], v[84:87]
  buffer_load_dwordx4 v[104:107], v1, s[52:55], s71 offen
  buffer_load_dwordx4 v[120:123], v2, s[32:35], s69 offen
  s_add_u32 s69, s69, 4096
  s_waitcnt vmcnt(17)
  v_mfma_f32_16x16x32_bf16 v[8:11], v[124:127], v[144:147], v[8:11]
  v_mfma_f32_16x16x32_bf16 v[12:15], v[128:131], v[144:147], v[12:15]
  v_mfma_f32_16x16x32_bf16 v[16:19], v[132:135], v[144:147], v[16:19]
  v_mfma_f32_16x16x32_bf16 v[20:23], v[136:139], v[144:147], v[20:23]
  v_mfma_f32_16x16x32_bf16 v[24:27], v[140:143], v[144:147], v[24:27]
  buffer_load_dwordx4 v[144:147], v2, s[32:35], s66 offen
  s_add_u32 s66, s66, 4096
  v_mfma_f32_16x16x32_bf16 v[28:31], v[124:127], v[148:151], v[28:31]
  v_mfma_f32_16x16x32_bf16 v[32:35], v[128:131], v[148:151], v[32:35]
  v_mfma_f32_16x16x32_bf16 v[36:39], v[132:135], v[148:151], v[36:39]
  v_mfma_f32_16x16x32_bf16 v[40:43], v[136:139], v[148:151], v[40:43]
  v_mfma_f32_16x16x32_bf16 v[44:47], v[140:143], v[148:151], v[44:47]
  buffer_load_dwordx4 v[148:151], v2, s[32:35], s67 offen
  s_add_u32 s67, s67, 4096
  v_mfma_f32_16x16x32_bf16 v[48:51], v[124:127], v[152:155], v[48:51]
  v_mfma_f32_16x16x32_bf16 v[52:55], v[128:131], v[152:155], v[52:55]
  v_mfma_f32_16x16x32_bf16 v[56:59], v[132:135], v[152:155], v[56:59]
  v_mfma_f32_16x16x32_bf16 v[60:63], v[136:139], v[152:155], v[60:63]
  v_mfma_f32_16x16x32_bf16 v[64:67], v[140:143], v[152:155], v[64:67]
  buffer_load_dwordx4 v[152:155], v2, s[32:35], s68 offen
  s_add_u32 s68, s68, 4096
  v_mfma_f32_16x16x32_bf16 v[68:71], v[124:127], v[156:159], v[68:71]
  s_mov_b32 s70, 102400
  s_mov_b32 s71, 106496
  buffer_load_dwordx4 v[124:127], v1, s[52:55], s70 offen offset:0
  v_mfma_f32_16x16x32_bf16 v[72:75], v[128:131], v[156:159], v[72:75]
  buffer_load_dwordx4 v[128:131], v1, s[52:55], s70 offen offset:1024
  v_mfma_f32_16x16x32_bf16 v[76:79], v[132:135], v[156:159], v[76:79]
  buffer_load_dwordx4 v[132:135], v1, s[52:55], s70 offen offset:2048
  v_mfma_f32_16x16x32_bf16 v[80:83], v[136:139], v[156:159], v[80:83]
  buffer_load_dwordx4 v[136:139], v1, s[52:55], s70 offen offset:3072
  v_mfma_f32_16x16x32_bf16 v[84:87], v[140:143], v[156:159], v[84:87]
  buffer_load_dwordx4 v[140:143], v1, s[52:55], s71 offen
  buffer_load_dwordx4 v[156:159], v2, s[32:35], s69 offen
  s_add_u32 s69, s69, 4096
  s_waitcnt vmcnt(22)
  v_mfma_f32_16x16x32_bf16 v[8:11], v[160:163], v[180:183], v[8:11]
  v_mfma_f32_16x16x32_bf16 v[12:15], v[164:167], v[180:183], v[12:15]
  v_mfma_f32_16x16x32_bf16 v[16:19], v[168:171], v[180:183], v[16:19]
  v_mfma_f32_16x16x32_bf16 v[20:23], v[172:175], v[180:183], v[20:23]
  v_mfma_f32_16x16x32_bf16 v[24:27], v[176:179], v[180:183], v[24:27]
  buffer_load_dwordx4 v[180:183], v2, s[32:35], s66 offen
  s_add_u32 s66, s66, 4096
  v_mfma_f32_16x16x32_bf16 v[28:31], v[160:163], v[184:187], v[28:31]
  v_mfma_f32_16x16x32_bf16 v[32:35], v[164:167], v[184:187], v[32:35]
  v_mfma_f32_16x16x32_bf16 v[36:39], v[168:171], v[184:187], v[36:39]
  v_mfma_f32_16x16x32_bf16 v[40:43], v[172:175], v[184:187], v[40:43]
  v_mfma_f32_16x16x32_bf16 v[44:47], v[176:179], v[184:187], v[44:47]
  buffer_load_dwordx4 v[184:187], v2, s[32:35], s67 offen
  s_add_u32 s67, s67, 4096
  v_mfma_f32_16x16x32_bf16 v[48:51], v[160:163], v[188:191], v[48:51]
  v_mfma_f32_16x16x32_bf16 v[52:55], v[164:167], v[188:191], v[52:55]
  v_mfma_f32_16x16x32_bf16 v[56:59], v[168:171], v[188:191], v[56:59]
  v_mfma_f32_16x16x32_bf16 v[60:63], v[172:175], v[188:191], v[60:63]
  v_mfma_f32_16x16x32_bf16 v[64:67], v[176:179], v[188:191], v[64:67]
  buffer_load_dwordx4 v[188:191], v2, s[32:35], s68 offen
  s_add_u32 s68, s68, 4096
  v_mfma_f32_16x16x32_bf16 v[68:71], v[160:163], v[192:195], v[68:71]
  s_mov_b32 s70, 122880
  s_mov_b32 s71, 126976
  buffer_load_dwordx4 v[160:163], v1, s[52:55], s70 offen offset:0
  v_mfma_f32_16x16x32_bf16 v[72:75], v[164:167], v[192:195], v[72:75]
  buffer_load_dwordx4 v[164:167], v1, s[52:55], s70 offen offset:1024
  v_mfma_f32_16x16x32_bf16 v[76:79], v[168:171], v[192:195], v[76:79]
  buffer_load_dwordx4 v[168:171], v1, s[52:55], s70 offen offset:2048
  v_mfma_f32_16x16x32_bf16 v[80:83], v[172:175], v[192:195], v[80:83]
  buffer_load_dwordx4 v[172:175], v1, s[52:55], s70 offen offset:3072
  v_mfma_f32_16x16x32_bf16 v[84:87], v[176:179], v[192:195], v[84:87]
  buffer_load_dwordx4 v[176:179], v1, s[52:55], s71 offen
  buffer_load_dwordx4 v[192:195], v2, s[32:35], s69 offen
  s_add_u32 s69, s69, 4096
  s_waitcnt vmcnt(27)
  v_mfma_f32_16x16x32_bf16 v[8:11], v[196:199], v[216:219], v[8:11]
  v_mfma_f32_16x16x32_bf16 v[12:15], v[200:203], v[216:219], v[12:15]
  v_mfma_f32_16x16x32_bf16 v[16:19], v[204:207], v[216:219], v[16:19]
  v_mfma_f32_16x16x32_bf16 v[20:23], v[208:211], v[216:219], v[20:23]
  v_mfma_f32_16x16x32_bf16 v[24:27], v[212:215], v[216:219], v[24:27]
  buffer_load_dwordx4 v[216:219], v2, s[32:35], s66 offen
  s_add_u32 s66, s66, 4096
  v_mfma_f32_16x16x32_bf16 v[28:31], v[196:199], v[220:223], v[28:31]
  v_mfma_f32_16x16x32_bf16 v[32:35], v[200:203], v[220:223], v[32:35]
  v_mfma_f32_16x16x32_bf16 v[36:39], v[204:207], v[220:223], v[36:39]
  v_mfma_f32_16x16x32_bf16 v[40:43], v[208:211], v[220:223], v[40:43]
  v_mfma_f32_16x16x32_bf16 v[44:47], v[212:215], v[220:223], v[44:47]
  buffer_load_dwordx4 v[220:223], v2, s[32:35], s67 offen
  s_add_u32 s67, s67, 4096
  v_mfma_f32_16x16x32_bf16 v[48:51], v[196:199], v[224:227], v[48:51]
  v_mfma_f32_16x16x32_bf16 v[52:55], v[200:203], v[224:227], v[52:55]
  v_mfma_f32_16x16x32_bf16 v[56:59], v[204:207], v[224:227], v[56:59]
  v_mfma_f32_16x16x32_bf16 v[60:63], v[208:211], v[224:227], v[60:63]
  v_mfma_f32_16x16x32_bf16 v[64:67], v[212:215], v[224:227], v[64:67]
  buffer_load_dwordx4 v[224:227], v2, s[32:35], s68 offen
  s_add_u32 s68, s68, 4096
  v_mfma_f32_16x16x32_bf16 v[68:71], v[196:199], v[228:231], v[68:71]
  s_mov_b32 s70, 143360
  s_mov_b32 s71, 147456
  buffer_load_dwordx4 v[196:199], v1, s[52:55], s70 offen offset:0
  v_mfma_f32_16x16x32_bf16 v[72:75], v[200:203], v[228:231], v[72:75]
  buffer_load_dwordx4 v[200:203], v1, s[52:55], s70 offen offset:1024
  v_mfma_f32_16x16x32_bf16 v[76:79], v[204:207], v[228:231], v[76:79]
  buffer_load_dwordx4 v[204:207], v1, s[52:55], s70 offen offset:2048
  v_mfma_f32_16x16x32_bf16 v[80:83], v[208:211], v[228:231], v[80:83]
  buffer_load_dwordx4 v[208:211], v1, s[52:55], s70 offen offset:3072
  v_mfma_f32_16x16x32_bf16 v[84:87], v[212:215], v[228:231], v[84:87]
  buffer_load_dwordx4 v[212:215], v1, s[52:55], s71 offen
  buffer_load_dwordx4 v[228:231], v2, s[32:35], s69 offen
  s_add_u32 s69, s69, 4096
  s_waitcnt vmcnt(27)
  v_mfma_f32_16x16x32_bf16 v[8:11], v[88:91], v[108:111], v[8:11]
  v_mfma_f32_16x16x32_bf16 v[12:15], v[92:95], v[108:111], v[12:15]
  v_mfma_f32_16x16x32_bf16 v[16:19], v[96:99], v[108:111], v[16:19]
  v_mfma_f32_16x16x32_bf16 v[20:23], v[100:103], v[108:111], v[20:23]
  v_mfma_f32_16x16x32_bf16 v[24:27], v[104:107], v[108:111], v[24:27]
  buffer_load_dwordx4 v[108:111], v2, s[32:35], s66 offen
  s_add_u32 s66, s66, 4096
  v_mfma_f32_16x16x32_bf16 v[28:31], v[88:91], v[112:115], v[28:31]
  v_mfma_f32_16x16x32_bf16 v[32:35], v[92:95], v[112:115], v[32:35]
  v_mfma_f32_16x16x32_bf16 v[36:39], v[96:99], v[112:115], v[36:39]
  v_mfma_f32_16x16x32_bf16 v[40:43], v[100:103], v[112:115], v[40:43]
  v_mfma_f32_16x16x32_bf16 v[44:47], v[104:107], v[112:115], v[44:47]
  buffer_load_dwordx4 v[112:115], v2, s[32:35], s67 offen
  s_add_u32 s67, s67, 4096
  v_mfma_f32_16x16x32_bf16 v[48:51], v[88:91], v[116:119], v[48:51]
  v_mfma_f32_16x16x32_bf16 v[52:55], v[92:95], v[116:119], v[52:55]
  v_mfma_f32_16x16x32_bf16 v[56:59], v[96:99], v[116:119], v[56:59]
  v_mfma_f32_16x16x32_bf16 v[60:63], v[100:103], v[116:119], v[60:63]
  v_mfma_f32_16x16x32_bf16 v[64:67], v[104:107], v[116:119], v[64:67]
  buffer_load_dwordx4 v[116:119], v2, s[32:35], s68 offen
  s_add_u32 s68, s68, 4096
  v_mfma_f32_16x16x32_bf16 v[68:71], v[88:91], v[120:123], v[68:71]
  s_mov_b32 s70, 163840
  s_mov_b32 s71, 167936
  buffer_load_dwordx4 v[88:91], v1, s[52:55], s70 offen offset:0
  v_mfma_f32_16x16x32_bf16 v[72:75], v[92:95], v[120:123], v[72:75]
  buffer_load_dwordx4 v[92:95], v1, s[52:55], s70 offen offset:1024
  v_mfma_f32_16x16x32_bf16 v[76:79], v[96:99], v[120:123], v[76:79]
  buffer_load_dwordx4 v[96:99], v1, s[52:55], s70 offen offset:2048
  v_mfma_f32_16x16x32_bf16 v[80:83], v[100:103], v[120:123], v[80:83]
  buffer_load_dwordx4 v[100:103], v1, s[52:55], s70 offen offset:3072
  v_mfma_f32_16x16x32_bf16 v[84:87], v[104:107], v[120:123], v[84:87]
  buffer_load_dwordx4 v[104:107], v1, s[52:55], s71 offen
  buffer_load_dwordx4 v[120:123], v2, s[32:35], s69 offen
  s_add_u32 s69, s69, 4096
  s_waitcnt vmcnt(27)
  v_mfma_f32_16x16x32_bf16 v[8:11], v[124:127], v[144:147], v[8:11]
  v_mfma_f32_16x16x32_bf16 v[12:15], v[128:131], v[144:147], v[12:15]
  v_mfma_f32_16x16x32_bf16 v[16:19], v[132:135], v[144:147], v[16:19]
  v_mfma_f32_16x16x32_bf16 v[20:23], v[136:139], v[144:147], v[20:23]
  v_mfma_f32_16x16x32_bf16 v[24:27], v[140:143], v[144:147], v[24:27]
  buffer_load_dwordx4 v[144:147], v2, s[32:35], s66 offen
  s_add_u32 s66, s66, 4096
  v_mfma_f32_16x16x32_bf16 v[28:31], v[124:127], v[148:151], v[28:31]
  v_mfma_f32_16x16x32_bf16 v[32:35], v[128:131], v[148:151], v[32:35]
  v_mfma_f32_16x16x32_bf16 v[36:39], v[132:135], v[148:151], v[36:39]
  v_mfma_f32_16x16x32_bf16 v[40:43], v[136:139], v[148:151], v[40:43]
  v_mfma_f32_16x16x32_bf16 v[44:47], v[140:143], v[148:151], v[44:47]
  buffer_load_dwordx4 v[148:151], v2, s[32:35], s67 offen
  s_add_u32 s67, s67, 4096
  v_mfma_f32_16x16x32_bf16 v[48:51], v[124:127], v[152:155], v[48:51]
  v_mfma_f32_16x16x32_bf16 v[52:55], v[128:131], v[152:155], v[52:55]
  v_mfma_f32_16x16x32_bf16 v[56:59], v[132:135], v[152:155], v[56:59]
  v_mfma_f32_16x16x32_bf16 v[60:63], v[136:139], v[152:155], v[60:63]
  v_mfma_f32_16x16x32_bf16 v[64:67], v[140:143], v[152:155], v[64:67]
  buffer_load_dwordx4 v[152:155], v2, s[32:35], s68 offen
  s_add_u32 s68, s68, 4096
  v_mfma_f32_16x16x32_bf16 v[68:71], v[124:127], v[156:159], v[68:71]
  s_mov_b32 s70, 184320
  s_mov_b32 s71, 188416
  buffer_load_dwordx4 v[124:127], v1, s[52:55], s70 offen offset:0
  v_mfma_f32_16x16x32_bf16 v[72:75], v[128:131], v[156:159], v[72:75]
  buffer_load_dwordx4 v[128:131], v1, s[52:55], s70 offen offset:1024
  v_mfma_f32_16x16x32_bf16 v[76:79], v[132:135], v[156:159], v[76:79]
  buffer_load_dwordx4 v[132:135], v1, s[52:55], s70 offen offset:2048
  v_mfma_f32_16x16x32_bf16 v[80:83], v[136:139], v[156:159], v[80:83]
  buffer_load_dwordx4 v[136:139], v1, s[52:55], s70 offen offset:3072
  v_mfma_f32_16x16x32_bf16 v[84:87], v[140:143], v[156:159], v[84:87]
  buffer_load_dwordx4 v[140:143], v1, s[52:55], s71 offen
  buffer_load_dwordx4 v[156:159], v2, s[32:35], s69 offen
  s_add_u32 s69, s69, 4096
  s_waitcnt vmcnt(27)
  v_mfma_f32_16x16x32_bf16 v[8:11], v[160:163], v[180:183], v[8:11]
  v_mfma_f32_16x16x32_bf16 v[12:15], v[164:167], v[180:183], v[12:15]
  v_mfma_f32_16x16x32_bf16 v[16:19], v[168:171], v[180:183], v[16:19]
  v_mfma_f32_16x16x32_bf16 v[20:23], v[172:175], v[180:183], v[20:23]
  v_mfma_f32_16x16x32_bf16 v[24:27], v[176:179], v[180:183], v[24:27]
  v_mfma_f32_16x16x32_bf16 v[28:31], v[160:163], v[184:187], v[28:31]
  v_mfma_f32_16x16x32_bf16 v[32:35], v[164:167], v[184:187], v[32:35]
  v_mfma_f32_16x16x32_bf16 v[36:39], v[168:171], v[184:187], v[36:39]
  v_mfma_f32_16x16x32_bf16 v[40:43], v[172:175], v[184:187], v[40:43]
  v_mfma_f32_16x16x32_bf16 v[44:47], v[176:179], v[184:187], v[44:47]
  v_mfma_f32_16x16x32_bf16 v[48:51], v[160:163], v[188:191], v[48:51]
  v_mfma_f32_16x16x32_bf16 v[52:55], v[164:167], v[188:191], v[52:55]
  v_mfma_f32_16x16x32_bf16 v[56:59], v[168:171], v[188:191], v[56:59]
  v_mfma_f32_16x16x32_bf16 v[60:63], v[172:175], v[188:191], v[60:63]
  v_mfma_f32_16x16x32_bf16 v[64:67], v[176:179], v[188:191], v[64:67]
  v_mfma_f32_16x16x32_bf16 v[68:71], v[160:163], v[192:195], v[68:71]
  v_mfma_f32_16x16x32_bf16 v[72:75], v[164:167], v[192:195], v[72:75]
  v_mfma_f32_16x16x32_bf16 v[76:79], v[168:171], v[192:195], v[76:79]
  v_mfma_f32_16x16x32_bf16 v[80:83], v[172:175], v[192:195], v[80:83]
  v_mfma_f32_16x16x32_bf16 v[84:87], v[176:179], v[192:195], v[84:87]
  s_waitcnt vmcnt(18)
  v_mfma_f32_16x16x32_bf16 v[8:11], v[196:199], v[216:219], v[8:11]
  v_mfma_f32_16x16x32_bf16 v[12:15], v[200:203], v[216:219], v[12:15]
  v_mfma_f32_16x16x32_bf16 v[16:19], v[204:207], v[216:219], v[16:19]
  v_mfma_f32_16x16x32_bf16 v[20:23], v[208:211], v[216:219], v[20:23]
  v_mfma_f32_16x16x32_bf16 v[24:27], v[212:215], v[216:219], v[24:27]
  v_mfma_f32_16x16x32_bf16 v[28:31], v[196:199], v[220:223], v[28:31]
  v_mfma_f32_16x16x32_bf16 v[32:35], v[200:203], v[220:223], v[32:35]
  v_mfma_f32_16x16x32_bf16 v[36:39], v[204:207], v[220:223], v[36:39]
  v_mfma_f32_16x16x32_bf16 v[40:43], v[208:211], v[220:223], v[40:43]
  v_mfma_f32_16x16x32_bf16 v[44:47], v[212:215], v[220:223], v[44:47]
  v_mfma_f32_16x16x32_bf16 v[48:51], v[196:199], v[224:227], v[48:51]
  v_mfma_f32_16x16x32_bf16 v[52:55], v[200:203], v[224:227], v[52:55]
  v_mfma_f32_16x16x32_bf16 v[56:59], v[204:207], v[224:227], v[56:59]
  v_mfma_f32_16x16x32_bf16 v[60:63], v[208:211], v[224:227], v[60:63]
  v_mfma_f32_16x16x32_bf16 v[64:67], v[212:215], v[224:227], v[64:67]
  v_mfma_f32_16x16x32_bf16 v[68:71], v[196:199], v[228:231], v[68:71]
  v_mfma_f32_16x16x32_bf16 v[72:75], v[200:203], v[228:231], v[72:75]
  v_mfma_f32_16x16x32_bf16 v[76:79], v[204:207], v[228:231], v[76:79]
  v_mfma_f32_16x16x32_bf16 v[80:83], v[208:211], v[228:231], v[80:83]
  v_mfma_f32_16x16x32_bf16 v[84:87], v[212:215], v[228:231], v[84:87]
  s_waitcnt vmcnt(9)
  v_mfma_f32_16x16x32_bf16 v[8:11], v[88:91], v[108:111], v[8:11]
  v_mfma_f32_16x16x32_bf16 v[12:15], v[92:95], v[108:111], v[12:15]
  v_mfma_f32_16x16x32_bf16 v[16:19], v[96:99], v[108:111], v[16:19]
  v_mfma_f32_16x16x32_bf16 v[20:23], v[100:103], v[108:111], v[20:23]
  v_mfma_f32_16x16x32_bf16 v[24:27], v[104:107], v[108:111], v[24:27]
  v_mfma_f32_16x16x32_bf16 v[28:31], v[88:91], v[112:115], v[28:31]
  v_mfma_f32_16x16x32_bf16 v[32:35], v[92:95], v[112:115], v[32:35]
  v_mfma_f32_16x16x32_bf16 v[36:39], v[96:99], v[112:115], v[36:39]
  v_mfma_f32_16x16x32_bf16 v[40:43], v[100:103], v[112:115], v[40:43]
  v_mfma_f32_16x16x32_bf16 v[44:47], v[104:107], v[112:115], v[44:47]
  v_mfma_f32_16x16x32_bf16 v[48:51], v[88:91], v[116:119], v[48:51]
  v_mfma_f32_16x16x32_bf16 v[52:55], v[92:95], v[116:119], v[52:55]
  v_mfma_f32_16x16x32_bf16 v[56:59], v[96:99], v[116:119], v[56:59]
  v_mfma_f32_16x16x32_bf16 v[60:63], v[100:103], v[116:119], v[60:63]
  v_mfma_f32_16x16x32_bf16 v[64:67], v[104:107], v[116:119], v[64:67]
  v_mfma_f32_16x16x32_bf16 v[68:71], v[88:91], v[120:123], v[68:71]
  v_mfma_f32_16x16x32_bf16 v[72:75], v[92:95], v[120:123], v[72:75]
  v_mfma_f32_16x16x32_bf16 v[76:79], v[96:99], v[120:123], v[76:79]
  v_mfma_f32_16x16x32_bf16 v[80:83], v[100:103], v[120:123], v[80:83]
  v_mfma_f32_16x16x32_bf16 v[84:87], v[104:107], v[120:123], v[84:87]
  s_waitcnt vmcnt(0)
  s_add_u32 s60, s61, 1
  s_and_b32 s60, s60, 3
  s_mul_i32 s60, s60, 15360
  s_add_u32 s60, s60, 61440
  v_add_u32 v4, s60, v3
  s_add_u32 s60, s61, 2
  s_and_b32 s60, s60, 3
  s_mul_i32 s60, s60, 15360
  s_add_u32 s60, s60, 66560
  v_add_u32 v5, s60, v3
  s_add_u32 s60, s61, 3
  s_and_b32 s60, s60, 3
  s_mul_i32 s60, s60, 15360
  s_add_u32 s60, s60, 71680
  v_add_u32 v6, s60, v3
  v_mfma_f32_16x16x32_bf16 v[28:31], v[124:127], v[148:151], v[28:31]
  v_mfma_f32_16x16x32_bf16 v[32:35], v[128:131], v[148:151], v[32:35]
  v_mfma_f32_16x16x32_bf16 v[36:39], v[132:135], v[148:151], v[36:39]
  v_mfma_f32_16x16x32_bf16 v[40:43], v[136:139], v[148:151], v[40:43]
  v_mfma_f32_16x16x32_bf16 v[44:47], v[140:143], v[148:151], v[44:47]
  v_mfma_f32_16x16x32_bf16 v[48:51], v[124:127], v[152:155], v[48:51]
  v_mfma_f32_16x16x32_bf16 v[52:55], v[128:131], v[152:155], v[52:55]
  v_mfma_f32_16x16x32_bf16 v[56:59], v[132:135], v[152:155], v[56:59]
  v_mfma_f32_16x16x32_bf16 v[60:63], v[136:139], v[152:155], v[60:63]
  v_mfma_f32_16x16x32_bf16 v[64:67], v[140:143], v[152:155], v[64:67]
  v_mfma_f32_16x16x32_bf16 v[68:71], v[124:127], v[156:159], v[68:71]
  ds_write_b128 v4, v[28:31] offset:0
  v_mfma_f32_16x16x32_bf16 v[72:75], v[128:131], v[156:159], v[72:75]
  ds_write_b128 v4, v[32:35] offset:1024
  v_mfma_f32_16x16x32_bf16 v[76:79], v[132:135], v[156:159], v[76:79]
  ds_write_b128 v4, v[36:39] offset:2048
  v_mfma_f32_16x16x32_bf16 v[80:83], v[136:139], v[156:159], v[80:83]
  ds_write_b128 v4, v[40:43] offset:3072
  v_mfma_f32_16x16x32_bf16 v[84:87], v[140:143], v[156:159], v[84:87]
  ds_write_b128 v4, v[44:47] offset:4096
  v_mfma_f32_16x16x32_bf16 v[8:11], v[124:127], v[144:147], v[8:11]
  ds_write_b128 v5, v[48:51] offset:0
  v_mfma_f32_16x16x32_bf16 v[12:15], v[128:131], v[144:147], v[12:15]
  ds_write_b128 v5, v[52:55] offset:1024
  v_mfma_f32_16x16x32_bf16 v[16:19], v[132:135], v[144:147], v[16:19]
  ds_write_b128 v5, v[56:59] offset:2048
  v_mfma_f32_16x16x32_bf16 v[20:23], v[136:139], v[144:147], v[20:23]
  ds_write_b128 v5, v[60:63] offset:3072
  v_mfma_f32_16x16x32_bf16 v[24:27], v[140:143], v[144:147], v[24:27]
  ds_write_b128 v5, v[64:67] offset:4096
  s_nop 7
  ds_write_b128 v6, v[68:71] offset:0
  ds_write_b128 v6, v[72:75] offset:1024
  ds_write_b128 v6, v[76:79] offset:2048
  ds_write_b128 v6, v[80:83] offset:3072
  ds_write_b128 v6, v[84:87] offset:4096
  s_waitcnt lgkmcnt(0)
  s_lshl_b32 s60, s61, 2
  s_add_u32 s60, s60, 122976
  v_mov_b32 v254, s60
  v_mov_b32 v255, 1
  ds_write_b32 v254, v255
  s_mul_i32 s60, s61, 15360
  s_add_u32 s60, s60, 61440
  v_add_u32 v4, s60, v3
  v_mov_b32 v1, v4
  v_and_b32 v5, 15, v0
  v_lshrrev_b32 v6, 4, v0
  v_lshrrev_b32 v7, 2, v5
  v_lshlrev_b32 v7, 4, v7
  v_and_b32 v254, 1, v5
  v_lshl_add_u32 v7, v254, 3, v7
  v_bfe_u32 v254, v5, 1, 1
  v_add_u32 v7, v7, v254
  s_lshl_b32 s62, s65, 6
  s_lshl_b32 s63, s61, 1
  s_add_u32 s62, s62, s63
  v_add_u32 v7, s62, v7
  s_mul_i32 s63, s64, 80
  v_lshl_add_u32 v5, v6, 2, s63
  v_lshlrev_b32 v4, 4, v7
  v_add_u32 v4, 4096, v4
  v_mul_u32_u24 v7, 640, v7
  v_add_u32 v7, v7, v5
  v_lshlrev_b32 v6, 1, v7
  v_lshlrev_b32 v7, 2, v7
  v_lshlrev_b32 v5, 1, v5
  s_mul_i32 s60, s61, 15360
  v_add_u32 v4, s60, v3
  v_lshlrev_b32 v168, 16, v232
  v_and_b32 v169, 0xffff0000, v232
  v_lshlrev_b32 v170, 16, v233
  v_and_b32 v171, 0xffff0000, v233
  v_lshlrev_b32 v172, 16, v234
  v_and_b32 v173, 0xffff0000, v234
  v_lshlrev_b32 v174, 16, v235
  v_and_b32 v175, 0xffff0000, v235
  v_lshlrev_b32 v176, 16, v236
  v_and_b32 v177, 0xffff0000, v236
  v_lshlrev_b32 v178, 16, v237
  v_and_b32 v179, 0xffff0000, v237
  v_lshlrev_b32 v180, 16, v238
  v_and_b32 v181, 0xffff0000, v238
  v_lshlrev_b32 v182, 16, v239
  v_and_b32 v183, 0xffff0000, v239
  v_lshlrev_b32 v184, 16, v240
  v_and_b32 v185, 0xffff0000, v240
  v_lshlrev_b32 v186, 16, v241
  v_and_b32 v187, 0xffff0000, v241
  s_lshl_b32 s60, s61, 2
  s_add_u32 s60, s60, 122992
  v_mov_b32 v254, s60
K2s_g:
  ds_read_b32 v255, v254 offset:0
  s_waitcnt lgkmcnt(0)
  v_readfirstlane_b32 s60, v255
  s_cmp_eq_u32 s60, 0
  s_cbranch_scc1 K2s_g
  ds_read_b128 v[148:151], v4 offset:0
  ds_read_b128 v[152:155], v4 offset:1024
  ds_read_b128 v[156:159], v4 offset:2048
  ds_read_b128 v[160:163], v4 offset:3072
  ds_read_b128 v[164:167], v4 offset:4096
  v_mov_b32 v254, 122976
K2s_rf:
  ds_read_b128 v[244:247], v254
  s_waitcnt lgkmcnt(0)
  v_and_b32 v244, v244, v245
  v_and_b32 v246, v246, v247
  v_and_b32 v244, v244, v246
  s_nop 0
  v_readfirstlane_b32 s60, v244
  s_and_b32 s60, s60, -1
  s_cbranch_scc0 K2s_rf
  ds_read_b128 v[88:91], v1 offset:0
  ds_read_b128 v[108:111], v1 offset:5120
  ds_read_b128 v[128:131], v1 offset:10240
  ds_read_b128 v[92:95], v1 offset:1024
  ds_read_b128 v[112:115], v1 offset:6144
  ds_read_b128 v[132:135], v1 offset:11264
  ds_read_b128 v[96:99], v1 offset:2048
  ds_read_b128 v[116:119], v1 offset:7168
  ds_read_b128 v[136:139], v1 offset:12288
  ds_read_b128 v[100:103], v1 offset:3072
  ds_read_b128 v[120:123], v1 offset:8192
  ds_read_b128 v[140:143], v1 offset:13312
  ds_read_b128 v[104:107], v1 offset:4096
  ds_read_b128 v[124:127], v1 offset:9216
  ds_read_b128 v[144:147], v1 offset:14336
  s_waitcnt lgkmcnt(12)
  v_pk_add_f32 v[88:89], v[88:89], v[108:109]
  v_pk_add_f32 v[8:9], v[8:9], v[128:129]
  v_pk_add_f32 v[90:91], v[90:91], v[110:111]
  v_pk_add_f32 v[10:11], v[10:11], v[130:131]
  v_pk_add_f32 v[8:9], v[8:9], v[88:89]
  v_pk_add_f32 v[10:11], v[10:11], v[90:91]
  v_pk_fma_f32 v[8:9], v[8:9], v[148:149], v[168:169]
  v_pk_fma_f32 v[10:11], v[10:11], v[150:151], v[170:171]
  buffer_store_dwordx4 v[8:11], v7, s[56:59], 0 offen offset:0 sc1
  s_waitcnt lgkmcnt(9)
  v_pk_add_f32 v[92:93], v[92:93], v[112:113]
  v_pk_add_f32 v[12:13], v[12:13], v[132:133]
  v_pk_add_f32 v[94:95], v[94:95], v[114:115]
  v_pk_add_f32 v[14:15], v[14:15], v[134:135]
  v_pk_add_f32 v[12:13], v[12:13], v[92:93]
  v_pk_add_f32 v[14:15], v[14:15], v[94:95]
  v_pk_fma_f32 v[12:13], v[12:13], v[152:153], v[172:173]
  v_pk_fma_f32 v[14:15], v[14:15], v[154:155], v[174:175]
  buffer_store_dwordx4 v[12:15], v7, s[56:59], 0 offen offset:64 sc1
  s_waitcnt lgkmcnt(6)
  v_pk_add_f32 v[96:97], v[96:97], v[116:117]
  v_pk_add_f32 v[16:17], v[16:17], v[136:137]
  v_pk_add_f32 v[98:99], v[98:99], v[118:119]
  v_pk_add_f32 v[18:19], v[18:19], v[138:139]
  v_pk_add_f32 v[16:17], v[16:17], v[96:97]
  v_pk_add_f32 v[18:19], v[18:19], v[98:99]
  v_pk_fma_f32 v[16:17], v[16:17], v[156:157], v[176:177]
  v_pk_fma_f32 v[18:19], v[18:19], v[158:159], v[178:179]
  buffer_store_dwordx4 v[16:19], v7, s[56:59], 0 offen offset:128 sc1
  s_waitcnt lgkmcnt(3)
  v_pk_add_f32 v[100:101], v[100:101], v[120:121]
  v_pk_add_f32 v[20:21], v[20:21], v[140:141]
  v_pk_add_f32 v[102:103], v[102:103], v[122:123]
  v_pk_add_f32 v[22:23], v[22:23], v[142:143]
  v_pk_add_f32 v[20:21], v[20:21], v[100:101]
  v_pk_add_f32 v[22:23], v[22:23], v[102:103]
  v_pk_fma_f32 v[20:21], v[20:21], v[160:161], v[180:181]
  v_pk_fma_f32 v[22:23], v[22:23], v[162:163], v[182:183]
  buffer_store_dwordx4 v[20:23], v7, s[56:59], 0 offen offset:192 sc1
  s_waitcnt lgkmcnt(0)
  v_pk_add_f32 v[104:105], v[104:105], v[124:125]
  v_pk_add_f32 v[24:25], v[24:25], v[144:145]
  v_pk_add_f32 v[106:107], v[106:107], v[126:127]
  v_pk_add_f32 v[26:27], v[26:27], v[146:147]
  v_pk_add_f32 v[24:25], v[24:25], v[104:105]
  v_pk_add_f32 v[26:27], v[26:27], v[106:107]
  v_pk_fma_f32 v[24:25], v[24:25], v[164:165], v[184:185]
  v_pk_fma_f32 v[26:27], v[26:27], v[166:167], v[186:187]
  buffer_store_dwordx4 v[24:27], v7, s[56:59], 0 offen offset:256 sc1
  s_endpgm
K1_sync:
  s_mov_b32 s97, 0
  s_mov_b32 s70, 12
  s_mov_b32 s36, s12
  s_and_b32 s37, s13, 0xffff
  s_mov_b32 s38, 1048576
  s_mov_b32 s39, 0x20000
  s_mov_b32 s40, s16
  s_and_b32 s41, s17, 0xffff
  s_mov_b32 s42, 1280
  s_mov_b32 s43, 0x20000
  s_mov_b32 s44, s18
  s_and_b32 s45, s19, 0xffff
  s_mov_b32 s46, 1280
  s_mov_b32 s47, 0x20000
  s_mov_b32 s48, s20
  s_and_b32 s49, s21, 0xffff
  s_mov_b32 s50, 1280
  s_mov_b32 s51, 0x20000
  s_mov_b32 s52, s14
  s_and_b32 s53, s15, 0xffff
  s_mov_b32 s54, 3072
  s_mov_b32 s55, 0x20000

  v_mov_b32 v1, 0
  buffer_load_dword v2, v1, s[36:39], 0 offen
  s_lshl_b32 s60, s32, 4
  v_add_u32 v3, s60, v0
  v_min_u32 v3, 639, v3
  v_lshlrev_b32 v4, 1, v3
  buffer_load_ushort v5, v4, s[40:43], 0 offen
  buffer_load_ushort v6, v4, s[44:47], 0 offen
  buffer_load_ushort v7, v4, s[48:51], 0 offen
  s_lshl_b32 s60, s33, 7
  v_lshlrev_b32 v4, 2, v0
  v_add_u32 v4, s60, v4
  v_min_u32 v4, 3068, v4
  buffer_load_dword v8, v4, s[52:55], 0 offen
  v_mov_b32 v10, 0
  v_mov_b32 v11, 0
  v_lshlrev_b32 v13, 3, v0
  v_add_u32 v12, 122880, v13
  s_mov_b64 exec, 0xffff
  ds_write_b64 v12, v[10:11]
  s_mov_b64 exec, -1
  v_add_u32 v12, 132736, v13

  ds_write_b64 v12, v[10:11] offset:0
  ds_write_b64 v12, v[10:11] offset:384
  ds_write_b64 v12, v[10:11] offset:1920
  ds_write_b64 v12, v[10:11] offset:2304
  ds_write_b64 v12, v[10:11] offset:3840
  ds_write_b64 v12, v[10:11] offset:4224
  s_mov_b32 s76, s4
  s_and_b32 s77, s5, 0xffff
  s_mov_b32 s78, 2621440
  s_mov_b32 s79, 0x20000
  v_lshrrev_b32 v20, 4, v0
  s_lshl_b32 s60, s29, 7
  s_lshl_b32 s61, s30, 3
  s_add_u32 s60, s60, s61
  s_add_u32 s60, s60, 4
  v_add_u32 v20, s60, v20
  v_lshlrev_b32 v21, 4, v20
  v_add_u32 v21, 4096, v21
  v_mul_u32_u24 v20, 1280, v20
  v_and_b32 v22, 15, v0
  v_lshl_add_u32 v20, v22, 4, v20
  buffer_load_dwordx4 v[24:27], v20, s[76:79], 0 offen offset:0
  buffer_load_dwordx4 v[28:31], v20, s[76:79], 0 offen offset:256
  buffer_load_dwordx4 v[32:35], v20, s[76:79], 0 offen offset:512
  buffer_load_dwordx4 v[36:39], v20, s[76:79], 0 offen offset:768
  buffer_load_dwordx4 v[40:43], v20, s[76:79], 0 offen offset:1024
  s_waitcnt vmcnt(9)

  v_readfirstlane_b32 s71, v2
  s_mul_i32 s72, s71, 2654435761
  s_add_u32 s72, s72, 2135587861
  v_mov_b32 v9, s72
  v_mov_b32 v12, 122912
  s_waitcnt lgkmcnt(0)
  ds_write_b32 v12, v9
  s_waitcnt lgkmcnt(0)

  s_cmp_eq_u32 s70, 0
  s_cbranch_scc1 K1_nb23
  s_barrier
  s_sub_u32 s70, s70, 1
K1_nb23:
  s_waitcnt vmcnt(0)
  v_mov_b32 v23, s72
  v_lshlrev_b32 v48, 16, v24
  v_and_b32 v49, 0xffff0000, v24
  v_lshlrev_b32 v50, 16, v25
  v_and_b32 v51, 0xffff0000, v25
  v_lshlrev_b32 v52, 16, v26
  v_and_b32 v53, 0xffff0000, v26
  v_lshlrev_b32 v54, 16, v27
  v_and_b32 v55, 0xffff0000, v27
  v_lshlrev_b32 v56, 16, v28
  v_and_b32 v57, 0xffff0000, v28
  v_lshlrev_b32 v58, 16, v29
  v_and_b32 v59, 0xffff0000, v29
  v_lshlrev_b32 v60, 16, v30
  v_and_b32 v61, 0xffff0000, v30
  v_lshlrev_b32 v62, 16, v31
  v_and_b32 v63, 0xffff0000, v31
  v_lshlrev_b32 v64, 16, v32
  v_and_b32 v65, 0xffff0000, v32
  v_lshlrev_b32 v66, 16, v33
  v_and_b32 v67, 0xffff0000, v33
  v_lshlrev_b32 v68, 16, v34
  v_and_b32 v69, 0xffff0000, v34
  v_lshlrev_b32 v70, 16, v35
  v_and_b32 v71, 0xffff0000, v35
  v_lshlrev_b32 v72, 16, v36
  v_and_b32 v73, 0xffff0000, v36
  v_lshlrev_b32 v74, 16, v37
  v_and_b32 v75, 0xffff0000, v37
  v_lshlrev_b32 v76, 16, v38
  v_and_b32 v77, 0xffff0000, v38
  v_lshlrev_b32 v78, 16, v39
  v_and_b32 v79, 0xffff0000, v39
  v_lshlrev_b32 v80, 16, v40
  v_and_b32 v81, 0xffff0000, v40
  v_lshlrev_b32 v82, 16, v41
  v_and_b32 v83, 0xffff0000, v41
  v_lshlrev_b32 v84, 16, v42
  v_and_b32 v85, 0xffff0000, v42
  v_lshlrev_b32 v86, 16, v43
  v_and_b32 v87, 0xffff0000, v43
  v_add_f32 v88, v48, v52
  v_add_f32 v89, v49, v53
  v_add_f32 v90, v50, v54
  v_add_f32 v91, v51, v55
  v_add_f32 v88, v88, v56
  v_add_f32 v89, v89, v57
  v_add_f32 v90, v90, v58
  v_add_f32 v91, v91, v59
  v_add_f32 v88, v88, v60
  v_add_f32 v89, v89, v61
  v_add_f32 v90, v90, v62
  v_add_f32 v91, v91, v63
  v_add_f32 v88, v88, v64
  v_add_f32 v89, v89, v65
  v_add_f32 v90, v90, v66
  v_add_f32 v91, v91, v67
  v_add_f32 v88, v88, v68
  v_add_f32 v89, v89, v69
  v_add_f32 v90, v90, v70
  v_add_f32 v91, v91, v71
  v_add_f32 v88, v88, v72
  v_add_f32 v89, v89, v73
  v_add_f32 v90, v90, v74
  v_add_f32 v91, v91, v75
  v_add_f32 v88, v88, v76
  v_add_f32 v89, v89, v77
  v_add_f32 v90, v90, v78
  v_add_f32 v91, v91, v79
  v_add_f32 v88, v88, v80
  v_add_f32 v89, v89, v81
  v_add_f32 v90, v90, v82
  v_add_f32 v91, v91, v83
  v_add_f32 v88, v88, v84
  v_add_f32 v89, v89, v85
  v_add_f32 v90, v90, v86
  v_add_f32 v91, v91, v87
  v_add_f32 v88, v88, v89
  v_add_f32 v90, v90, v91
  v_add_f32 v88, v88, v90
  s_nop 1
  v_add_f32_dpp v88, v88, v88 row_ror:8 row_mask:0xf bank_mask:0xf
  s_nop 1
  v_add_f32_dpp v88, v88, v88 row_ror:4 row_mask:0xf bank_mask:0xf
  s_nop 1
  v_add_f32_dpp v88, v88, v88 row_ror:2 row_mask:0xf bank_mask:0xf
  s_nop 1
  v_add_f32_dpp v88, v88, v88 row_ror:1 row_mask:0xf bank_mask:0xf
  s_nop 0
  v_mul_f32 v92, 0.0015625000232830644, v88
  v_sub_f32 v48, v48, v92
  v_sub_f32 v49, v49, v92
  v_sub_f32 v50, v50, v92
  v_sub_f32 v51, v51, v92
  v_sub_f32 v52, v52, v92
  v_sub_f32 v53, v53, v92
  v_sub_f32 v54, v54, v92
  v_sub_f32 v55, v55, v92
  v_sub_f32 v56, v56, v92
  v_sub_f32 v57, v57, v92
  v_sub_f32 v58, v58, v92
  v_sub_f32 v59, v59, v92
  v_sub_f32 v60, v60, v92
  v_sub_f32 v61, v61, v92
  v_sub_f32 v62, v62, v92
  v_sub_f32 v63, v63, v92
  v_sub_f32 v64, v64, v92
  v_sub_f32 v65, v65, v92
  v_sub_f32 v66, v66, v92
  v_sub_f32 v67, v67, v92
  v_sub_f32 v68, v68, v92
  v_sub_f32 v69, v69, v92
  v_sub_f32 v70, v70, v92
  v_sub_f32 v71, v71, v92
  v_sub_f32 v72, v72, v92
  v_sub_f32 v73, v73, v92
  v_sub_f32 v74, v74, v92
  v_sub_f32 v75, v75, v92
  v_sub_f32 v76, v76, v92
  v_sub_f32 v77, v77, v92
  v_sub_f32 v78, v78, v92
  v_sub_f32 v79, v79, v92
  v_sub_f32 v80, v80, v92
  v_sub_f32 v81, v81, v92
  v_sub_f32 v82, v82, v92
  v_sub_f32 v83, v83, v92
  v_sub_f32 v84, v84, v92
  v_sub_f32 v85, v85, v92
  v_sub_f32 v86, v86, v92
  v_sub_f32 v87, v87, v92
  v_mul_f32 v88, v48, v48
  v_mul_f32 v89, v49, v49
  v_mul_f32 v90, v50, v50
  v_mul_f32 v91, v51, v51
  v_fmac_f32 v88, v52, v52
  v_fmac_f32 v89, v53, v53
  v_fmac_f32 v90, v54, v54
  v_fmac_f32 v91, v55, v55
  v_fmac_f32 v88, v56, v56
  v_fmac_f32 v89, v57, v57
  v_fmac_f32 v90, v58, v58
  v_fmac_f32 v91, v59, v59
  v_fmac_f32 v88, v60, v60
  v_fmac_f32 v89, v61, v61
  v_fmac_f32 v90, v62, v62
  v_fmac_f32 v91, v63, v63
  v_fmac_f32 v88, v64, v64
  v_fmac_f32 v89, v65, v65
  v_fmac_f32 v90, v66, v66
  v_fmac_f32 v91, v67, v67
  v_fmac_f32 v88, v68, v68
  v_fmac_f32 v89, v69, v69
  v_fmac_f32 v90, v70, v70
  v_fmac_f32 v91, v71, v71
  v_fmac_f32 v88, v72, v72
  v_fmac_f32 v89, v73, v73
  v_fmac_f32 v90, v74, v74
  v_fmac_f32 v91, v75, v75
  v_fmac_f32 v88, v76, v76
  v_fmac_f32 v89, v77, v77
  v_fmac_f32 v90, v78, v78
  v_fmac_f32 v91, v79, v79
  v_fmac_f32 v88, v80, v80
  v_fmac_f32 v89, v81, v81
  v_fmac_f32 v90, v82, v82
  v_fmac_f32 v91, v83, v83
  v_fmac_f32 v88, v84, v84
  v_fmac_f32 v89, v85, v85
  v_fmac_f32 v90, v86, v86
  v_fmac_f32 v91, v87, v87
  v_add_f32 v88, v88, v89
  v_add_f32 v90, v90, v91
  v_add_f32 v88, v88, v90
  s_nop 1
  v_add_f32_dpp v88, v88, v88 row_ror:8 row_mask:0xf bank_mask:0xf
  s_nop 1
  v_add_f32_dpp v88, v88, v88 row_ror:4 row_mask:0xf bank_mask:0xf
  s_nop 1
  v_add_f32_dpp v88, v88, v88 row_ror:2 row_mask:0xf bank_mask:0xf
  s_nop 1
  v_add_f32_dpp v88, v88, v88 row_ror:1 row_mask:0xf bank_mask:0xf
  s_nop 0
  v_mul_f32 v88, 0.0015625000232830644, v88
  v_cvt_pk_bf16_f32 v96, v92, v92
  v_lshlrev_b32 v96, 16, v96
  v_cvt_pk_bf16_f32 v88, v88, v88
  v_lshlrev_b32 v88, 16, v88
  v_add_f32 v88, 0x3727c5ac, v88
  v_cvt_pk_bf16_f32 v88, v88, v88
  v_lshlrev_b32 v88, 16, v88
  v_sqrt_f32 v88, v88
  s_nop 0
  v_cvt_pk_bf16_f32 v88, v88, v88
  v_lshlrev_b32 v88, 16, v88
  v_rcp_f32 v98, v88
  v_mov_b32 v97, v23
  v_mov_b32 v99, v23
  s_mov_b32 exec_lo, 0x00010001
  s_mov_b32 exec_hi, 0x00010001
  buffer_store_dwordx4 v[96:99], v21, s[36:39], 0 offen sc1
  s_mov_b64 exec, -1
  s_cmp_eq_u32 s70, 0
  s_cbranch_scc1 K1_nb24
  s_barrier
  s_sub_u32 s70, s70, 1
K1_nb24:
  s_mov_b32 s40, s26
  s_and_b32 s41, s27, 0xffff
  s_mov_b32 s42, 1966080
  s_mov_b32 s43, 0x20000
  s_mov_b32 s44, s22
  s_and_b32 s45, s23, 0xffff
  s_mov_b32 s46, 819200
  s_mov_b32 s47, 0x20000
  s_mov_b32 s48, s24
  s_and_b32 s49, s25, 0xffff
  s_mov_b32 s50, 819200
  s_mov_b32 s51, 0x20000
  s_add_u32 s52, s12, 12582912
  s_addc_u32 s53, s13, 0
  s_and_b32 s53, s53, 0xffff
  s_mov_b32 s54, 3604480
  s_mov_b32 s55, 0x20000
  v_lshrrev_b32 v100, 3, v0
  v_and_b32 v101, 7, v0
  v_xor_b32 v101, v101, v100
  v_mul_u32_u24 v100, 1280, v100
  v_lshl_add_u32 v100, v101, 4, v100
  s_add_u32 s61, s2, 256
  s_cmp_lt_u32 s2, 224
  s_cselect_b32 s61, s61, s2
  s_add_u32 s62, s2, 144
  s_cmp_ge_u32 s2, 112
  s_cselect_b32 s62, s62, s2
  s_mul_i32 s63, s2, 6554
  s_lshr_b32 s63, s63, 16
  s_mul_i32 s64, s63, 10
  s_sub_u32 s64, s2, s64
  s_mul_i32 s65, s63, 40960
  s_lshl_b32 s66, s64, 7
  s_add_u32 s65, s65, s66
  s_mov_b32 m0, 139264
  s_add_u32 s66, s65, 0
  buffer_load_dwordx4 v100, s[40:43], s66 offen lds
  s_mov_b32 m0, 140288
  s_add_u32 s66, s65, 10240
  buffer_load_dwordx4 v100, s[40:43], s66 offen lds
  s_mov_b32 m0, 141312
  s_add_u32 s66, s65, 20480
  buffer_load_dwordx4 v100, s[40:43], s66 offen lds
  s_mov_b32 m0, 142336
  s_add_u32 s66, s65, 30720
  buffer_load_dwordx4 v100, s[40:43], s66 offen lds
  s_mul_i32 s90, s63, 5
  s_lshl_b32 s91, s64, 2
  s_mul_i32 s63, s61, 6554
  s_lshr_b32 s63, s63, 16
  s_mul_i32 s64, s63, 10
  s_sub_u32 s64, s61, s64
  s_mul_i32 s65, s63, 40960
  s_lshl_b32 s66, s64, 7
  s_add_u32 s65, s65, s66
  s_mov_b32 m0, 143360
  s_add_u32 s66, s65, 0
  buffer_load_dwordx4 v100, s[40:43], s66 offen lds
  s_mov_b32 m0, 144384
  s_add_u32 s66, s65, 10240
  buffer_load_dwordx4 v100, s[40:43], s66 offen lds
  s_mov_b32 m0, 145408
  s_add_u32 s66, s65, 20480
  buffer_load_dwordx4 v100, s[40:43], s66 offen lds
  s_mov_b32 m0, 146432
  s_add_u32 s66, s65, 30720
  buffer_load_dwordx4 v100, s[40:43], s66 offen lds
  s_mul_i32 s92, s63, 5
  s_lshl_b32 s93, s64, 2
  s_mul_i32 s63, s2, 6554
  s_lshr_b32 s63, s63, 16
  s_mul_i32 s64, s63, 10
  s_sub_u32 s64, s2, s64
  s_mul_i32 s65, s63, 20480
  s_lshl_b32 s66, s64, 7
  s_add_u32 s65, s65, s66
  s_mov_b32 m0, 147456
  s_add_u32 s66, s65, 0
  buffer_load_dwordx4 v100, s[44:47], s66 offen lds
  s_mov_b32 m0, 148480
  s_add_u32 s66, s65, 10240
  buffer_load_dwordx4 v100, s[44:47], s66 offen lds
  s_mov_b32 m0, 149504
  s_add_u32 s66, s65, 0
  buffer_load_dwordx4 v100, s[48:51], s66 offen lds
  s_mov_b32 m0, 150528
  s_add_u32 s66, s65, 10240
  buffer_load_dwordx4 v100, s[48:51], s66 offen lds
  s_mul_i32 s65, s63, 13108
  s_lshr_b32 s65, s65, 16
  s_mul_i32 s66, s65, 5
  s_sub_u32 s66, s63, s66
  s_mul_i32 s65, s65, 440
  s_mul_i32 s64, s64, 20
  s_add_u32 s65, s65, s64
  s_add_u32 s65, s65, s66
  s_add_u32 s65, s65, 240
  s_lshl_b32 s94, s65, 10
  s_mul_i32 s63, s62, 6554
  s_lshr_b32 s63, s63, 16
  s_mul_i32 s64, s63, 10
  s_sub_u32 s64, s62, s64
  s_mul_i32 s65, s63, 20480
  s_lshl_b32 s66, s64, 7
  s_add_u32 s65, s65, s66
  s_mov_b32 m0, 151552
  s_add_u32 s66, s65, 0
  buffer_load_dwordx4 v100, s[44:47], s66 offen lds
  s_mov_b32 m0, 152576
  s_add_u32 s66, s65, 10240
  buffer_load_dwordx4 v100, s[44:47], s66 offen lds
  s_mov_b32 m0, 153600
  s_add_u32 s66, s65, 0
  buffer_load_dwordx4 v100, s[48:51], s66 offen lds
  s_mov_b32 m0, 154624
  s_add_u32 s66, s65, 10240
  buffer_load_dwordx4 v100, s[48:51], s66 offen lds
  s_mul_i32 s65, s63, 13108
  s_lshr_b32 s65, s65, 16
  s_mul_i32 s66, s65, 5
  s_sub_u32 s66, s63, s66
  s_mul_i32 s65, s65, 440
  s_mul_i32 s64, s64, 20
  s_add_u32 s65, s65, s64
  s_add_u32 s65, s65, s66
  s_add_u32 s65, s65, 240
  s_lshl_b32 s95, s65, 10

  v_lshlrev_b32 v5, 16, v5
  v_lshlrev_b32 v6, 16, v6
  v_lshlrev_b32 v7, 16, v7
  v_mul_f32 v7, 0x3fb8aa3b, v7
  v_exp_f32 v7, v7
  s_nop 0

  v_cvt_pk_bf16_f32 v7, v7, v7
  v_lshlrev_b32 v7, 16, v7

  v_mul_f32 v12, v7, v5
  v_mul_f32 v13, v7, v6
  v_mul_f32 v12, 0x3fb8aa3b, v12
  v_exp_f32 v12, v12
  v_mul_f32 v13, 0.15915494, v13
  v_sin_f32 v14, v13
  v_cos_f32 v15, v13
  s_nop 0
  v_mul_f32 v16, v12, v15
  v_mul_f32 v17, v12, v14
  v_subrev_f32 v12, 1.0, v16
  v_mul_f32 v13, v5, v5
  v_fmac_f32 v13, v6, v6
  v_rcp_f32 v13, v13
  v_mul_f32 v14, v12, v5
  v_fmac_f32 v14, v17, v6
  v_mul_f32 v15, v17, v5
  v_fma_f32 v15, -v12, v6, v15
  v_add_f32 v13, v13, v13
  v_mul_f32 v22, v14, v13
  v_mul_f32 v23, v15, v13

  v_mul_f32 v25, v16, v17
  v_mul_f32 v24, v17, v17
  v_fma_f32 v24, v16, v16, -v24
  v_add_f32 v25, v25, v25
  v_mul_f32 v27, v24, v25
  v_mul_f32 v26, v25, v25
  v_fma_f32 v26, v24, v24, -v26
  v_add_f32 v27, v27, v27
  v_mul_f32 v19, v26, v27
  v_mul_f32 v18, v27, v27
  v_fma_f32 v18, v26, v26, -v18
  v_add_f32 v19, v19, v19
  v_mul_f32 v21, v18, v19
  v_mul_f32 v20, v19, v19
  v_fma_f32 v20, v18, v18, -v20
  v_add_f32 v21, v21, v21
  s_cmp_eq_u32 s70, 0
  s_cbranch_scc1 K1_nb25
  s_barrier
  s_sub_u32 s70, s70, 1
K1_nb25:
  v_mul_f32 v29, v20, v21
  v_mul_f32 v28, v21, v21
  v_fma_f32 v28, v20, v20, -v28
  v_add_f32 v29, v29, v29
  v_mul_f32 v31, v28, v29
  v_mul_f32 v30, v29, v29
  v_fma_f32 v30, v28, v28, -v30
  v_add_f32 v31, v31, v31
  v_mul_f32 v33, v30, v31
  v_mul_f32 v32, v31, v31
  v_fma_f32 v32, v30, v30, -v32
  v_add_f32 v33, v33, v33

  v_lshlrev_b32 v12, 5, v0
  v_add_u32 v12, 125568, v12
  v_min_u32 v12, 127072, v12
  s_mov_b32 exec_hi, 0xffff
  ds_write_b128 v12, v[16:19]
  ds_write_b128 v12, v[20:23] offset:16
  v_lshrrev_b32 v12, 4, v0
  v_lshlrev_b32 v12, 10, v12
  v_and_b32 v13, 15, v0
  v_lshl_add_u32 v12, v13, 3, v12
  v_add_u32 v12, 128640, v12
  v_mov_b32 v34, 1.0
  v_mov_b32 v35, 0
  ds_write_b64 v12, v[34:35]
  ds_write_b64 v12, v[20:21] offset:128
  ds_write_b64 v12, v[28:29] offset:256
  ds_write_b64 v12, v[30:31] offset:512

  v_mul_f32 v38, v29, v21
  v_fma_f32 v38, v28, v20, -v38
  v_mul_f32 v35, v28, v21
  v_fma_f32 v35, v29, v20, v35
  v_mov_b32 v34, v38
  ds_write_b64 v12, v[34:35] offset:384
  v_mul_f32 v38, v31, v21
  v_fma_f32 v38, v30, v20, -v38
  v_mul_f32 v37, v30, v21
  v_fma_f32 v37, v31, v20, v37
  v_mov_b32 v36, v38
  ds_write_b64 v12, v[36:37] offset:640
  v_mul_f32 v38, v31, v29
  v_fma_f32 v38, v30, v28, -v38
  v_mul_f32 v37, v30, v29
  v_fma_f32 v37, v31, v28, v37
  v_mov_b32 v36, v38
  ds_write_b64 v12, v[36:37] offset:768
  v_mul_f32 v38, v31, v35
  v_fma_f32 v38, v30, v34, -v38
  v_mul_f32 v37, v30, v35
  v_fma_f32 v37, v31, v34, v37
  v_mov_b32 v36, v38
  ds_write_b64 v12, v[36:37] offset:896
  s_mov_b64 exec, -1

  v_lshlrev_b32 v34, 16, v8
  v_and_b32 v35, 0xffff0000, v8
  v_lshlrev_b32 v12, 3, v0
  v_add_u32 v12, 132224, v12
  ds_write_b64 v12, v[34:35]

  s_cmp_eq_u32 s70, 0
  s_cbranch_scc1 K1_nb26
  s_barrier
  s_sub_u32 s70, s70, 1
K1_nb26:

  s_mov_b32 s73, 65536
  s_lshl_b32 s60, s29, 11
  v_lshlrev_b32 v12, 4, v0
  v_add_u32 v13, s60, v12
  v_add_u32 v13, 4096, v13
  v_lshlrev_b32 v14, 4, v3
  v_add_u32 v14, 36864, v14
  v_and_b32 v15, 31, v0
  v_lshlrev_b32 v15, 4, v15
  v_lshrrev_b32 v34, 5, v0
  v_lshl_add_u32 v15, v34, 9, v15
  s_lshl_b32 s60, s33, 13
  v_add_u32 v15, s60, v15
  v_add_u32 v15, 262144, v15
  v_add_u32 v39, 4096, v15
  s_movk_i32 s74, 0
  s_cmp_eq_u32 s31, 1
  s_cselect_b32 s74, 8192, 0

  s_cmp_eq_u32 s70, 0
  s_cbranch_scc1 K1_nb27
  s_barrier
  s_sub_u32 s70, s70, 1
K1_nb27:
  s_waitcnt vmcnt(0)
  buffer_load_dwordx4 v[40:43], v13, s[36:39], 0 offen sc1
  buffer_load_dwordx4 v[44:47], v13, s[36:39], 0 offen offset:1024 sc1
  buffer_load_dwordx4 v[48:51], v14, s[36:39], 0 offen sc1
  buffer_load_dwordx4 v[52:55], v15, s[36:39], 0 offen offset:0 sc1
  buffer_load_dwordx4 v[56:59], v15, s[36:39], 0 offen offset:1024 sc1
  buffer_load_dwordx4 v[60:63], v15, s[36:39], 0 offen offset:2048 sc1
  buffer_load_dwordx4 v[64:67], v15, s[36:39], 0 offen offset:3072 sc1
  buffer_load_dwordx4 v[68:71], v39, s[36:39], 0 offen offset:0 sc1
  buffer_load_dwordx4 v[72:75], v39, s[36:39], 0 offen offset:1024 sc1
  buffer_load_dwordx4 v[76:79], v39, s[36:39], 0 offen offset:2048 sc1
  buffer_load_dwordx4 v[80:83], v39, s[36:39], 0 offen offset:3072 sc1
  buffer_load_dwordx4 v[84:87], v15, s[36:39], s74 offen offset:0 sc1
  buffer_load_dwordx4 v[88:91], v15, s[36:39], s74 offen offset:1024 sc1
  buffer_load_dwordx4 v[92:95], v15, s[36:39], s74 offen offset:2048 sc1
  buffer_load_dwordx4 v[96:99], v15, s[36:39], s74 offen offset:3072 sc1
  buffer_load_dwordx4 v[100:103], v39, s[36:39], s74 offen offset:0 sc1
  buffer_load_dwordx4 v[104:107], v39, s[36:39], s74 offen offset:1024 sc1
  buffer_load_dwordx4 v[108:111], v39, s[36:39], s74 offen offset:2048 sc1
  buffer_load_dwordx4 v[112:115], v39, s[36:39], s74 offen offset:3072 sc1
  v_lshrrev_b32 v121, 4, v0
  v_lshlrev_b32 v121, 2, v121
  v_bfe_u32 v122, v0, 2, 2
  v_add_u32 v121, v121, v122
  v_and_b32 v122, 7, v121
  v_bfe_u32 v123, v0, 1, 1
  v_xor_b32 v122, v122, v123
  v_lshlrev_b32 v121, 7, v121
  v_lshl_add_u32 v121, v122, 4, v121
  v_and_b32 v122, 1, v0
  v_lshl_add_u32 v121, v122, 3, v121
  v_add_u32 v121, 139264, v121
  v_xor_b32 v122, 32, v121
  v_xor_b32 v123, 64, v121
  v_xor_b32 v124, 0x60, v121
  v_lshlrev_b32 v125, 4, v0
  ds_read_b64_tr_b16 v[128:129], v121 offset:0
  ds_read_b64_tr_b16 v[130:131], v121 offset:2048
  ds_read_b64_tr_b16 v[132:133], v122 offset:0
  ds_read_b64_tr_b16 v[134:135], v122 offset:2048
  ds_read_b64_tr_b16 v[136:137], v123 offset:0
  ds_read_b64_tr_b16 v[138:139], v123 offset:2048
  ds_read_b64_tr_b16 v[140:141], v124 offset:0
  ds_read_b64_tr_b16 v[142:143], v124 offset:2048
  ds_read_b64_tr_b16 v[144:145], v121 offset:4096
  ds_read_b64_tr_b16 v[146:147], v121 offset:6144
  ds_read_b64_tr_b16 v[148:149], v122 offset:4096
  ds_read_b64_tr_b16 v[150:151], v122 offset:6144
  ds_read_b64_tr_b16 v[152:153], v123 offset:4096
  ds_read_b64_tr_b16 v[154:155], v123 offset:6144
  ds_read_b64_tr_b16 v[156:157], v124 offset:4096
  ds_read_b64_tr_b16 v[158:159], v124 offset:6144
  s_add_u32 s63, s91, 0
  s_mul_i32 s64, s63, 13108
  s_lshr_b32 s64, s64, 16
  s_mul_i32 s65, s64, 5
  s_sub_u32 s65, s63, s65
  s_mul_i32 s64, s64, 440
  s_add_u32 s64, s64, s90
  s_add_u32 s64, s64, s65
  s_lshl_b32 s64, s64, 10
  s_waitcnt lgkmcnt(14)
  buffer_store_dwordx4 v[128:131], v125, s[52:55], s64 offen sc1
  s_add_u32 s63, s91, 1
  s_mul_i32 s64, s63, 13108
  s_lshr_b32 s64, s64, 16
  s_mul_i32 s65, s64, 5
  s_sub_u32 s65, s63, s65
  s_mul_i32 s64, s64, 440
  s_add_u32 s64, s64, s90
  s_add_u32 s64, s64, s65
  s_lshl_b32 s64, s64, 10
  s_waitcnt lgkmcnt(12)
  buffer_store_dwordx4 v[132:135], v125, s[52:55], s64 offen sc1
  s_add_u32 s63, s91, 2
  s_mul_i32 s64, s63, 13108
  s_lshr_b32 s64, s64, 16
  s_mul_i32 s65, s64, 5
  s_sub_u32 s65, s63, s65
  s_mul_i32 s64, s64, 440
  s_add_u32 s64, s64, s90
  s_add_u32 s64, s64, s65
  s_lshl_b32 s64, s64, 10
  s_waitcnt lgkmcnt(10)
  buffer_store_dwordx4 v[136:139], v125, s[52:55], s64 offen sc1
  s_add_u32 s63, s91, 3
  s_mul_i32 s64, s63, 13108
  s_lshr_b32 s64, s64, 16
  s_mul_i32 s65, s64, 5
  s_sub_u32 s65, s63, s65
  s_mul_i32 s64, s64, 440
  s_add_u32 s64, s64, s90
  s_add_u32 s64, s64, s65
  s_lshl_b32 s64, s64, 10
  s_waitcnt lgkmcnt(8)
  buffer_store_dwordx4 v[140:143], v125, s[52:55], s64 offen sc1
  s_add_u32 s63, s93, 0
  s_mul_i32 s64, s63, 13108
  s_lshr_b32 s64, s64, 16
  s_mul_i32 s65, s64, 5
  s_sub_u32 s65, s63, s65
  s_mul_i32 s64, s64, 440
  s_add_u32 s64, s64, s92
  s_add_u32 s64, s64, s65
  s_lshl_b32 s64, s64, 10
  s_waitcnt lgkmcnt(6)
  buffer_store_dwordx4 v[144:147], v125, s[52:55], s64 offen sc1
  s_add_u32 s63, s93, 1
  s_mul_i32 s64, s63, 13108
  s_lshr_b32 s64, s64, 16
  s_mul_i32 s65, s64, 5
  s_sub_u32 s65, s63, s65
  s_mul_i32 s64, s64, 440
  s_add_u32 s64, s64, s92
  s_add_u32 s64, s64, s65
  s_lshl_b32 s64, s64, 10
  s_waitcnt lgkmcnt(4)
  buffer_store_dwordx4 v[148:151], v125, s[52:55], s64 offen sc1
  s_add_u32 s63, s93, 2
  s_mul_i32 s64, s63, 13108
  s_lshr_b32 s64, s64, 16
  s_mul_i32 s65, s64, 5
  s_sub_u32 s65, s63, s65
  s_mul_i32 s64, s64, 440
  s_add_u32 s64, s64, s92
  s_add_u32 s64, s64, s65
  s_lshl_b32 s64, s64, 10
  s_waitcnt lgkmcnt(2)
  buffer_store_dwordx4 v[152:155], v125, s[52:55], s64 offen sc1
  s_add_u32 s63, s93, 3
  s_mul_i32 s64, s63, 13108
  s_lshr_b32 s64, s64, 16
  s_mul_i32 s65, s64, 5
  s_sub_u32 s65, s63, s65
  s_mul_i32 s64, s64, 440
  s_add_u32 s64, s64, s92
  s_add_u32 s64, s64, s65
  s_lshl_b32 s64, s64, 10
  s_waitcnt lgkmcnt(0)
  buffer_store_dwordx4 v[156:159], v125, s[52:55], s64 offen sc1
  s_cmp_eq_u32 s70, 0
  s_cbranch_scc1 K1_nb28
  s_barrier
  s_sub_u32 s70, s70, 1
K1_nb28:
  v_and_b32 v121, 15, v0
  v_lshrrev_b32 v122, 5, v0
  v_and_b32 v123, 7, v121
  v_xor_b32 v122, v122, v123
  v_lshlrev_b32 v121, 7, v121
  v_lshl_add_u32 v121, v122, 4, v121
  v_bfe_u32 v122, v0, 4, 1
  v_lshl_add_u32 v121, v122, 3, v121
  v_add_u32 v121, 147456, v121
  v_xor_b32 v122, 32, v121
  v_xor_b32 v123, 64, v121
  v_xor_b32 v124, 0x60, v121
  ds_read_b64 v[160:161], v121 offset:0
  ds_read_b64 v[162:163], v121 offset:2048
  ds_read_b64 v[164:165], v122 offset:0
  ds_read_b64 v[166:167], v122 offset:2048
  ds_read_b64 v[168:169], v123 offset:0
  ds_read_b64 v[170:171], v123 offset:2048
  ds_read_b64 v[172:173], v124 offset:0
  ds_read_b64 v[174:175], v124 offset:2048
  ds_read_b64 v[176:177], v121 offset:4096
  ds_read_b64 v[178:179], v121 offset:6144
  ds_read_b64 v[180:181], v122 offset:4096
  ds_read_b64 v[182:183], v122 offset:6144
  ds_read_b64 v[184:185], v123 offset:4096
  ds_read_b64 v[186:187], v123 offset:6144
  ds_read_b64 v[188:189], v124 offset:4096
  ds_read_b64 v[190:191], v124 offset:6144
  s_add_u32 s64, s94, 0
  s_waitcnt lgkmcnt(14)
  buffer_store_dwordx4 v[160:163], v125, s[52:55], s64 offen sc1
  s_add_u32 s64, s94, 5120
  s_waitcnt lgkmcnt(12)
  buffer_store_dwordx4 v[164:167], v125, s[52:55], s64 offen sc1
  s_add_u32 s64, s94, 10240
  s_waitcnt lgkmcnt(10)
  buffer_store_dwordx4 v[168:171], v125, s[52:55], s64 offen sc1
  s_add_u32 s64, s94, 15360
  s_waitcnt lgkmcnt(8)
  buffer_store_dwordx4 v[172:175], v125, s[52:55], s64 offen sc1
  s_add_u32 s64, s95, 0
  s_waitcnt lgkmcnt(6)
  buffer_store_dwordx4 v[176:179], v125, s[52:55], s64 offen sc1
  s_add_u32 s64, s95, 5120
  s_waitcnt lgkmcnt(4)
  buffer_store_dwordx4 v[180:183], v125, s[52:55], s64 offen sc1
  s_add_u32 s64, s95, 10240
  s_waitcnt lgkmcnt(2)
  buffer_store_dwordx4 v[184:187], v125, s[52:55], s64 offen sc1
  s_add_u32 s64, s95, 15360
  s_waitcnt lgkmcnt(0)
  buffer_store_dwordx4 v[188:191], v125, s[52:55], s64 offen sc1
  s_cmp_eq_u32 s70, 0
  s_cbranch_scc1 K1_nb29
  s_barrier
  s_sub_u32 s70, s70, 1
K1_nb29:
  s_cmp_eq_u32 s70, 0
  s_cbranch_scc1 K1_nb30
  s_barrier
  s_sub_u32 s70, s70, 1
K1_nb30:
  s_waitcnt vmcnt(16)
  s_branch K1_gchk
K1_gather:
  buffer_load_dwordx4 v[40:43], v13, s[36:39], 0 offen sc1
  buffer_load_dwordx4 v[44:47], v13, s[36:39], 0 offen offset:1024 sc1
  buffer_load_dwordx4 v[48:51], v14, s[36:39], 0 offen sc1
  buffer_load_dwordx4 v[52:55], v15, s[36:39], 0 offen offset:0 sc1
  buffer_load_dwordx4 v[56:59], v15, s[36:39], 0 offen offset:1024 sc1
  buffer_load_dwordx4 v[60:63], v15, s[36:39], 0 offen offset:2048 sc1
  buffer_load_dwordx4 v[64:67], v15, s[36:39], 0 offen offset:3072 sc1
  buffer_load_dwordx4 v[68:71], v39, s[36:39], 0 offen offset:0 sc1
  buffer_load_dwordx4 v[72:75], v39, s[36:39], 0 offen offset:1024 sc1
  buffer_load_dwordx4 v[76:79], v39, s[36:39], 0 offen offset:2048 sc1
  buffer_load_dwordx4 v[80:83], v39, s[36:39], 0 offen offset:3072 sc1
  buffer_load_dwordx4 v[84:87], v15, s[36:39], s74 offen offset:0 sc1
  buffer_load_dwordx4 v[88:91], v15, s[36:39], s74 offen offset:1024 sc1
  buffer_load_dwordx4 v[92:95], v15, s[36:39], s74 offen offset:2048 sc1
  buffer_load_dwordx4 v[96:99], v15, s[36:39], s74 offen offset:3072 sc1
  buffer_load_dwordx4 v[100:103], v39, s[36:39], s74 offen offset:0 sc1
  buffer_load_dwordx4 v[104:107], v39, s[36:39], s74 offen offset:1024 sc1
  buffer_load_dwordx4 v[108:111], v39, s[36:39], s74 offen offset:2048 sc1
  buffer_load_dwordx4 v[112:115], v39, s[36:39], s74 offen offset:3072 sc1
  s_cmp_eq_u32 s70, 0
  s_cbranch_scc1 K1_nb31
  s_barrier
  s_sub_u32 s70, s70, 1
K1_nb31:
  s_cmp_eq_u32 s70, 0
  s_cbranch_scc1 K1_nb32
  s_barrier
  s_sub_u32 s70, s70, 1
K1_nb32:
  s_waitcnt vmcnt(0)
K1_gchk:
  v_mov_b32 v34, 0
  v_mov_b32 v35, s72
  v_xor_b32 v36, v35, v41
  v_xor_b32 v37, v35, v43
  v_or3_b32 v34, v34, v36, v37
  v_xor_b32 v36, v35, v45
  v_xor_b32 v37, v35, v47
  v_or3_b32 v34, v34, v36, v37
  v_xor_b32 v36, v35, v49
  v_xor_b32 v37, v35, v51
  v_or3_b32 v34, v34, v36, v37
  v_xor_b32 v36, v35, v53
  v_xor_b32 v37, v35, v55
  v_or3_b32 v34, v34, v36, v37
  v_xor_b32 v36, v35, v57
  v_xor_b32 v37, v35, v59
  v_or3_b32 v34, v34, v36, v37
  v_xor_b32 v36, v35, v61
  v_xor_b32 v37, v35, v63
  v_or3_b32 v34, v34, v36, v37
  v_xor_b32 v36, v35, v65
  v_xor_b32 v37, v35, v67
  v_or3_b32 v34, v34, v36, v37
  v_xor_b32 v36, v35, v69
  v_xor_b32 v37, v35, v71
  v_or3_b32 v34, v34, v36, v37
  v_xor_b32 v36, v35, v73
  v_xor_b32 v37, v35, v75
  v_or3_b32 v34, v34, v36, v37
  v_xor_b32 v36, v35, v77
  v_xor_b32 v37, v35, v79
  v_or3_b32 v34, v34, v36, v37
  v_xor_b32 v36, v35, v81
  v_xor_b32 v37, v35, v83
  v_or3_b32 v34, v34, v36, v37
  v_xor_b32 v36, v35, v85
  v_xor_b32 v37, v35, v87
  v_or3_b32 v34, v34, v36, v37
  v_xor_b32 v36, v35, v89
  v_xor_b32 v37, v35, v91
  v_or3_b32 v34, v34, v36, v37
  v_xor_b32 v36, v35, v93
  v_xor_b32 v37, v35, v95
  v_or3_b32 v34, v34, v36, v37
  v_xor_b32 v36, v35, v97
  v_xor_b32 v37, v35, v99
  v_or3_b32 v34, v34, v36, v37
  v_xor_b32 v36, v35, v101
  v_xor_b32 v37, v35, v103
  v_or3_b32 v34, v34, v36, v37
  v_xor_b32 v36, v35, v105
  v_xor_b32 v37, v35, v107
  v_or3_b32 v34, v34, v36, v37
  v_xor_b32 v36, v35, v109
  v_xor_b32 v37, v35, v111
  v_or3_b32 v34, v34, v36, v37
  v_xor_b32 v36, v35, v113
  v_xor_b32 v37, v35, v115
  v_or3_b32 v34, v34, v36, v37

  v_cmp_ne_u32 vcc, 0, v34
  s_cmp_eq_u64 vcc, 0
  s_cbranch_scc1 K1_gok
  s_sub_u32 s73, s73, 1
  s_cmp_lg_u32 s73, 0
  s_cbranch_scc1 K1_gather
K1_gok:

  v_lshrrev_b32 v34, 4, v0
  v_lshlrev_b32 v34, 6, v34
  v_and_b32 v35, 7, v0
  v_lshl_add_u32 v34, v35, 3, v34
  v_bfe_u32 v35, v0, 3, 1
  v_lshl_add_u32 v34, v35, 2, v34
  v_add_u32 v34, 123136, v34
  v_bfe_u32 v35, v0, 4, 2
  v_lshlrev_b32 v35, 2, v35
  v_and_b32 v36, 1, v0
  v_lshl_add_u32 v35, v36, 1, v35
  v_bfe_u32 v36, v0, 3, 1
  v_add_u32 v35, v35, v36
  v_lshlrev_b32 v35, 4, v35
  v_bfe_u32 v36, v0, 1, 2
  v_lshl_add_u32 v35, v36, 2, v35
  v_add_u32 v35, 124160, v35
  v_mul_f32 v36, v40, v42
  v_mul_f32 v37, v44, v46
  ds_write_b32 v34, v42
  ds_write_b32 v34, v46 offset:256
  ds_write_b32 v34, v36 offset:512
  ds_write_b32 v34, v37 offset:768
  ds_write_b32 v35, v42
  ds_write_b32 v35, v46 offset:256
  ds_write_b32 v35, v36 offset:512
  ds_write_b32 v35, v37 offset:768
  v_mov_b32 v36, v48
  v_mov_b32 v37, v50
  v_lshlrev_b32 v34, 3, v0
  v_add_u32 v34, 125184, v34
  s_mov_b32 exec_hi, 0xffff
  ds_write_b64 v34, v[36:37]
  s_mov_b64 exec, -1

  s_cmp_eq_u32 s70, 0
  s_cbranch_scc1 K1_nb33
  s_barrier
  s_sub_u32 s70, s70, 1
K1_nb33:
  v_add_f32 v52, v52, v56
  v_add_f32 v54, v54, v58
  v_add_f32 v52, v52, v60
  v_add_f32 v54, v54, v62
  v_add_f32 v52, v52, v64
  v_add_f32 v54, v54, v66
  v_add_f32 v52, v52, v68
  v_add_f32 v54, v54, v70
  v_add_f32 v52, v52, v72
  v_add_f32 v54, v54, v74
  v_add_f32 v52, v52, v76
  v_add_f32 v54, v54, v78
  v_add_f32 v52, v52, v80
  v_add_f32 v54, v54, v82
  v_mov_b32 v36, v52
  v_mov_b32 v37, v54
  v_mov_b32 v34, v52
  v_mov_b32 v35, v54
  s_nop 1
  v_permlane32_swap_b32 v36, v34
  v_permlane32_swap_b32 v37, v35
  s_nop 1
  v_add_f32 v36, v36, v34
  v_add_f32 v37, v37, v35
  v_and_b32 v34, 31, v0
  v_lshlrev_b32 v34, 3, v34
  v_add_u32 v34, 131712, v34
  ds_write_b64 v34, v[36:37]

  v_add_f32 v84, v84, v88
  v_add_f32 v86, v86, v90
  v_add_f32 v84, v84, v92
  v_add_f32 v86, v86, v94
  v_add_f32 v84, v84, v96
  v_add_f32 v86, v86, v98
  v_add_f32 v84, v84, v100
  v_add_f32 v86, v86, v102
  v_add_f32 v84, v84, v104
  v_add_f32 v86, v86, v106
  v_add_f32 v84, v84, v108
  v_add_f32 v86, v86, v110
  v_add_f32 v84, v84, v112
  v_add_f32 v86, v86, v114
  v_mov_b32 v36, v84
  v_mov_b32 v37, v86
  v_mov_b32 v34, v84
  v_mov_b32 v35, v86
  s_nop 1
  v_permlane32_swap_b32 v36, v34
  v_permlane32_swap_b32 v37, v35
  s_nop 1
  v_add_f32 v36, v36, v34
  v_add_f32 v37, v37, v35
  v_and_b32 v34, 31, v0
  v_lshlrev_b32 v34, 3, v34
  v_add_u32 v34, 131968, v34
  ds_write_b64 v34, v[36:37]

  v_mov_b32 v34, 122880
  v_mov_b32 v35, 1
  s_waitcnt lgkmcnt(0)
  ds_write_b32 v34, v35

K1_drain2:
  s_cmp_le_u32 s70, 3
  s_cbranch_scc1 K1_drained2
  s_barrier
  s_sub_u32 s70, s70, 1
  s_branch K1_drain2
K1_drained2:
  s_lshl_b32 s60, s2, 2
  s_add_u32 s60, s60, 524288
  v_mov_b32 v34, s60
  v_mov_b32 v35, s72
  s_waitcnt vmcnt(0)
  s_mov_b64 exec, 1
  buffer_store_dword v35, v34, s[36:39], 0 offen sc1
  s_mov_b64 exec, -1
K1_drain:
  s_cmp_eq_u32 s70, 0
  s_cbranch_scc1 K1_drained
  s_barrier
  s_sub_u32 s70, s70, 1
  s_branch K1_drain
K1_drained:

  s_mov_b32 s73, 65536
  v_lshlrev_b32 v14, 4, v3
  v_add_u32 v14, 65536, v14
  s_mov_b32 s75, 0
  v_lshlrev_b32 v164, 4, v0
  v_add_u32 v164, 524288, v164
  s_cmp_eq_u32 s29, 0
  s_cbranch_scc1 K1_czero

K1_cpoll:
  s_mov_b32 s60, 0
  buffer_load_dwordx4 v[40:43], v14, s[36:39], s60 offen sc1
  s_cmp_le_u32 s29, 1
  s_cbranch_scc1 K1_cld
  s_mov_b32 s60, 10240
  buffer_load_dwordx4 v[44:47], v14, s[36:39], s60 offen sc1
  s_cmp_le_u32 s29, 2
  s_cbranch_scc1 K1_cld
  s_mov_b32 s60, 20480
  buffer_load_dwordx4 v[48:51], v14, s[36:39], s60 offen sc1
  s_cmp_le_u32 s29, 3
  s_cbranch_scc1 K1_cld
  s_mov_b32 s60, 30720
  buffer_load_dwordx4 v[52:55], v14, s[36:39], s60 offen sc1
  s_cmp_le_u32 s29, 4
  s_cbranch_scc1 K1_cld
  s_mov_b32 s60, 40960
  buffer_load_dwordx4 v[56:59], v14, s[36:39], s60 offen sc1
  s_cmp_le_u32 s29, 5
  s_cbranch_scc1 K1_cld
  s_mov_b32 s60, 51200
  buffer_load_dwordx4 v[60:63], v14, s[36:39], s60 offen sc1
  s_cmp_le_u32 s29, 6
  s_cbranch_scc1 K1_cld
  s_mov_b32 s60, 61440
  buffer_load_dwordx4 v[64:67], v14, s[36:39], s60 offen sc1
  s_cmp_le_u32 s29, 7
  s_cbranch_scc1 K1_cld
  s_mov_b32 s60, 71680
  buffer_load_dwordx4 v[68:71], v14, s[36:39], s60 offen sc1
  s_cmp_le_u32 s29, 8
  s_cbranch_scc1 K1_cld
  s_mov_b32 s60, 81920
  buffer_load_dwordx4 v[72:75], v14, s[36:39], s60 offen sc1
  s_cmp_le_u32 s29, 9
  s_cbranch_scc1 K1_cld
  s_mov_b32 s60, 92160
  buffer_load_dwordx4 v[76:79], v14, s[36:39], s60 offen sc1
  s_cmp_le_u32 s29, 10
  s_cbranch_scc1 K1_cld
  s_mov_b32 s60, 102400
  buffer_load_dwordx4 v[80:83], v14, s[36:39], s60 offen sc1
  s_cmp_le_u32 s29, 11
  s_cbranch_scc1 K1_cld
  s_mov_b32 s60, 112640
  buffer_load_dwordx4 v[84:87], v14, s[36:39], s60 offen sc1
  s_cmp_le_u32 s29, 12
  s_cbranch_scc1 K1_cld
  s_mov_b32 s60, 122880
  buffer_load_dwordx4 v[88:91], v14, s[36:39], s60 offen sc1
  s_cmp_le_u32 s29, 13
  s_cbranch_scc1 K1_cld
  s_mov_b32 s60, 133120
  buffer_load_dwordx4 v[92:95], v14, s[36:39], s60 offen sc1
  s_cmp_le_u32 s29, 14
  s_cbranch_scc1 K1_cld
  s_mov_b32 s60, 143360
  buffer_load_dwordx4 v[96:99], v14, s[36:39], s60 offen sc1
  s_cmp_le_u32 s29, 15
  s_cbranch_scc1 K1_cld
K1_cld:
  s_waitcnt vmcnt(0)
  v_min_u32 v4, v41, v43
  v_max_u32 v5, v41, v43
  s_cmp_le_u32 s29, 1
  s_cbranch_scc1 K1_ctag
  v_min3_u32 v4, v4, v45, v47
  v_max3_u32 v5, v5, v45, v47
  s_cmp_le_u32 s29, 2
  s_cbranch_scc1 K1_ctag
  v_min3_u32 v4, v4, v49, v51
  v_max3_u32 v5, v5, v49, v51
  s_cmp_le_u32 s29, 3
  s_cbranch_scc1 K1_ctag
  v_min3_u32 v4, v4, v53, v55
  v_max3_u32 v5, v5, v53, v55
  s_cmp_le_u32 s29, 4
  s_cbranch_scc1 K1_ctag
  v_min3_u32 v4, v4, v57, v59
  v_max3_u32 v5, v5, v57, v59
  s_cmp_le_u32 s29, 5
  s_cbranch_scc1 K1_ctag
  v_min3_u32 v4, v4, v61, v63
  v_max3_u32 v5, v5, v61, v63
  s_cmp_le_u32 s29, 6
  s_cbranch_scc1 K1_ctag
  v_min3_u32 v4, v4, v65, v67
  v_max3_u32 v5, v5, v65, v67
  s_cmp_le_u32 s29, 7
  s_cbranch_scc1 K1_ctag
  v_min3_u32 v4, v4, v69, v71
  v_max3_u32 v5, v5, v69, v71
  s_cmp_le_u32 s29, 8
  s_cbranch_scc1 K1_ctag
  v_min3_u32 v4, v4, v73, v75
  v_max3_u32 v5, v5, v73, v75
  s_cmp_le_u32 s29, 9
  s_cbranch_scc1 K1_ctag
  v_min3_u32 v4, v4, v77, v79
  v_max3_u32 v5, v5, v77, v79
  s_cmp_le_u32 s29, 10
  s_cbranch_scc1 K1_ctag
  v_min3_u32 v4, v4, v81, v83
  v_max3_u32 v5, v5, v81, v83
  s_cmp_le_u32 s29, 11
  s_cbranch_scc1 K1_ctag
  v_min3_u32 v4, v4, v85, v87
  v_max3_u32 v5, v5, v85, v87
  s_cmp_le_u32 s29, 12
  s_cbranch_scc1 K1_ctag
  v_min3_u32 v4, v4, v89, v91
  v_max3_u32 v5, v5, v89, v91
  s_cmp_le_u32 s29, 13
  s_cbranch_scc1 K1_ctag
  v_min3_u32 v4, v4, v93, v95
  v_max3_u32 v5, v5, v93, v95
  s_cmp_le_u32 s29, 14
  s_cbranch_scc1 K1_ctag
  v_min3_u32 v4, v4, v97, v99
  v_max3_u32 v5, v5, v97, v99
K1_ctag:
  v_xor_b32 v4, s72, v4
  v_xor_b32 v5, s72, v5
  v_or_b32 v34, v4, v5
  s_mov_b32 exec_hi, 0xffff
  v_cmp_ne_u32 vcc, 0, v34
  s_mov_b64 exec, -1
  s_cmp_eq_u64 vcc, 0
  s_cbranch_scc0 K1_cfail
  v_mov_b32 v36, v40
  v_mov_b32 v37, v42
  s_cmp_le_u32 s29, 1
  s_cbranch_scc1 K1_chx_1
  v_fma_f32 v4, v32, v36, v44
  v_fma_f32 v5, v32, v37, v46
  v_fma_f32 v4, -v33, v37, v4
  v_fma_f32 v5, v33, v36, v5
  s_cmp_le_u32 s29, 2
  s_cbranch_scc1 K1_chx_2
  v_fma_f32 v36, v32, v4, v48
  v_fma_f32 v37, v32, v5, v50
  v_fma_f32 v36, -v33, v5, v36
  v_fma_f32 v37, v33, v4, v37
  s_cmp_le_u32 s29, 3
  s_cbranch_scc1 K1_chx_3
  v_fma_f32 v4, v32, v36, v52
  v_fma_f32 v5, v32, v37, v54
  v_fma_f32 v4, -v33, v37, v4
  v_fma_f32 v5, v33, v36, v5
  s_cmp_le_u32 s29, 4
  s_cbranch_scc1 K1_chx_4
  v_fma_f32 v36, v32, v4, v56
  v_fma_f32 v37, v32, v5, v58
  v_fma_f32 v36, -v33, v5, v36
  v_fma_f32 v37, v33, v4, v37
  s_cmp_le_u32 s29, 5
  s_cbranch_scc1 K1_chx_5
  v_fma_f32 v4, v32, v36, v60
  v_fma_f32 v5, v32, v37, v62
  v_fma_f32 v4, -v33, v37, v4
  v_fma_f32 v5, v33, v36, v5
  s_cmp_le_u32 s29, 6
  s_cbranch_scc1 K1_chx_6
  v_fma_f32 v36, v32, v4, v64
  v_fma_f32 v37, v32, v5, v66
  v_fma_f32 v36, -v33, v5, v36
  v_fma_f32 v37, v33, v4, v37
  s_cmp_le_u32 s29, 7
  s_cbranch_scc1 K1_chx_7
  v_fma_f32 v4, v32, v36, v68
  v_fma_f32 v5, v32, v37, v70
  v_fma_f32 v4, -v33, v37, v4
  v_fma_f32 v5, v33, v36, v5
  s_cmp_le_u32 s29, 8
  s_cbranch_scc1 K1_chx_8
  v_fma_f32 v36, v32, v4, v72
  v_fma_f32 v37, v32, v5, v74
  v_fma_f32 v36, -v33, v5, v36
  v_fma_f32 v37, v33, v4, v37
  s_cmp_le_u32 s29, 9
  s_cbranch_scc1 K1_chx_9
  v_fma_f32 v4, v32, v36, v76
  v_fma_f32 v5, v32, v37, v78
  v_fma_f32 v4, -v33, v37, v4
  v_fma_f32 v5, v33, v36, v5
  s_cmp_le_u32 s29, 10
  s_cbranch_scc1 K1_chx_10
  v_fma_f32 v36, v32, v4, v80
  v_fma_f32 v37, v32, v5, v82
  v_fma_f32 v36, -v33, v5, v36
  v_fma_f32 v37, v33, v4, v37
  s_cmp_le_u32 s29, 11
  s_cbranch_scc1 K1_chx_11
  v_fma_f32 v4, v32, v36, v84
  v_fma_f32 v5, v32, v37, v86
  v_fma_f32 v4, -v33, v37, v4
  v_fma_f32 v5, v33, v36, v5
  s_cmp_le_u32 s29, 12
  s_cbranch_scc1 K1_chx_12
  v_fma_f32 v36, v32, v4, v88
  v_fma_f32 v37, v32, v5, v90
  v_fma_f32 v36, -v33, v5, v36
  v_fma_f32 v37, v33, v4, v37
  s_cmp_le_u32 s29, 13
  s_cbranch_scc1 K1_chx_13
  v_fma_f32 v4, v32, v36, v92
  v_fma_f32 v5, v32, v37, v94
  v_fma_f32 v4, -v33, v37, v4
  v_fma_f32 v5, v33, v36, v5
  s_cmp_le_u32 s29, 14
  s_cbranch_scc1 K1_chx_14
  v_fma_f32 v36, v32, v4, v96
  v_fma_f32 v37, v32, v5, v98
  v_fma_f32 v36, -v33, v5, v36
  v_fma_f32 v37, v33, v4, v37
  s_branch K1_cok
K1_chx_1:
K1_chx_3:
K1_chx_5:
K1_chx_7:
K1_chx_9:
K1_chx_11:
K1_chx_13:
  s_branch K1_cok
K1_chx_2:
K1_chx_4:
K1_chx_6:
K1_chx_8:
K1_chx_10:
K1_chx_12:
K1_chx_14:
  v_mov_b32 v36, v4
  v_mov_b32 v37, v5
  s_branch K1_cok
K1_cfail:
  s_sub_u32 s73, s73, 1
  s_cmp_lg_u32 s73, 0
  s_cbranch_scc1 K1_cpoll
  s_branch K1_cok
K1_czero:
  v_mov_b32 v36, 0
  v_mov_b32 v37, 0
K1_cok:
  v_lshlrev_b32 v34, 3, v0
  v_add_u32 v34, 138496, v34
  s_mov_b32 exec_hi, 0xffff
  ds_write_b64 v34, v[36:37]
  s_mov_b64 exec, -1
  v_mov_b32 v34, 122884
  v_mov_b32 v35, 1
  s_waitcnt lgkmcnt(0)
  ds_write_b32 v34, v35

  s_cmp_eq_u32 s29, 15
  s_cbranch_scc0 K1_nobump
  s_cmp_eq_u32 s30, 0
  s_cbranch_scc0 K1_nobump
  s_add_u32 s71, s71, 1
  v_mov_b32 v35, s71
  v_mov_b32 v34, 0
  s_mov_b64 exec, 1
  buffer_store_dword v35, v34, s[36:39], 0 offen sc1
  s_waitcnt vmcnt(0)
K1_nobump:
  s_mov_b64 exec, -1
  s_branch K2_loader
K2_loader:
  s_setprio 3
  s_load_dwordx2 s[4:5], s[0:1], 0
  s_load_dwordx2 s[6:7], s[0:1], 64
  s_load_dwordx2 s[8:9], s[0:1], 104
  s_load_dwordx2 s[12:13], s[0:1], 112
  s_load_dwordx2 s[10:11], s[0:1], 128
  s_and_b32 s60, s2, 7
  s_lshr_b32 s61, s2, 3
  s_and_b32 s62, s60, 1
  s_lshl_b32 s62, s62, 2
  s_and_b32 s63, s61, 3
  s_add_u32 s64, s62, s63

  s_lshr_b32 s62, s61, 3
  s_lshl_b32 s62, s62, 2
  s_lshr_b32 s63, s60, 1
  s_add_u32 s62, s62, s63
  s_lshl_b32 s62, s62, 1
  s_bfe_u32 s63, s61, 0x10002
  s_add_u32 s65, s62, s63
  s_and_b32 s61, s28, 3
  s_waitcnt lgkmcnt(0)
  s_mov_b32 s24, s8
  s_and_b32 s25, s9, 0xffff
  s_mov_b32 s26, 1280
  s_mov_b32 s27, 0x20000
  s_add_u32 s32, s10, 1048576
  s_addc_u32 s33, s11, 0
  s_and_b32 s33, s33, 0xffff
  s_mov_b32 s34, 11534336
  s_mov_b32 s35, 0x20000
  s_add_u32 s52, s10, 12582912
  s_addc_u32 s53, s11, 0
  s_and_b32 s53, s53, 0xffff
  s_mov_b32 s54, 3604480
  s_mov_b32 s55, 0x20000
  s_mov_b32 s36, s10
  s_and_b32 s37, s11, 0xffff
  s_mov_b32 s38, 1048576
  s_mov_b32 s39, 0x20000
  v_lshlrev_b32 v3, 4, v0
  s_add_u32 s62, s61, 0
  s_mul_i32 s63, s64, 450560
  s_mul_i32 s60, s62, 5120
  s_add_u32 s63, s63, s60
  v_add_u32 v1, s63, v3
  s_mul_i32 s63, s65, 360448
  s_lshl_b32 s60, s62, 10
  s_add_u32 s63, s63, s60
  v_add_u32 v2, s63, v3
  s_add_u32 s66, s61, 0
  s_and_b32 s66, s66, 3
  s_mul_i32 s66, s66, 90112
  s_add_u32 s67, s61, 1
  s_and_b32 s67, s67, 3
  s_mul_i32 s67, s67, 90112
  s_add_u32 s68, s61, 2
  s_and_b32 s68, s68, 3
  s_mul_i32 s68, s68, 90112
  s_add_u32 s69, s61, 3
  s_and_b32 s69, s69, 3
  s_mul_i32 s69, s69, 90112
  v_lshrrev_b32 v6, 4, v0
  s_mul_i32 s63, s64, 80
  v_lshl_add_u32 v5, v6, 2, s63
  v_lshlrev_b32 v5, 1, v5
  buffer_load_dwordx2 v[242:243], v5, s[24:27], 0 offen offset:0
  buffer_load_dwordx2 v[244:245], v5, s[24:27], 0 offen offset:32
  buffer_load_dwordx2 v[246:247], v5, s[24:27], 0 offen offset:64
  buffer_load_dwordx2 v[248:249], v5, s[24:27], 0 offen offset:96
  buffer_load_dwordx2 v[250:251], v5, s[24:27], 0 offen offset:128
  v_mov_b32 v8, 122912
  ds_read_b32 v8, v8
  v_add_u32 v9, 524288, v3
  s_mov_b32 s73, 65536
  s_waitcnt lgkmcnt(0)
  v_mov_b32 v254, 122928
K2f_fd:
  ds_read_b128 v[16:19], v254
  s_waitcnt lgkmcnt(0)
  v_and_b32 v16, v16, v17
  v_and_b32 v18, v18, v19
  v_and_b32 v16, v16, v18
  s_nop 0
  v_readfirstlane_b32 s60, v16
  s_and_b32 s60, s60, -1
  s_cbranch_scc0 K2f_fd
  s_cmp_eq_u32 s61, 0
  s_cbranch_scc0 K2f_nopoll
K2f_wpoll:
  buffer_load_dwordx4 v[12:15], v9, s[36:39], 0 offen sc1
  s_waitcnt vmcnt(0)
  v_xor_b32 v12, v12, v8
  v_xor_b32 v13, v13, v8
  v_xor_b32 v14, v14, v8
  v_xor_b32 v15, v15, v8
  v_or3_b32 v12, v12, v13, v14
  v_or_b32 v12, v12, v15
  v_cmp_ne_u32 vcc, 0, v12
  s_cmp_eq_u64 vcc, 0
  s_cbranch_scc1 K2f_wok
  s_sub_u32 s73, s73, 1
  s_cmp_lg_u32 s73, 0
  s_cbranch_scc1 K2f_wpoll
K2f_wok:
  v_mov_b32 v254, 122920
  v_mov_b32 v255, 1
  ds_write_b32 v254, v255
  s_branch K2f_go
K2f_nopoll:
  v_mov_b32 v254, 122920
K2f_w:
  ds_read_b32 v255, v254 offset:0
  s_waitcnt lgkmcnt(0)
  v_readfirstlane_b32 s60, v255
  s_cmp_eq_u32 s60, 0
  s_cbranch_scc1 K2f_w
K2f_go:
  s_mov_b32 s70, 0
  s_mov_b32 s71, 4096
  buffer_load_dwordx4 v[88:91], v1, s[52:55], s70 offen offset:0
  buffer_load_dwordx4 v[92:95], v1, s[52:55], s70 offen offset:1024
  buffer_load_dwordx4 v[96:99], v1, s[52:55], s70 offen offset:2048
  buffer_load_dwordx4 v[100:103], v1, s[52:55], s70 offen offset:3072
  buffer_load_dwordx4 v[104:107], v1, s[52:55], s71 offen
  s_mov_b32 s70, 20480
  s_mov_b32 s71, 24576
  buffer_load_dwordx4 v[124:127], v1, s[52:55], s70 offen offset:0
  buffer_load_dwordx4 v[128:131], v1, s[52:55], s70 offen offset:1024
  buffer_load_dwordx4 v[132:135], v1, s[52:55], s70 offen offset:2048
  buffer_load_dwordx4 v[136:139], v1, s[52:55], s70 offen offset:3072
  buffer_load_dwordx4 v[140:143], v1, s[52:55], s71 offen
  s_mul_i32 s31, s61, 15360
  s_mov_b32 s70, 81920
  s_add_u32 m0, s31, 0
  s_mov_b32 s71, 86016
  buffer_load_dwordx4 v1, s[52:55], s70 offen offset:0 lds
  buffer_load_dwordx4 v1, s[52:55], s70 offen offset:1024 lds
  buffer_load_dwordx4 v1, s[52:55], s70 offen offset:2048 lds
  buffer_load_dwordx4 v1, s[52:55], s70 offen offset:3072 lds
  s_add_u32 m0, s31, 4096
  s_nop 0
  buffer_load_dwordx4 v1, s[52:55], s71 offen lds
  s_mov_b32 s70, 102400
  s_add_u32 m0, s31, 5120
  s_mov_b32 s71, 106496
  buffer_load_dwordx4 v1, s[52:55], s70 offen offset:0 lds
  buffer_load_dwordx4 v1, s[52:55], s70 offen offset:1024 lds
  buffer_load_dwordx4 v1, s[52:55], s70 offen offset:2048 lds
  buffer_load_dwordx4 v1, s[52:55], s70 offen offset:3072 lds
  s_add_u32 m0, s31, 9216
  s_nop 0
  buffer_load_dwordx4 v1, s[52:55], s71 offen lds
  s_mov_b32 s70, 122880
  s_add_u32 m0, s31, 10240
  s_mov_b32 s71, 126976
  buffer_load_dwordx4 v1, s[52:55], s70 offen offset:0 lds
  buffer_load_dwordx4 v1, s[52:55], s70 offen offset:1024 lds
  buffer_load_dwordx4 v1, s[52:55], s70 offen offset:2048 lds
  buffer_load_dwordx4 v1, s[52:55], s70 offen offset:3072 lds
  s_add_u32 m0, s31, 14336
  s_nop 0
  buffer_load_dwordx4 v1, s[52:55], s71 offen lds
  v_mov_b32 v254, 122944
K2f_p2g:
  ds_read_b128 v[16:19], v254
  s_waitcnt lgkmcnt(0)
  v_and_b32 v16, v16, v17
  v_and_b32 v18, v18, v19
  v_and_b32 v16, v16, v18
  s_nop 0
  v_readfirstlane_b32 s60, v16
  s_and_b32 s60, s60, -1
  s_cbranch_scc0 K2f_p2g
  s_mov_b32 s70, 40960
  s_mov_b32 s71, 45056
  buffer_load_dwordx4 v[160:163], v1, s[52:55], s70 offen offset:0
  buffer_load_dwordx4 v[164:167], v1, s[52:55], s70 offen offset:1024
  buffer_load_dwordx4 v[168:171], v1, s[52:55], s70 offen offset:2048
  buffer_load_dwordx4 v[172:175], v1, s[52:55], s70 offen offset:3072
  buffer_load_dwordx4 v[176:179], v1, s[52:55], s71 offen
  s_mov_b32 s70, 61440
  s_mov_b32 s71, 65536
  buffer_load_dwordx4 v[196:199], v1, s[52:55], s70 offen offset:0
  buffer_load_dwordx4 v[200:203], v1, s[52:55], s70 offen offset:1024
  buffer_load_dwordx4 v[204:207], v1, s[52:55], s70 offen offset:2048
  buffer_load_dwordx4 v[208:211], v1, s[52:55], s70 offen offset:3072
  buffer_load_dwordx4 v[212:215], v1, s[52:55], s71 offen
  s_cmp_eq_u32 s61, 0
  s_cbranch_scc0 K2f_nohf
  v_and_b32 v9, 31, v0
  v_lshlrev_b32 v9, 2, v9
  s_lshl_b32 s62, s65, 7
  s_add_u32 s62, s62, 528384
  v_add_u32 v9, s62, v9
  s_mov_b32 s73, 65536
K2f_hpoll:
  buffer_load_dword v12, v9, s[36:39], 0 offen sc1
  s_waitcnt vmcnt(0)
  v_cmp_ne_u32 vcc, v8, v12
  s_cmp_eq_u64 vcc, 0
  s_cbranch_scc1 K2f_hok
  s_sub_u32 s73, s73, 1
  s_cmp_lg_u32 s73, 0
  s_cbranch_scc1 K2f_hpoll
K2f_hok:
  v_mov_b32 v254, 122916
  v_mov_b32 v255, 1
  ds_write_b32 v254, v255
K2f_nohf:
  s_waitcnt vmcnt(35)
  v_lshlrev_b32 v8, 16, v242
  v_and_b32 v9, 0xffff0000, v242
  v_lshlrev_b32 v10, 16, v243
  v_and_b32 v11, 0xffff0000, v243
  v_lshlrev_b32 v12, 16, v244
  v_and_b32 v13, 0xffff0000, v244
  v_lshlrev_b32 v14, 16, v245
  v_and_b32 v15, 0xffff0000, v245
  v_lshlrev_b32 v16, 16, v246
  v_and_b32 v17, 0xffff0000, v246
  v_lshlrev_b32 v18, 16, v247
  v_and_b32 v19, 0xffff0000, v247
  v_lshlrev_b32 v20, 16, v248
  v_and_b32 v21, 0xffff0000, v248
  v_lshlrev_b32 v22, 16, v249
  v_and_b32 v23, 0xffff0000, v249
  v_lshlrev_b32 v24, 16, v250
  v_and_b32 v25, 0xffff0000, v250
  v_lshlrev_b32 v26, 16, v251
  v_and_b32 v27, 0xffff0000, v251
  v_mov_b32 v28, 0
  v_mov_b32 v29, 0
  v_mov_b32 v30, 0
  v_mov_b32 v31, 0
  v_mov_b32 v32, 0
  v_mov_b32 v33, 0
  v_mov_b32 v34, 0
  v_mov_b32 v35, 0
  v_mov_b32 v36, 0
  v_mov_b32 v37, 0
  v_mov_b32 v38, 0
  v_mov_b32 v39, 0
  v_mov_b32 v40, 0
  v_mov_b32 v41, 0
  v_mov_b32 v42, 0
  v_mov_b32 v43, 0
  v_mov_b32 v44, 0
  v_mov_b32 v45, 0
  v_mov_b32 v46, 0
  v_mov_b32 v47, 0
  v_mov_b32 v48, 0
  v_mov_b32 v49, 0
  v_mov_b32 v50, 0
  v_mov_b32 v51, 0
  v_mov_b32 v52, 0
  v_mov_b32 v53, 0
  v_mov_b32 v54, 0
  v_mov_b32 v55, 0
  v_mov_b32 v56, 0
  v_mov_b32 v57, 0
  v_mov_b32 v58, 0
  v_mov_b32 v59, 0
  v_mov_b32 v60, 0
  v_mov_b32 v61, 0
  v_mov_b32 v62, 0
  v_mov_b32 v63, 0
  v_mov_b32 v64, 0
  v_mov_b32 v65, 0
  v_mov_b32 v66, 0
  v_mov_b32 v67, 0
  v_mov_b32 v68, 0
  v_mov_b32 v69, 0
  v_mov_b32 v70, 0
  v_mov_b32 v71, 0
  v_mov_b32 v72, 0
  v_mov_b32 v73, 0
  v_mov_b32 v74, 0
  v_mov_b32 v75, 0
  v_mov_b32 v76, 0
  v_mov_b32 v77, 0
  v_mov_b32 v78, 0
  v_mov_b32 v79, 0
  v_mov_b32 v80, 0
  v_mov_b32 v81, 0
  v_mov_b32 v82, 0
  v_mov_b32 v83, 0
  v_mov_b32 v84, 0
  v_mov_b32 v85, 0
  v_mov_b32 v86, 0
  v_mov_b32 v87, 0
  v_mov_b32 v254, 122916
K2f_hf:
  ds_read_b32 v255, v254 offset:0
  s_waitcnt lgkmcnt(0)
  v_readfirstlane_b32 s60, v255
  s_cmp_eq_u32 s60, 0
  s_cbranch_scc1 K2f_hf
  buffer_load_dwordx4 v[108:111], v2, s[32:35], s66 offen
  s_add_u32 s66, s66, 4096
  buffer_load_dwordx4 v[112:115], v2, s[32:35], s67 offen
  s_add_u32 s67, s67, 4096
  buffer_load_dwordx4 v[116:119], v2, s[32:35], s68 offen
  s_add_u32 s68, s68, 4096
  buffer_load_dwordx4 v[120:123], v2, s[32:35], s69 offen
  s_add_u32 s69, s69, 4096
  buffer_load_dwordx4 v[144:147], v2, s[32:35], s66 offen
  s_add_u32 s66, s66, 4096
  buffer_load_dwordx4 v[148:151], v2, s[32:35], s67 offen
  s_add_u32 s67, s67, 4096
  buffer_load_dwordx4 v[152:155], v2, s[32:35], s68 offen
  s_add_u32 s68, s68, 4096
  buffer_load_dwordx4 v[156:159], v2, s[32:35], s69 offen
  s_add_u32 s69, s69, 4096
  buffer_load_dwordx4 v[180:183], v2, s[32:35], s66 offen
  s_add_u32 s66, s66, 4096
  buffer_load_dwordx4 v[184:187], v2, s[32:35], s67 offen
  s_add_u32 s67, s67, 4096
  buffer_load_dwordx4 v[188:191], v2, s[32:35], s68 offen
  s_add_u32 s68, s68, 4096
  buffer_load_dwordx4 v[192:195], v2, s[32:35], s69 offen
  s_add_u32 s69, s69, 4096
  buffer_load_dwordx4 v[216:219], v2, s[32:35], s66 offen
  s_add_u32 s66, s66, 4096
  buffer_load_dwordx4 v[220:223], v2, s[32:35], s67 offen
  s_add_u32 s67, s67, 4096
  buffer_load_dwordx4 v[224:227], v2, s[32:35], s68 offen
  s_add_u32 s68, s68, 4096
  buffer_load_dwordx4 v[228:231], v2, s[32:35], s69 offen
  s_add_u32 s69, s69, 4096
  s_waitcnt vmcnt(12)
  v_add_u32 v7, s31, v3
  v_mfma_f32_16x16x32_bf16 v[8:11], v[88:91], v[108:111], v[8:11]
  v_mfma_f32_16x16x32_bf16 v[12:15], v[92:95], v[108:111], v[12:15]
  v_mfma_f32_16x16x32_bf16 v[16:19], v[96:99], v[108:111], v[16:19]
  v_mfma_f32_16x16x32_bf16 v[20:23], v[100:103], v[108:111], v[20:23]
  v_mfma_f32_16x16x32_bf16 v[24:27], v[104:107], v[108:111], v[24:27]
  buffer_load_dwordx4 v[108:111], v2, s[32:35], s66 offen
  s_add_u32 s66, s66, 4096
  v_mfma_f32_16x16x32_bf16 v[28:31], v[88:91], v[112:115], v[28:31]
  v_mfma_f32_16x16x32_bf16 v[32:35], v[92:95], v[112:115], v[32:35]
  v_mfma_f32_16x16x32_bf16 v[36:39], v[96:99], v[112:115], v[36:39]
  v_mfma_f32_16x16x32_bf16 v[40:43], v[100:103], v[112:115], v[40:43]
  v_mfma_f32_16x16x32_bf16 v[44:47], v[104:107], v[112:115], v[44:47]
  buffer_load_dwordx4 v[112:115], v2, s[32:35], s67 offen
  s_add_u32 s67, s67, 4096
  v_mfma_f32_16x16x32_bf16 v[48:51], v[88:91], v[116:119], v[48:51]
  v_mfma_f32_16x16x32_bf16 v[52:55], v[92:95], v[116:119], v[52:55]
  v_mfma_f32_16x16x32_bf16 v[56:59], v[96:99], v[116:119], v[56:59]
  v_mfma_f32_16x16x32_bf16 v[60:63], v[100:103], v[116:119], v[60:63]
  v_mfma_f32_16x16x32_bf16 v[64:67], v[104:107], v[116:119], v[64:67]
  buffer_load_dwordx4 v[116:119], v2, s[32:35], s68 offen
  s_add_u32 s68, s68, 4096
  v_mfma_f32_16x16x32_bf16 v[68:71], v[88:91], v[120:123], v[68:71]
  s_waitcnt vmcnt(39)
  ds_read_b128 v[88:91], v7 offset:0
  v_mfma_f32_16x16x32_bf16 v[72:75], v[92:95], v[120:123], v[72:75]
  ds_read_b128 v[92:95], v7 offset:1024
  v_mfma_f32_16x16x32_bf16 v[76:79], v[96:99], v[120:123], v[76:79]
  ds_read_b128 v[96:99], v7 offset:2048
  v_mfma_f32_16x16x32_bf16 v[80:83], v[100:103], v[120:123], v[80:83]
  ds_read_b128 v[100:103], v7 offset:3072
  v_mfma_f32_16x16x32_bf16 v[84:87], v[104:107], v[120:123], v[84:87]
  ds_read_b128 v[104:107], v7 offset:4096
  buffer_load_dwordx4 v[120:123], v2, s[32:35], s69 offen
  s_add_u32 s69, s69, 4096
  s_waitcnt vmcnt(12)
  v_mfma_f32_16x16x32_bf16 v[8:11], v[124:127], v[144:147], v[8:11]
  v_mfma_f32_16x16x32_bf16 v[12:15], v[128:131], v[144:147], v[12:15]
  v_mfma_f32_16x16x32_bf16 v[16:19], v[132:135], v[144:147], v[16:19]
  v_mfma_f32_16x16x32_bf16 v[20:23], v[136:139], v[144:147], v[20:23]
  v_mfma_f32_16x16x32_bf16 v[24:27], v[140:143], v[144:147], v[24:27]
  buffer_load_dwordx4 v[144:147], v2, s[32:35], s66 offen
  s_add_u32 s66, s66, 4096
  v_mfma_f32_16x16x32_bf16 v[28:31], v[124:127], v[148:151], v[28:31]
  v_mfma_f32_16x16x32_bf16 v[32:35], v[128:131], v[148:151], v[32:35]
  v_mfma_f32_16x16x32_bf16 v[36:39], v[132:135], v[148:151], v[36:39]
  v_mfma_f32_16x16x32_bf16 v[40:43], v[136:139], v[148:151], v[40:43]
  v_mfma_f32_16x16x32_bf16 v[44:47], v[140:143], v[148:151], v[44:47]
  buffer_load_dwordx4 v[148:151], v2, s[32:35], s67 offen
  s_add_u32 s67, s67, 4096
  v_mfma_f32_16x16x32_bf16 v[48:51], v[124:127], v[152:155], v[48:51]
  v_mfma_f32_16x16x32_bf16 v[52:55], v[128:131], v[152:155], v[52:55]
  v_mfma_f32_16x16x32_bf16 v[56:59], v[132:135], v[152:155], v[56:59]
  v_mfma_f32_16x16x32_bf16 v[60:63], v[136:139], v[152:155], v[60:63]
  v_mfma_f32_16x16x32_bf16 v[64:67], v[140:143], v[152:155], v[64:67]
  buffer_load_dwordx4 v[152:155], v2, s[32:35], s68 offen
  s_add_u32 s68, s68, 4096
  v_mfma_f32_16x16x32_bf16 v[68:71], v[124:127], v[156:159], v[68:71]
  s_waitcnt vmcnt(38)
  ds_read_b128 v[124:127], v7 offset:5120
  v_mfma_f32_16x16x32_bf16 v[72:75], v[128:131], v[156:159], v[72:75]
  ds_read_b128 v[128:131], v7 offset:6144
  v_mfma_f32_16x16x32_bf16 v[76:79], v[132:135], v[156:159], v[76:79]
  ds_read_b128 v[132:135], v7 offset:7168
  v_mfma_f32_16x16x32_bf16 v[80:83], v[136:139], v[156:159], v[80:83]
  ds_read_b128 v[136:139], v7 offset:8192
  v_mfma_f32_16x16x32_bf16 v[84:87], v[140:143], v[156:159], v[84:87]
  ds_read_b128 v[140:143], v7 offset:9216
  buffer_load_dwordx4 v[156:159], v2, s[32:35], s69 offen
  s_add_u32 s69, s69, 4096
  s_waitcnt vmcnt(12)
  v_mfma_f32_16x16x32_bf16 v[8:11], v[160:163], v[180:183], v[8:11]
  v_mfma_f32_16x16x32_bf16 v[12:15], v[164:167], v[180:183], v[12:15]
  v_mfma_f32_16x16x32_bf16 v[16:19], v[168:171], v[180:183], v[16:19]
  v_mfma_f32_16x16x32_bf16 v[20:23], v[172:175], v[180:183], v[20:23]
  v_mfma_f32_16x16x32_bf16 v[24:27], v[176:179], v[180:183], v[24:27]
  buffer_load_dwordx4 v[180:183], v2, s[32:35], s66 offen
  s_add_u32 s66, s66, 4096
  v_mfma_f32_16x16x32_bf16 v[28:31], v[160:163], v[184:187], v[28:31]
  v_mfma_f32_16x16x32_bf16 v[32:35], v[164:167], v[184:187], v[32:35]
  v_mfma_f32_16x16x32_bf16 v[36:39], v[168:171], v[184:187], v[36:39]
  v_mfma_f32_16x16x32_bf16 v[40:43], v[172:175], v[184:187], v[40:43]
  v_mfma_f32_16x16x32_bf16 v[44:47], v[176:179], v[184:187], v[44:47]
  buffer_load_dwordx4 v[184:187], v2, s[32:35], s67 offen
  s_add_u32 s67, s67, 4096
  v_mfma_f32_16x16x32_bf16 v[48:51], v[160:163], v[188:191], v[48:51]
  v_mfma_f32_16x16x32_bf16 v[52:55], v[164:167], v[188:191], v[52:55]
  v_mfma_f32_16x16x32_bf16 v[56:59], v[168:171], v[188:191], v[56:59]
  v_mfma_f32_16x16x32_bf16 v[60:63], v[172:175], v[188:191], v[60:63]
  v_mfma_f32_16x16x32_bf16 v[64:67], v[176:179], v[188:191], v[64:67]
  buffer_load_dwordx4 v[188:191], v2, s[32:35], s68 offen
  s_add_u32 s68, s68, 4096
  v_mfma_f32_16x16x32_bf16 v[68:71], v[160:163], v[192:195], v[68:71]
  s_waitcnt vmcnt(37)
  ds_read_b128 v[160:163], v7 offset:10240
  v_mfma_f32_16x16x32_bf16 v[72:75], v[164:167], v[192:195], v[72:75]
  ds_read_b128 v[164:167], v7 offset:11264
  v_mfma_f32_16x16x32_bf16 v[76:79], v[168:171], v[192:195], v[76:79]
  ds_read_b128 v[168:171], v7 offset:12288
  v_mfma_f32_16x16x32_bf16 v[80:83], v[172:175], v[192:195], v[80:83]
  ds_read_b128 v[172:175], v7 offset:13312
  v_mfma_f32_16x16x32_bf16 v[84:87], v[176:179], v[192:195], v[84:87]
  ds_read_b128 v[176:179], v7 offset:14336
  buffer_load_dwordx4 v[192:195], v2, s[32:35], s69 offen
  s_add_u32 s69, s69, 4096
  s_waitcnt vmcnt(12)
  v_mfma_f32_16x16x32_bf16 v[8:11], v[196:199], v[216:219], v[8:11]
  v_mfma_f32_16x16x32_bf16 v[12:15], v[200:203], v[216:219], v[12:15]
  v_mfma_f32_16x16x32_bf16 v[16:19], v[204:207], v[216:219], v[16:19]
  v_mfma_f32_16x16x32_bf16 v[20:23], v[208:211], v[216:219], v[20:23]
  v_mfma_f32_16x16x32_bf16 v[24:27], v[212:215], v[216:219], v[24:27]
  buffer_load_dwordx4 v[216:219], v2, s[32:35], s66 offen
  s_add_u32 s66, s66, 4096
  v_mfma_f32_16x16x32_bf16 v[28:31], v[196:199], v[220:223], v[28:31]
  v_mfma_f32_16x16x32_bf16 v[32:35], v[200:203], v[220:223], v[32:35]
  v_mfma_f32_16x16x32_bf16 v[36:39], v[204:207], v[220:223], v[36:39]
  v_mfma_f32_16x16x32_bf16 v[40:43], v[208:211], v[220:223], v[40:43]
  v_mfma_f32_16x16x32_bf16 v[44:47], v[212:215], v[220:223], v[44:47]
  buffer_load_dwordx4 v[220:223], v2, s[32:35], s67 offen
  s_add_u32 s67, s67, 4096
  v_mfma_f32_16x16x32_bf16 v[48:51], v[196:199], v[224:227], v[48:51]
  v_mfma_f32_16x16x32_bf16 v[52:55], v[200:203], v[224:227], v[52:55]
  v_mfma_f32_16x16x32_bf16 v[56:59], v[204:207], v[224:227], v[56:59]
  v_mfma_f32_16x16x32_bf16 v[60:63], v[208:211], v[224:227], v[60:63]
  v_mfma_f32_16x16x32_bf16 v[64:67], v[212:215], v[224:227], v[64:67]
  buffer_load_dwordx4 v[224:227], v2, s[32:35], s68 offen
  s_add_u32 s68, s68, 4096
  v_mfma_f32_16x16x32_bf16 v[68:71], v[196:199], v[228:231], v[68:71]
  s_mov_b32 s70, 143360
  s_mov_b32 s71, 147456
  buffer_load_dwordx4 v[196:199], v1, s[52:55], s70 offen offset:0
  v_mfma_f32_16x16x32_bf16 v[72:75], v[200:203], v[228:231], v[72:75]
  buffer_load_dwordx4 v[200:203], v1, s[52:55], s70 offen offset:1024
  v_mfma_f32_16x16x32_bf16 v[76:79], v[204:207], v[228:231], v[76:79]
  buffer_load_dwordx4 v[204:207], v1, s[52:55], s70 offen offset:2048
  v_mfma_f32_16x16x32_bf16 v[80:83], v[208:211], v[228:231], v[80:83]
  buffer_load_dwordx4 v[208:211], v1, s[52:55], s70 offen offset:3072
  v_mfma_f32_16x16x32_bf16 v[84:87], v[212:215], v[228:231], v[84:87]
  buffer_load_dwordx4 v[212:215], v1, s[52:55], s71 offen
  buffer_load_dwordx4 v[228:231], v2, s[32:35], s69 offen
  s_add_u32 s69, s69, 4096
  s_waitcnt vmcnt(17)
  s_waitcnt lgkmcnt(0)
  v_mfma_f32_16x16x32_bf16 v[8:11], v[88:91], v[108:111], v[8:11]
  v_mfma_f32_16x16x32_bf16 v[12:15], v[92:95], v[108:111], v[12:15]
  v_mfma_f32_16x16x32_bf16 v[16:19], v[96:99], v[108:111], v[16:19]
  v_mfma_f32_16x16x32_bf16 v[20:23], v[100:103], v[108:111], v[20:23]
  v_mfma_f32_16x16x32_bf16 v[24:27], v[104:107], v[108:111], v[24:27]
  buffer_load_dwordx4 v[108:111], v2, s[32:35], s66 offen
  s_add_u32 s66, s66, 4096
  v_mfma_f32_16x16x32_bf16 v[28:31], v[88:91], v[112:115], v[28:31]
  v_mfma_f32_16x16x32_bf16 v[32:35], v[92:95], v[112:115], v[32:35]
  v_mfma_f32_16x16x32_bf16 v[36:39], v[96:99], v[112:115], v[36:39]
  v_mfma_f32_16x16x32_bf16 v[40:43], v[100:103], v[112:115], v[40:43]
  v_mfma_f32_16x16x32_bf16 v[44:47], v[104:107], v[112:115], v[44:47]
  buffer_load_dwordx4 v[112:115], v2, s[32:35], s67 offen
  s_add_u32 s67, s67, 4096
  v_mfma_f32_16x16x32_bf16 v[48:51], v[88:91], v[116:119], v[48:51]
  v_mfma_f32_16x16x32_bf16 v[52:55], v[92:95], v[116:119], v[52:55]
  v_mfma_f32_16x16x32_bf16 v[56:59], v[96:99], v[116:119], v[56:59]
  v_mfma_f32_16x16x32_bf16 v[60:63], v[100:103], v[116:119], v[60:63]
  v_mfma_f32_16x16x32_bf16 v[64:67], v[104:107], v[116:119], v[64:67]
  buffer_load_dwordx4 v[116:119], v2, s[32:35], s68 offen
  s_add_u32 s68, s68, 4096
  v_mfma_f32_16x16x32_bf16 v[68:71], v[88:91], v[120:123], v[68:71]
  s_mov_b32 s70, 163840
  s_mov_b32 s71, 167936
  buffer_load_dwordx4 v[88:91], v1, s[52:55], s70 offen offset:0
  v_mfma_f32_16x16x32_bf16 v[72:75], v[92:95], v[120:123], v[72:75]
  buffer_load_dwordx4 v[92:95], v1, s[52:55], s70 offen offset:1024
  v_mfma_f32_16x16x32_bf16 v[76:79], v[96:99], v[120:123], v[76:79]
  buffer_load_dwordx4 v[96:99], v1, s[52:55], s70 offen offset:2048
  v_mfma_f32_16x16x32_bf16 v[80:83], v[100:103], v[120:123], v[80:83]
  buffer_load_dwordx4 v[100:103], v1, s[52:55], s70 offen offset:3072
  v_mfma_f32_16x16x32_bf16 v[84:87], v[104:107], v[120:123], v[84:87]
  buffer_load_dwordx4 v[104:107], v1, s[52:55], s71 offen
  buffer_load_dwordx4 v[120:123], v2, s[32:35], s69 offen
  s_add_u32 s69, s69, 4096
  s_waitcnt vmcnt(22)
  s_waitcnt lgkmcnt(0)
  v_mfma_f32_16x16x32_bf16 v[8:11], v[124:127], v[144:147], v[8:11]
  v_mfma_f32_16x16x32_bf16 v[12:15], v[128:131], v[144:147], v[12:15]
  v_mfma_f32_16x16x32_bf16 v[16:19], v[132:135], v[144:147], v[16:19]
  v_mfma_f32_16x16x32_bf16 v[20:23], v[136:139], v[144:147], v[20:23]
  v_mfma_f32_16x16x32_bf16 v[24:27], v[140:143], v[144:147], v[24:27]
  buffer_load_dwordx4 v[144:147], v2, s[32:35], s66 offen
  s_add_u32 s66, s66, 4096
  v_mfma_f32_16x16x32_bf16 v[28:31], v[124:127], v[148:151], v[28:31]
  v_mfma_f32_16x16x32_bf16 v[32:35], v[128:131], v[148:151], v[32:35]
  v_mfma_f32_16x16x32_bf16 v[36:39], v[132:135], v[148:151], v[36:39]
  v_mfma_f32_16x16x32_bf16 v[40:43], v[136:139], v[148:151], v[40:43]
  v_mfma_f32_16x16x32_bf16 v[44:47], v[140:143], v[148:151], v[44:47]
  buffer_load_dwordx4 v[148:151], v2, s[32:35], s67 offen
  s_add_u32 s67, s67, 4096
  v_mfma_f32_16x16x32_bf16 v[48:51], v[124:127], v[152:155], v[48:51]
  v_mfma_f32_16x16x32_bf16 v[52:55], v[128:131], v[152:155], v[52:55]
  v_mfma_f32_16x16x32_bf16 v[56:59], v[132:135], v[152:155], v[56:59]
  v_mfma_f32_16x16x32_bf16 v[60:63], v[136:139], v[152:155], v[60:63]
  v_mfma_f32_16x16x32_bf16 v[64:67], v[140:143], v[152:155], v[64:67]
  buffer_load_dwordx4 v[152:155], v2, s[32:35], s68 offen
  s_add_u32 s68, s68, 4096
  v_mfma_f32_16x16x32_bf16 v[68:71], v[124:127], v[156:159], v[68:71]
  s_mov_b32 s70, 184320
  s_mov_b32 s71, 188416
  buffer_load_dwordx4 v[124:127], v1, s[52:55], s70 offen offset:0
  v_mfma_f32_16x16x32_bf16 v[72:75], v[128:131], v[156:159], v[72:75]
  buffer_load_dwordx4 v[128:131], v1, s[52:55], s70 offen offset:1024
  v_mfma_f32_16x16x32_bf16 v[76:79], v[132:135], v[156:159], v[76:79]
  buffer_load_dwordx4 v[132:135], v1, s[52:55], s70 offen offset:2048
  v_mfma_f32_16x16x32_bf16 v[80:83], v[136:139], v[156:159], v[80:83]
  buffer_load_dwordx4 v[136:139], v1, s[52:55], s70 offen offset:3072
  v_mfma_f32_16x16x32_bf16 v[84:87], v[140:143], v[156:159], v[84:87]
  buffer_load_dwordx4 v[140:143], v1, s[52:55], s71 offen
  buffer_load_dwordx4 v[156:159], v2, s[32:35], s69 offen
  s_add_u32 s69, s69, 4096
  s_waitcnt vmcnt(27)
  s_waitcnt lgkmcnt(0)
  s_lshl_b32 s60, s61, 2
  s_add_u32 s60, s60, 122960
  v_mov_b32 v254, s60
  v_mov_b32 v255, 1
  ds_write_b32 v254, v255
  v_mfma_f32_16x16x32_bf16 v[8:11], v[160:163], v[180:183], v[8:11]
  v_mfma_f32_16x16x32_bf16 v[12:15], v[164:167], v[180:183], v[12:15]
  v_mfma_f32_16x16x32_bf16 v[16:19], v[168:171], v[180:183], v[16:19]
  v_mfma_f32_16x16x32_bf16 v[20:23], v[172:175], v[180:183], v[20:23]
  v_mfma_f32_16x16x32_bf16 v[24:27], v[176:179], v[180:183], v[24:27]
  buffer_load_dwordx4 v[180:183], v2, s[32:35], s66 offen
  s_add_u32 s66, s66, 4096
  v_mfma_f32_16x16x32_bf16 v[28:31], v[160:163], v[184:187], v[28:31]
  v_mfma_f32_16x16x32_bf16 v[32:35], v[164:167], v[184:187], v[32:35]
  v_mfma_f32_16x16x32_bf16 v[36:39], v[168:171], v[184:187], v[36:39]
  v_mfma_f32_16x16x32_bf16 v[40:43], v[172:175], v[184:187], v[40:43]
  v_mfma_f32_16x16x32_bf16 v[44:47], v[176:179], v[184:187], v[44:47]
  buffer_load_dwordx4 v[184:187], v2, s[32:35], s67 offen
  s_add_u32 s67, s67, 4096
  v_mfma_f32_16x16x32_bf16 v[48:51], v[160:163], v[188:191], v[48:51]
  v_mfma_f32_16x16x32_bf16 v[52:55], v[164:167], v[188:191], v[52:55]
  v_mfma_f32_16x16x32_bf16 v[56:59], v[168:171], v[188:191], v[56:59]
  v_mfma_f32_16x16x32_bf16 v[60:63], v[172:175], v[188:191], v[60:63]
  v_mfma_f32_16x16x32_bf16 v[64:67], v[176:179], v[188:191], v[64:67]
  buffer_load_dwordx4 v[188:191], v2, s[32:35], s68 offen
  s_add_u32 s68, s68, 4096
  v_mfma_f32_16x16x32_bf16 v[68:71], v[160:163], v[192:195], v[68:71]
  s_mov_b32 s70, 204800
  s_mov_b32 s71, 208896
  buffer_load_dwordx4 v[160:163], v1, s[52:55], s70 offen offset:0
  v_mfma_f32_16x16x32_bf16 v[72:75], v[164:167], v[192:195], v[72:75]
  buffer_load_dwordx4 v[164:167], v1, s[52:55], s70 offen offset:1024
  v_mfma_f32_16x16x32_bf16 v[76:79], v[168:171], v[192:195], v[76:79]
  buffer_load_dwordx4 v[168:171], v1, s[52:55], s70 offen offset:2048
  v_mfma_f32_16x16x32_bf16 v[80:83], v[172:175], v[192:195], v[80:83]
  buffer_load_dwordx4 v[172:175], v1, s[52:55], s70 offen offset:3072
  v_mfma_f32_16x16x32_bf16 v[84:87], v[176:179], v[192:195], v[84:87]
  buffer_load_dwordx4 v[176:179], v1, s[52:55], s71 offen
  buffer_load_dwordx4 v[192:195], v2, s[32:35], s69 offen
  s_add_u32 s69, s69, 4096
  s_waitcnt vmcnt(27)
  v_mfma_f32_16x16x32_bf16 v[8:11], v[196:199], v[216:219], v[8:11]
  v_mfma_f32_16x16x32_bf16 v[12:15], v[200:203], v[216:219], v[12:15]
  v_mfma_f32_16x16x32_bf16 v[16:19], v[204:207], v[216:219], v[16:19]
  v_mfma_f32_16x16x32_bf16 v[20:23], v[208:211], v[216:219], v[20:23]
  v_mfma_f32_16x16x32_bf16 v[24:27], v[212:215], v[216:219], v[24:27]
  buffer_load_dwordx4 v[216:219], v2, s[32:35], s66 offen
  s_add_u32 s66, s66, 4096
  v_mfma_f32_16x16x32_bf16 v[28:31], v[196:199], v[220:223], v[28:31]
  v_mfma_f32_16x16x32_bf16 v[32:35], v[200:203], v[220:223], v[32:35]
  v_mfma_f32_16x16x32_bf16 v[36:39], v[204:207], v[220:223], v[36:39]
  v_mfma_f32_16x16x32_bf16 v[40:43], v[208:211], v[220:223], v[40:43]
  v_mfma_f32_16x16x32_bf16 v[44:47], v[212:215], v[220:223], v[44:47]
  buffer_load_dwordx4 v[220:223], v2, s[32:35], s67 offen
  s_add_u32 s67, s67, 4096
  v_mfma_f32_16x16x32_bf16 v[48:51], v[196:199], v[224:227], v[48:51]
  v_mfma_f32_16x16x32_bf16 v[52:55], v[200:203], v[224:227], v[52:55]
  v_mfma_f32_16x16x32_bf16 v[56:59], v[204:207], v[224:227], v[56:59]
  v_mfma_f32_16x16x32_bf16 v[60:63], v[208:211], v[224:227], v[60:63]
  v_mfma_f32_16x16x32_bf16 v[64:67], v[212:215], v[224:227], v[64:67]
  buffer_load_dwordx4 v[224:227], v2, s[32:35], s68 offen
  s_add_u32 s68, s68, 4096
  v_mfma_f32_16x16x32_bf16 v[68:71], v[196:199], v[228:231], v[68:71]
  s_mov_b32 s70, 225280
  s_mov_b32 s71, 229376
  buffer_load_dwordx4 v[196:199], v1, s[52:55], s70 offen offset:0
  v_mfma_f32_16x16x32_bf16 v[72:75], v[200:203], v[228:231], v[72:75]
  buffer_load_dwordx4 v[200:203], v1, s[52:55], s70 offen offset:1024
  v_mfma_f32_16x16x32_bf16 v[76:79], v[204:207], v[228:231], v[76:79]
  buffer_load_dwordx4 v[204:207], v1, s[52:55], s70 offen offset:2048
  v_mfma_f32_16x16x32_bf16 v[80:83], v[208:211], v[228:231], v[80:83]
  buffer_load_dwordx4 v[208:211], v1, s[52:55], s70 offen offset:3072
  v_mfma_f32_16x16x32_bf16 v[84:87], v[212:215], v[228:231], v[84:87]
  buffer_load_dwordx4 v[212:215], v1, s[52:55], s71 offen
  buffer_load_dwordx4 v[228:231], v2, s[32:35], s69 offen
  s_add_u32 s69, s69, 4096
  s_waitcnt vmcnt(27)
  v_mfma_f32_16x16x32_bf16 v[8:11], v[88:91], v[108:111], v[8:11]
  v_mfma_f32_16x16x32_bf16 v[12:15], v[92:95], v[108:111], v[12:15]
  v_mfma_f32_16x16x32_bf16 v[16:19], v[96:99], v[108:111], v[16:19]
  v_mfma_f32_16x16x32_bf16 v[20:23], v[100:103], v[108:111], v[20:23]
  v_mfma_f32_16x16x32_bf16 v[24:27], v[104:107], v[108:111], v[24:27]
  v_mfma_f32_16x16x32_bf16 v[28:31], v[88:91], v[112:115], v[28:31]
  v_mfma_f32_16x16x32_bf16 v[32:35], v[92:95], v[112:115], v[32:35]
  v_mfma_f32_16x16x32_bf16 v[36:39], v[96:99], v[112:115], v[36:39]
  v_mfma_f32_16x16x32_bf16 v[40:43], v[100:103], v[112:115], v[40:43]
  v_mfma_f32_16x16x32_bf16 v[44:47], v[104:107], v[112:115], v[44:47]
  v_mfma_f32_16x16x32_bf16 v[48:51], v[88:91], v[116:119], v[48:51]
  v_mfma_f32_16x16x32_bf16 v[52:55], v[92:95], v[116:119], v[52:55]
  v_mfma_f32_16x16x32_bf16 v[56:59], v[96:99], v[116:119], v[56:59]
  v_mfma_f32_16x16x32_bf16 v[60:63], v[100:103], v[116:119], v[60:63]
  v_mfma_f32_16x16x32_bf16 v[64:67], v[104:107], v[116:119], v[64:67]
  v_mfma_f32_16x16x32_bf16 v[68:71], v[88:91], v[120:123], v[68:71]
  v_mfma_f32_16x16x32_bf16 v[72:75], v[92:95], v[120:123], v[72:75]
  v_mfma_f32_16x16x32_bf16 v[76:79], v[96:99], v[120:123], v[76:79]
  v_mfma_f32_16x16x32_bf16 v[80:83], v[100:103], v[120:123], v[80:83]
  v_mfma_f32_16x16x32_bf16 v[84:87], v[104:107], v[120:123], v[84:87]
  s_waitcnt vmcnt(18)
  v_mfma_f32_16x16x32_bf16 v[8:11], v[124:127], v[144:147], v[8:11]
  v_mfma_f32_16x16x32_bf16 v[12:15], v[128:131], v[144:147], v[12:15]
  v_mfma_f32_16x16x32_bf16 v[16:19], v[132:135], v[144:147], v[16:19]
  v_mfma_f32_16x16x32_bf16 v[20:23], v[136:139], v[144:147], v[20:23]
  v_mfma_f32_16x16x32_bf16 v[24:27], v[140:143], v[144:147], v[24:27]
  v_mfma_f32_16x16x32_bf16 v[28:31], v[124:127], v[148:151], v[28:31]
  v_mfma_f32_16x16x32_bf16 v[32:35], v[128:131], v[148:151], v[32:35]
  v_mfma_f32_16x16x32_bf16 v[36:39], v[132:135], v[148:151], v[36:39]
  v_mfma_f32_16x16x32_bf16 v[40:43], v[136:139], v[148:151], v[40:43]
  v_mfma_f32_16x16x32_bf16 v[44:47], v[140:143], v[148:151], v[44:47]
  v_mfma_f32_16x16x32_bf16 v[48:51], v[124:127], v[152:155], v[48:51]
  v_mfma_f32_16x16x32_bf16 v[52:55], v[128:131], v[152:155], v[52:55]
  v_mfma_f32_16x16x32_bf16 v[56:59], v[132:135], v[152:155], v[56:59]
  v_mfma_f32_16x16x32_bf16 v[60:63], v[136:139], v[152:155], v[60:63]
  v_mfma_f32_16x16x32_bf16 v[64:67], v[140:143], v[152:155], v[64:67]
  v_mfma_f32_16x16x32_bf16 v[68:71], v[124:127], v[156:159], v[68:71]
  v_mfma_f32_16x16x32_bf16 v[72:75], v[128:131], v[156:159], v[72:75]
  v_mfma_f32_16x16x32_bf16 v[76:79], v[132:135], v[156:159], v[76:79]
  v_mfma_f32_16x16x32_bf16 v[80:83], v[136:139], v[156:159], v[80:83]
  v_mfma_f32_16x16x32_bf16 v[84:87], v[140:143], v[156:159], v[84:87]
  s_waitcnt vmcnt(9)
  v_mfma_f32_16x16x32_bf16 v[8:11], v[160:163], v[180:183], v[8:11]
  v_mfma_f32_16x16x32_bf16 v[12:15], v[164:167], v[180:183], v[12:15]
  v_mfma_f32_16x16x32_bf16 v[16:19], v[168:171], v[180:183], v[16:19]
  v_mfma_f32_16x16x32_bf16 v[20:23], v[172:175], v[180:183], v[20:23]
  v_mfma_f32_16x16x32_bf16 v[24:27], v[176:179], v[180:183], v[24:27]
  v_mfma_f32_16x16x32_bf16 v[28:31], v[160:163], v[184:187], v[28:31]
  v_mfma_f32_16x16x32_bf16 v[32:35], v[164:167], v[184:187], v[32:35]
  v_mfma_f32_16x16x32_bf16 v[36:39], v[168:171], v[184:187], v[36:39]
  v_mfma_f32_16x16x32_bf16 v[40:43], v[172:175], v[184:187], v[40:43]
  v_mfma_f32_16x16x32_bf16 v[44:47], v[176:179], v[184:187], v[44:47]
  v_mfma_f32_16x16x32_bf16 v[48:51], v[160:163], v[188:191], v[48:51]
  v_mfma_f32_16x16x32_bf16 v[52:55], v[164:167], v[188:191], v[52:55]
  v_mfma_f32_16x16x32_bf16 v[56:59], v[168:171], v[188:191], v[56:59]
  v_mfma_f32_16x16x32_bf16 v[60:63], v[172:175], v[188:191], v[60:63]
  v_mfma_f32_16x16x32_bf16 v[64:67], v[176:179], v[188:191], v[64:67]
  v_mfma_f32_16x16x32_bf16 v[68:71], v[160:163], v[192:195], v[68:71]
  v_mfma_f32_16x16x32_bf16 v[72:75], v[164:167], v[192:195], v[72:75]
  v_mfma_f32_16x16x32_bf16 v[76:79], v[168:171], v[192:195], v[76:79]
  v_mfma_f32_16x16x32_bf16 v[80:83], v[172:175], v[192:195], v[80:83]
  v_mfma_f32_16x16x32_bf16 v[84:87], v[176:179], v[192:195], v[84:87]
  s_waitcnt vmcnt(0)
  v_mov_b32 v254, 122960
K2f_dn:
  ds_read_b128 v[244:247], v254
  s_waitcnt lgkmcnt(0)
  v_and_b32 v244, v244, v245
  v_and_b32 v246, v246, v247
  v_and_b32 v244, v244, v246
  s_nop 0
  v_readfirstlane_b32 s60, v244
  s_and_b32 s60, s60, -1
  s_cbranch_scc0 K2f_dn
  v_mov_b32 v254, 122944
K2f_p2:
  ds_read_b128 v[244:247], v254
  s_waitcnt lgkmcnt(0)
  v_and_b32 v244, v244, v245
  v_and_b32 v246, v246, v247
  v_and_b32 v244, v244, v246
  s_nop 0
  v_readfirstlane_b32 s60, v244
  s_and_b32 s60, s60, -1
  s_cbranch_scc0 K2f_p2
  s_add_u32 s60, s61, 1
  s_and_b32 s60, s60, 3
  s_mul_i32 s60, s60, 15360
  s_add_u32 s60, s60, 0
  v_add_u32 v4, s60, v3
  s_add_u32 s60, s61, 2
  s_and_b32 s60, s60, 3
  s_mul_i32 s60, s60, 15360
  s_add_u32 s60, s60, 5120
  v_add_u32 v5, s60, v3
  s_add_u32 s60, s61, 3
  s_and_b32 s60, s60, 3
  s_mul_i32 s60, s60, 15360
  s_add_u32 s60, s60, 10240
  v_add_u32 v6, s60, v3
  v_mfma_f32_16x16x32_bf16 v[28:31], v[196:199], v[220:223], v[28:31]
  v_mfma_f32_16x16x32_bf16 v[32:35], v[200:203], v[220:223], v[32:35]
  v_mfma_f32_16x16x32_bf16 v[36:39], v[204:207], v[220:223], v[36:39]
  v_mfma_f32_16x16x32_bf16 v[40:43], v[208:211], v[220:223], v[40:43]
  v_mfma_f32_16x16x32_bf16 v[44:47], v[212:215], v[220:223], v[44:47]
  v_mfma_f32_16x16x32_bf16 v[48:51], v[196:199], v[224:227], v[48:51]
  v_mfma_f32_16x16x32_bf16 v[52:55], v[200:203], v[224:227], v[52:55]
  v_mfma_f32_16x16x32_bf16 v[56:59], v[204:207], v[224:227], v[56:59]
  v_mfma_f32_16x16x32_bf16 v[60:63], v[208:211], v[224:227], v[60:63]
  v_mfma_f32_16x16x32_bf16 v[64:67], v[212:215], v[224:227], v[64:67]
  v_mfma_f32_16x16x32_bf16 v[68:71], v[196:199], v[228:231], v[68:71]
  ds_write_b128 v4, v[28:31] offset:0
  v_mfma_f32_16x16x32_bf16 v[72:75], v[200:203], v[228:231], v[72:75]
  ds_write_b128 v4, v[32:35] offset:1024
  v_mfma_f32_16x16x32_bf16 v[76:79], v[204:207], v[228:231], v[76:79]
  ds_write_b128 v4, v[36:39] offset:2048
  v_mfma_f32_16x16x32_bf16 v[80:83], v[208:211], v[228:231], v[80:83]
  ds_write_b128 v4, v[40:43] offset:3072
  v_mfma_f32_16x16x32_bf16 v[84:87], v[212:215], v[228:231], v[84:87]
  ds_write_b128 v4, v[44:47] offset:4096
  v_mfma_f32_16x16x32_bf16 v[8:11], v[196:199], v[216:219], v[8:11]
  ds_write_b128 v5, v[48:51] offset:0
  v_mfma_f32_16x16x32_bf16 v[12:15], v[200:203], v[216:219], v[12:15]
  ds_write_b128 v5, v[52:55] offset:1024
  v_mfma_f32_16x16x32_bf16 v[16:19], v[204:207], v[216:219], v[16:19]
  ds_write_b128 v5, v[56:59] offset:2048
  v_mfma_f32_16x16x32_bf16 v[20:23], v[208:211], v[216:219], v[20:23]
  ds_write_b128 v5, v[60:63] offset:3072
  v_mfma_f32_16x16x32_bf16 v[24:27], v[212:215], v[216:219], v[24:27]
  ds_write_b128 v5, v[64:67] offset:4096
  s_nop 7
  ds_write_b128 v6, v[68:71] offset:0
  ds_write_b128 v6, v[72:75] offset:1024
  ds_write_b128 v6, v[76:79] offset:2048
  ds_write_b128 v6, v[80:83] offset:3072
  ds_write_b128 v6, v[84:87] offset:4096
  s_waitcnt lgkmcnt(0)
  s_lshl_b32 s60, s61, 2
  s_add_u32 s60, s60, 122960
  v_mov_b32 v254, s60
  v_mov_b32 v255, 3
  ds_write_b32 v254, v255
  s_mul_i32 s60, s61, 15360
  s_add_u32 s60, s60, 0
  v_add_u32 v4, s60, v3
  v_mov_b32 v254, 122960
K2f_rf:
  ds_read_b128 v[244:247], v254
  s_waitcnt lgkmcnt(0)
  v_and_b32 v244, v244, v245
  v_and_b32 v246, v246, v247
  v_and_b32 v244, v244, v246
  s_nop 0
  v_readfirstlane_b32 s60, v244
  s_and_b32 s60, s60, 2
  s_cbranch_scc0 K2f_rf
  ds_read_b128 v[88:91], v4 offset:0
  ds_read_b128 v[92:95], v4 offset:1024
  ds_read_b128 v[96:99], v4 offset:2048
  ds_read_b128 v[100:103], v4 offset:3072
  ds_read_b128 v[104:107], v4 offset:4096
  ds_read_b128 v[108:111], v4 offset:5120
  ds_read_b128 v[112:115], v4 offset:6144
  ds_read_b128 v[116:119], v4 offset:7168
  ds_read_b128 v[120:123], v4 offset:8192
  ds_read_b128 v[124:127], v4 offset:9216
  ds_read_b128 v[128:131], v4 offset:10240
  ds_read_b128 v[132:135], v4 offset:11264
  ds_read_b128 v[136:139], v4 offset:12288
  ds_read_b128 v[140:143], v4 offset:13312
  ds_read_b128 v[144:147], v4 offset:14336
  s_waitcnt lgkmcnt(10)
  v_pk_add_f32 v[8:9], v[8:9], v[88:89]
  v_pk_add_f32 v[10:11], v[10:11], v[90:91]
  v_pk_add_f32 v[12:13], v[12:13], v[92:93]
  v_pk_add_f32 v[14:15], v[14:15], v[94:95]
  v_pk_add_f32 v[16:17], v[16:17], v[96:97]
  v_pk_add_f32 v[18:19], v[18:19], v[98:99]
  v_pk_add_f32 v[20:21], v[20:21], v[100:101]
  v_pk_add_f32 v[22:23], v[22:23], v[102:103]
  v_pk_add_f32 v[24:25], v[24:25], v[104:105]
  v_pk_add_f32 v[26:27], v[26:27], v[106:107]
  s_waitcnt lgkmcnt(5)
  v_pk_add_f32 v[8:9], v[8:9], v[108:109]
  v_pk_add_f32 v[10:11], v[10:11], v[110:111]
  v_pk_add_f32 v[12:13], v[12:13], v[112:113]
  v_pk_add_f32 v[14:15], v[14:15], v[114:115]
  v_pk_add_f32 v[16:17], v[16:17], v[116:117]
  v_pk_add_f32 v[18:19], v[18:19], v[118:119]
  v_pk_add_f32 v[20:21], v[20:21], v[120:121]
  v_pk_add_f32 v[22:23], v[22:23], v[122:123]
  v_pk_add_f32 v[24:25], v[24:25], v[124:125]
  v_pk_add_f32 v[26:27], v[26:27], v[126:127]
  s_waitcnt lgkmcnt(0)
  v_pk_add_f32 v[8:9], v[8:9], v[128:129]
  v_pk_add_f32 v[10:11], v[10:11], v[130:131]
  v_pk_add_f32 v[12:13], v[12:13], v[132:133]
  v_pk_add_f32 v[14:15], v[14:15], v[134:135]
  v_pk_add_f32 v[16:17], v[16:17], v[136:137]
  v_pk_add_f32 v[18:19], v[18:19], v[138:139]
  v_pk_add_f32 v[20:21], v[20:21], v[140:141]
  v_pk_add_f32 v[22:23], v[22:23], v[142:143]
  v_pk_add_f32 v[24:25], v[24:25], v[144:145]
  v_pk_add_f32 v[26:27], v[26:27], v[146:147]
  v_mul_f32 v88, 0xbfb8aa3b, v8
  v_mul_f32 v89, 0xbfb8aa3b, v9
  v_mul_f32 v90, 0xbfb8aa3b, v10
  v_mul_f32 v91, 0xbfb8aa3b, v11
  v_exp_f32 v88, v88
  v_exp_f32 v89, v89
  v_exp_f32 v90, v90
  v_exp_f32 v91, v91
  v_add_f32 v88, 1.0, v88
  v_add_f32 v89, 1.0, v89
  v_add_f32 v90, 1.0, v90
  v_add_f32 v91, 1.0, v91
  v_rcp_f32 v88, v88
  v_rcp_f32 v89, v89
  v_rcp_f32 v90, v90
  v_rcp_f32 v91, v91
  v_mul_f32 v8, v8, v88
  v_mul_f32 v9, v9, v89
  v_mul_f32 v10, v10, v90
  v_mul_f32 v11, v11, v91
  ds_write_b128 v4, v[8:11] offset:0
  v_mul_f32 v88, 0xbfb8aa3b, v12
  v_mul_f32 v89, 0xbfb8aa3b, v13
  v_mul_f32 v90, 0xbfb8aa3b, v14
  v_mul_f32 v91, 0xbfb8aa3b, v15
  v_exp_f32 v88, v88
  v_exp_f32 v89, v89
  v_exp_f32 v90, v90
  v_exp_f32 v91, v91
  v_add_f32 v88, 1.0, v88
  v_add_f32 v89, 1.0, v89
  v_add_f32 v90, 1.0, v90
  v_add_f32 v91, 1.0, v91
  v_rcp_f32 v88, v88
  v_rcp_f32 v89, v89
  v_rcp_f32 v90, v90
  v_rcp_f32 v91, v91
  v_mul_f32 v12, v12, v88
  v_mul_f32 v13, v13, v89
  v_mul_f32 v14, v14, v90
  v_mul_f32 v15, v15, v91
  ds_write_b128 v4, v[12:15] offset:1024
  v_mul_f32 v88, 0xbfb8aa3b, v16
  v_mul_f32 v89, 0xbfb8aa3b, v17
  v_mul_f32 v90, 0xbfb8aa3b, v18
  v_mul_f32 v91, 0xbfb8aa3b, v19
  v_exp_f32 v88, v88
  v_exp_f32 v89, v89
  v_exp_f32 v90, v90
  v_exp_f32 v91, v91
  v_add_f32 v88, 1.0, v88
  v_add_f32 v89, 1.0, v89
  v_add_f32 v90, 1.0, v90
  v_add_f32 v91, 1.0, v91
  v_rcp_f32 v88, v88
  v_rcp_f32 v89, v89
  v_rcp_f32 v90, v90
  v_rcp_f32 v91, v91
  v_mul_f32 v16, v16, v88
  v_mul_f32 v17, v17, v89
  v_mul_f32 v18, v18, v90
  v_mul_f32 v19, v19, v91
  ds_write_b128 v4, v[16:19] offset:2048
  v_mul_f32 v88, 0xbfb8aa3b, v20
  v_mul_f32 v89, 0xbfb8aa3b, v21
  v_mul_f32 v90, 0xbfb8aa3b, v22
  v_mul_f32 v91, 0xbfb8aa3b, v23
  v_exp_f32 v88, v88
  v_exp_f32 v89, v89
  v_exp_f32 v90, v90
  v_exp_f32 v91, v91
  v_add_f32 v88, 1.0, v88
  v_add_f32 v89, 1.0, v89
  v_add_f32 v90, 1.0, v90
  v_add_f32 v91, 1.0, v91
  v_rcp_f32 v88, v88
  v_rcp_f32 v89, v89
  v_rcp_f32 v90, v90
  v_rcp_f32 v91, v91
  v_mul_f32 v20, v20, v88
  v_mul_f32 v21, v21, v89
  v_mul_f32 v22, v22, v90
  v_mul_f32 v23, v23, v91
  ds_write_b128 v4, v[20:23] offset:3072
  v_mul_f32 v88, 0xbfb8aa3b, v24
  v_mul_f32 v89, 0xbfb8aa3b, v25
  v_mul_f32 v90, 0xbfb8aa3b, v26
  v_mul_f32 v91, 0xbfb8aa3b, v27
  v_exp_f32 v88, v88
  v_exp_f32 v89, v89
  v_exp_f32 v90, v90
  v_exp_f32 v91, v91
  v_add_f32 v88, 1.0, v88
  v_add_f32 v89, 1.0, v89
  v_add_f32 v90, 1.0, v90
  v_add_f32 v91, 1.0, v91
  v_rcp_f32 v88, v88
  v_rcp_f32 v89, v89
  v_rcp_f32 v90, v90
  v_rcp_f32 v91, v91
  v_mul_f32 v24, v24, v88
  v_mul_f32 v25, v25, v89
  v_mul_f32 v26, v26, v90
  v_mul_f32 v27, v27, v91
  ds_write_b128 v4, v[24:27] offset:4096
  s_waitcnt lgkmcnt(0)
  s_lshl_b32 s60, s61, 2
  s_add_u32 s60, s60, 122992
  v_mov_b32 v254, s60
  v_mov_b32 v255, 1
  ds_write_b32 v254, v255
  s_waitcnt lgkmcnt(0)
  s_endpgm
K1_end:
  s_endpgm

.section .rodata,"a"
.p2align 6
.amdhsa_kernel recurrent_scan__ssm_conv_s5__dense_activation_squared_relu__prompt_kernel
  .amdhsa_next_free_vgpr 256
  .amdhsa_next_free_sgpr 100
  .amdhsa_accum_offset 256
  .amdhsa_group_segment_fixed_size 0
  .amdhsa_kernarg_size 136
  .amdhsa_user_sgpr_count 2
  .amdhsa_user_sgpr_kernarg_segment_ptr 1
  .amdhsa_system_sgpr_workgroup_id_x 1
  .amdhsa_float_denorm_mode_32 3
.end_amdhsa_kernel
```
